```python
import torch

def _softmax(x, axis=-1):
    return torch.softmax(x, dim=axis)
def _gelu(x):
    return torch.nn.functional.gelu(x, approximate="tanh")
def _silu(x):
    return torch.nn.functional.silu(x)
def _sigmoid(x):
    return torch.sigmoid(x)
def _layernorm(x, axis=-1, eps=1e-5):
    m = x.mean(dim=axis, keepdim=True)
    v = x.var(dim=axis, keepdim=True, unbiased=False)
    return (x - m) / torch.sqrt(v + eps)
def _scatter_add(tgt, idx, src, axis=0):
    return tgt.clone().index_add_(axis, idx, src)
def _segment_sum(src, seg, n):
    out = torch.zeros((n,) + src.shape[1:], dtype=src.dtype)
    return out.index_add_(0, seg, src)
def _pad(x, pw):
    flat = tuple(v for pair in reversed(pw) for v in pair)
    return torch.nn.functional.pad(x, flat)

kernel_name = 'sequential_preLN__ssm_conv_h3__glu_gated_bilinear__prompt'

def setup_inputs():

    _w = (lambda a: (lambda t: t.to(torch.bfloat16) if t.is_floating_point() else t)(torch.as_tensor(a)))
    def _A_setup():
        B, S, D = 1, 2048, 1024
        ks = 4
        return {
            "q": _w((lambda *s: torch.randn(*s, dtype=torch.bfloat16) * 0.05)(B, S, D)),
            "k": _w((lambda *s: torch.randn(*s, dtype=torch.bfloat16) * 0.2)(B, S, D)),
            "v": _w((lambda *s: torch.randn(*s, dtype=torch.bfloat16) * 0.2)(B, S, D)),
            "shift_k": _w((lambda *s: torch.randn(*s, dtype=torch.bfloat16) * 0.2)(D, ks) * 0.5),
            "ssm_k": _w((lambda *s: torch.randn(*s, dtype=torch.bfloat16) * 0.4)(D, S) * (1.0 / S ** 0.5)),
            "ssm_D": _w((lambda *s: torch.randn(*s, dtype=torch.bfloat16) * 0.2)(D)),
        }
    _A_in = _A_setup()

    def _B_setup():
        B, S, D, F = 1, 2048, 1024, 3584
        return {
            "x": _w((lambda *s: torch.randn(*s, dtype=torch.bfloat16) * 0.05)(B, S, D)),
            "w_gate": _w((lambda *s: torch.randn(*s, dtype=torch.bfloat16) * 0.2)(D, F) * (D ** -0.5)),
            "w_up": _w((lambda *s: torch.randn(*s, dtype=torch.bfloat16) * 0.2)(D, F) * (D ** -0.5)),
            "w_down": _w((lambda *s: torch.randn(*s, dtype=torch.bfloat16) * 0.2)(F, D) * (F ** -0.5)),
        }
    _B_in = _B_setup()

    return {
        "A_q": _A_in["q"],
        "A_k": _A_in["k"],
        "A_v": _A_in["v"],
        "A_shift_k": _A_in["shift_k"],
        "A_ssm_k": _A_in["ssm_k"],
        "A_ssm_D": _A_in["ssm_D"],
        "B_x": _B_in["x"],
        "B_w_gate": _B_in["w_gate"],
        "B_w_up": _B_in["w_up"],
        "B_w_down": _B_in["w_down"],
    }

def reference(A_q, A_k, A_v, A_shift_k, A_ssm_k, A_ssm_D, B_x, B_w_gate, B_w_up, B_w_down):
    def _A_ref(q, k, v, shift_k, ssm_k, ssm_D):
        B, S, D = q.shape
        ks = shift_k.shape[-1]
        k_pad = _pad(k, ((0, 0), (ks - 1, 0), (0, 0)))
        k_shift = torch.zeros_like(k)
        for t in range(ks):
            k_shift = k_shift + k_pad[:, t:t + S, :] * shift_k[:, ks - 1 - t][None, None, :]
        kv = k_shift * v
        L = 2 * S
        kv_pad = _pad(kv, ((0, 0), (0, S), (0, 0)))
        kf_pad = _pad(ssm_k, ((0, 0), (0, S)))
        kv_f = (lambda x, axes=(-2,-1): torch.fft.rfft2(x.float(), dim=axes))(kv_pad[:, None, :, :], axes=(1, 2))
        kf_f = (lambda x, axes=(-2,-1): torch.fft.rfft2(x.float(), dim=axes))(kf_pad[:, None, :], axes=(1, 2))
        kf_f = (lambda x, *d: x.permute(*d))(kf_f, 1, 2, 0)
        y_f = kv_f * kf_f[None, :, :, :]
        y = (lambda x, s, axes=(-2,-1): torch.fft.irfft2(x, s=s, dim=axes).to(torch.bfloat16))(y_f, (1, L), axes=(1, 2))[:, 0, :S, :]
        y = y + kv * ssm_D[None, None, :]
        return q * y

    def _B_ref(x, w_gate, w_up, w_down):
        g = torch.einsum("bsd,df->bsf", x, w_gate)
        u = torch.einsum("bsd,df->bsf", x, w_up)
        h = g * u
        return torch.einsum("bsf,fd->bsd", h, w_down)

    x = A_q
    h = x + _A_ref(_layernorm(x, axis=-1), A_k, A_v, A_shift_k, A_ssm_k, A_ssm_D)
    h2 = h + _B_ref(_layernorm(h, axis=-1), B_w_gate, B_w_up, B_w_down)
    return h2
```

```asm
; @launch grid=(256,1,1) block=(256,1,1) lds=159744
.amdgcn_target "amdgcn-amd-amdhsa--gfx950"
.text
.globl sequential_preLN__ssm_conv_h3__glu_gated_bilinear__prompt_kernel
.p2align 8
.type sequential_preLN__ssm_conv_h3__glu_gated_bilinear__prompt_kernel,@function
sequential_preLN__ssm_conv_h3__glu_gated_bilinear__prompt_kernel:
    s_cmp_ge_u32 s2, 256
    s_cbranch_scc1 sequential_preLN__ssm_conv_h3__glu_gated_bilinear__prompt_kernel_done
    s_load_dwordx16 s[4:19], s[0:1], 0
    s_load_dwordx8 s[20:27], s[0:1], 64
    s_load_dwordx2 s[28:29], s[0:1], 96
    v_lshrrev_b32 v1, 6, v0
    v_and_b32 v2, 63, v0
    v_readfirstlane_b32 s30, v1
    s_and_b32 s31, s2, 7
    s_lshr_b32 s3, s2, 3
    s_mov_b32 s56, 0xffff0000
    s_mov_b32 s57, 0x3727c5ac
    s_getpc_b64 s[72:73]
L_pc0:
    s_and_b32 s73, s73, 0xffff
    s_mov_b32 s74, sequential_preLN__ssm_conv_h3__glu_gated_bilinear__prompt_kernel_done-L_pc0
    s_mov_b32 s75, 0x00020000
    s_mul_i32 s76, s3, 2048
    v_lshlrev_b32 v202, 3, v0
    v_add_u32 v202, s76, v202
    buffer_load_dwordx2 v[202:203], v202, s[72:75], 0 offen
    v_and_b32 v8, 7, v0
    v_lshrrev_b32 v9, 3, v0
    s_lshr_b32 s60, s2, 4
    s_and_b32 s61, s2, 15
    s_lshl_b32 s62, s60, 18
    s_lshl_b32 s63, s61, 7
    s_add_u32 s62, s62, s63
    v_lshlrev_b32 v3, 13, v9
    v_lshl_add_u32 v3, v8, 4, v3
    v_add_u32 v3, s62, v3
    v_subrev_u32 v4, 6144, v3
    s_lshl_b32 s63, s61, 9
    v_lshlrev_b32 v5, 6, v8
    v_add_u32 v5, s63, v5
    s_mov_b32 s64, 4096
    s_lshl_b32 s65, s31, 5
    s_add_u32 s65, s65, s3
    s_lshl_b32 s66, s65, 2
    s_add_u32 s66, s66, s30
    s_mul_i32 s67, s30, 25856
    s_lshl_b32 s68, s66, 12
    v_lshlrev_b32 v10, 4, v2
    v_lshlrev_b32 v11, 2, v2
    v_add_u32 v12, 196, v10
    s_lshl_b32 s69, s2, 3
    s_lshl_b32 s70, s30, 1
    s_add_u32 s69, s69, s70
    s_lshl_b32 s70, s69, 11
    v_lshlrev_b32 v13, 3, v2
    v_accvgpr_write_b32 a236, -1
    v_accvgpr_write_b32 a237, -1
    v_accvgpr_write_b32 a238, -1
    v_accvgpr_write_b32 a239, -1
    s_waitcnt lgkmcnt(0)
    s_add_u32 s52, s28, 0x2000000
    s_addc_u32 s53, s29, 0
    s_and_b32 s53, s53, 0xffff
    s_mov_b32 s54, 0x1a000
    s_mov_b32 s55, 0x00020000
    s_lshl_b32 s58, s30, 8
    s_or_b32 s58, s58, s2
    s_cmp_ge_u32 s58, 13
    s_cbranch_scc1 L_noinit_1
    v_lshlrev_b32 v6, 7, v2
    v_mov_b32 v7, 0
    s_lshl_b32 s58, s2, 13
    buffer_store_dword v7, v6, s[52:55], s58 offen sc1
L_noinit_1:
    s_mov_b32 s32, s6
    s_and_b32 s33, s7, 0xffff
    s_mov_b32 s34, 0x400000
    s_mov_b32 s35, 0x00020000
    s_mov_b32 s36, s8
    s_and_b32 s37, s9, 0xffff
    s_mov_b32 s38, 0x400000
    s_mov_b32 s39, 0x00020000
    s_mov_b32 s40, s10
    s_and_b32 s41, s11, 0xffff
    s_mov_b32 s42, 0x2000
    s_mov_b32 s43, 0x00020000
    buffer_load_dwordx4 v[60:63], v5, s[40:43], 0 offen
    buffer_load_dwordx4 v[64:67], v5, s[40:43], 0 offen offset:16
    buffer_load_dwordx4 v[68:71], v5, s[40:43], 0 offen offset:32
    buffer_load_dwordx4 v[72:75], v5, s[40:43], 0 offen offset:48
    buffer_load_dwordx4 v[16:19], v4, s[32:35], 0 offen nt
    buffer_load_dwordx4 v[20:23], v4, s[32:35], 0 offen offset:2048 nt
    buffer_load_dwordx4 v[24:27], v4, s[32:35], s64 offen nt
    buffer_load_dwordx4 v[28:31], v3, s[32:35], 0 offen nt
    buffer_load_dwordx4 v[32:35], v3, s[32:35], 0 offen offset:2048 nt
    buffer_load_dwordx4 v[36:39], v3, s[32:35], s64 offen nt
    buffer_load_dwordx4 v[40:43], v3, s[32:35], s64 offen offset:2048 nt
    buffer_load_dwordx4 v[44:47], v3, s[36:39], 0 offen nt
    buffer_load_dwordx4 v[48:51], v3, s[36:39], 0 offen offset:2048 nt
    buffer_load_dwordx4 v[52:55], v3, s[36:39], s64 offen nt
    buffer_load_dwordx4 v[56:59], v3, s[36:39], s64 offen offset:2048 nt
    s_mov_b32 s48, s14
    s_and_b32 s49, s15, 0xffff
    s_mov_b32 s50, 0x800
    s_mov_b32 s51, 0x00020000
    s_lshl_b32 s58, s66, 1
    v_mov_b32 v6, s58
    buffer_load_ushort v200, v6, s[48:51], 0 offen
    s_mov_b32 s48, s26
    s_and_b32 s49, s27, 0xffff
    s_mov_b32 s50, 0x100
    s_mov_b32 s51, 0x00020000
    s_lshl_b32 s58, s30, 8
    s_or_b32 s58, s58, s2
    s_cmp_ge_u32 s58, 13
    s_cbranch_scc1 L_noflag_2
    s_waitcnt vmcnt(16)
    v_mov_b32 v6, 0
    v_mov_b32 v7, 1
    s_mov_b64 exec, 1
    buffer_atomic_add v7, v6, s[48:51], 0 offen
    s_mov_b64 exec, -1
L_noflag_2:
    s_add_u32 s44, s12, s68
    s_addc_u32 s45, s13, 0
    s_and_b32 s45, s45, 0xffff
    s_mov_b32 s46, 0x1000
    s_mov_b32 s47, 0x00020000
    buffer_load_dword v128, v11, s[44:47], 0 offen offset:0 nt
    buffer_load_dword v129, v11, s[44:47], 0 offen offset:256 nt
    buffer_load_dword v130, v11, s[44:47], 0 offen offset:512 nt
    buffer_load_dword v131, v11, s[44:47], 0 offen offset:768 nt
    buffer_load_dword v132, v11, s[44:47], 0 offen offset:1024 nt
    buffer_load_dword v133, v11, s[44:47], 0 offen offset:1280 nt
    buffer_load_dword v134, v11, s[44:47], 0 offen offset:1536 nt
    buffer_load_dword v135, v11, s[44:47], 0 offen offset:1792 nt
    buffer_load_dword v136, v11, s[44:47], 0 offen offset:2048 nt
    buffer_load_dword v137, v11, s[44:47], 0 offen offset:2304 nt
    buffer_load_dword v138, v11, s[44:47], 0 offen offset:2560 nt
    buffer_load_dword v139, v11, s[44:47], 0 offen offset:2816 nt
    buffer_load_dword v140, v11, s[44:47], 0 offen offset:3072 nt
    buffer_load_dword v141, v11, s[44:47], 0 offen offset:3328 nt
    buffer_load_dword v142, v11, s[44:47], 0 offen offset:3584 nt
    buffer_load_dword v143, v11, s[44:47], 0 offen offset:3840 nt
    s_add_u32 s40, s28, 0x0
    s_addc_u32 s41, s29, 0
    s_and_b32 s41, s41, 0xffff
    s_mov_b32 s42, 0x400000
    s_mov_b32 s43, 0x00020000
    v_sub_u32 v6, 31, v9
    v_lshlrev_b32 v7, 1, v8
    v_xor_b32 v6, v6, v7
    v_lshlrev_b32 v6, 3, v6
    v_lshl_add_u32 v6, v8, 11, v6
    v_add_u32 v14, 120832, v6
    s_and_b32 s83, s3, 7
    s_lshr_b32 s59, s3, 3
    s_lshl_b32 s72, s31, 2
    s_add_u32 s72, s72, s59
    s_lshl_b32 s73, s83, 4
    s_lshl_b32 s59, s30, 2
    s_add_u32 s73, s73, s59
    s_mul_i32 s74, s30, 7168
    s_mov_b32 s75, 0
    s_mov_b32 s76, 0
    s_mov_b32 s77, 0
    s_mov_b32 s78, 0
    s_and_b32 s86, s31, 1
    s_bfe_u32 s58, s31, 0x10001
    s_lshl_b32 s58, s58, 3
    s_and_b32 s59, s3, 7
    s_add_u32 s84, s58, s59
    s_lshr_b32 s58, s31, 2
    s_lshl_b32 s58, s58, 2
    s_lshr_b32 s59, s3, 3
    s_add_u32 s85, s58, s59
    s_lshl_b32 s87, s84, 3
    s_lshl_b32 s58, s30, 1
    s_add_u32 s87, s87, s58
    s_and_b32 s58, s30, 1
    s_lshl_b32 s58, s58, 5
    s_mul_i32 s59, s72, 224
    s_mov_b32 s62, 4682
    s_mov_b32 s63, 7168
    s_and_b32 s101, s72, 1
    s_lshl_b32 s101, s101, 1
    v_add_u32 v104, 0, v2
    v_mul_u32_u24 v105, s62, v104
    v_lshrrev_b32 v105, 16, v105
    v_mul_u32_u24 v106, 14, v105
    v_sub_u32 v106, v104, v106
    v_add_u32 v106, s101, v106
    v_subrev_u32 v108, 14, v106
    v_min_u32 v106, v106, v108
    v_bfe_u32 v107, v105, 2, 2
    v_lshlrev_b32 v107, 3, v107
    v_lshrrev_b32 v108, 4, v105
    v_lshl_add_u32 v107, v108, 2, v107
    v_and_b32 v108, 3, v105
    v_add3_u32 v107, v107, v108, s58
    v_mul_u32_u24 v107, s63, v107
    v_lshl_add_u32 v107, v106, 4, v107
    v_add_u32 v107, s59, v107
    v_accvgpr_write_b32 a176, v107
    v_add_u32 v104, 64, v2
    v_mul_u32_u24 v105, s62, v104
    v_lshrrev_b32 v105, 16, v105
    v_mul_u32_u24 v106, 14, v105
    v_sub_u32 v106, v104, v106
    v_add_u32 v106, s101, v106
    v_subrev_u32 v108, 14, v106
    v_min_u32 v106, v106, v108
    v_bfe_u32 v107, v105, 2, 2
    v_lshlrev_b32 v107, 3, v107
    v_lshrrev_b32 v108, 4, v105
    v_lshl_add_u32 v107, v108, 2, v107
    v_and_b32 v108, 3, v105
    v_add3_u32 v107, v107, v108, s58
    v_mul_u32_u24 v107, s63, v107
    v_lshl_add_u32 v107, v106, 4, v107
    v_add_u32 v107, s59, v107
    v_subrev_u32 v107, 1024, v107
    v_accvgpr_write_b32 a177, v107
    v_add_u32 v104, 128, v2
    v_mul_u32_u24 v105, s62, v104
    v_lshrrev_b32 v105, 16, v105
    v_mul_u32_u24 v106, 14, v105
    v_sub_u32 v106, v104, v106
    v_add_u32 v106, s101, v106
    v_subrev_u32 v108, 14, v106
    v_min_u32 v106, v106, v108
    v_bfe_u32 v107, v105, 2, 2
    v_lshlrev_b32 v107, 3, v107
    v_lshrrev_b32 v108, 4, v105
    v_lshl_add_u32 v107, v108, 2, v107
    v_and_b32 v108, 3, v105
    v_add3_u32 v107, v107, v108, s58
    v_mul_u32_u24 v107, s63, v107
    v_lshl_add_u32 v107, v106, 4, v107
    v_add_u32 v107, s59, v107
    v_subrev_u32 v107, 2048, v107
    v_accvgpr_write_b32 a178, v107
    v_add_u32 v104, 192, v2
    v_mul_u32_u24 v105, s62, v104
    v_lshrrev_b32 v105, 16, v105
    v_mul_u32_u24 v106, 14, v105
    v_sub_u32 v106, v104, v106
    v_add_u32 v106, s101, v106
    v_subrev_u32 v108, 14, v106
    v_min_u32 v106, v106, v108
    v_bfe_u32 v107, v105, 2, 2
    v_lshlrev_b32 v107, 3, v107
    v_lshrrev_b32 v108, 4, v105
    v_lshl_add_u32 v107, v108, 2, v107
    v_and_b32 v108, 3, v105
    v_add3_u32 v107, v107, v108, s58
    v_mul_u32_u24 v107, s63, v107
    v_lshl_add_u32 v107, v106, 4, v107
    v_add_u32 v107, s59, v107
    v_subrev_u32 v107, 3072, v107
    v_accvgpr_write_b32 a179, v107
    v_add_u32 v104, 256, v2
    v_mul_u32_u24 v105, s62, v104
    v_lshrrev_b32 v105, 16, v105
    v_mul_u32_u24 v106, 14, v105
    v_sub_u32 v106, v104, v106
    v_add_u32 v106, s101, v106
    v_subrev_u32 v108, 14, v106
    v_min_u32 v106, v106, v108
    v_bfe_u32 v107, v105, 2, 2
    v_lshlrev_b32 v107, 3, v107
    v_lshrrev_b32 v108, 4, v105
    v_lshl_add_u32 v107, v108, 2, v107
    v_and_b32 v108, 3, v105
    v_add3_u32 v107, v107, v108, s58
    v_mul_u32_u24 v107, s63, v107
    v_lshl_add_u32 v107, v106, 4, v107
    v_add_u32 v107, s59, v107
    v_accvgpr_write_b32 a180, v107
    v_add_u32 v104, 320, v2
    v_mul_u32_u24 v105, s62, v104
    v_lshrrev_b32 v105, 16, v105
    v_mul_u32_u24 v106, 14, v105
    v_sub_u32 v106, v104, v106
    v_add_u32 v106, s101, v106
    v_subrev_u32 v108, 14, v106
    v_min_u32 v106, v106, v108
    v_bfe_u32 v107, v105, 2, 2
    v_lshlrev_b32 v107, 3, v107
    v_lshrrev_b32 v108, 4, v105
    v_lshl_add_u32 v107, v108, 2, v107
    v_and_b32 v108, 3, v105
    v_add3_u32 v107, v107, v108, s58
    v_mul_u32_u24 v107, s63, v107
    v_lshl_add_u32 v107, v106, 4, v107
    v_add_u32 v107, s59, v107
    v_subrev_u32 v107, 1024, v107
    v_accvgpr_write_b32 a181, v107
    v_add_u32 v104, 384, v2
    v_mul_u32_u24 v105, s62, v104
    v_lshrrev_b32 v105, 16, v105
    v_mul_u32_u24 v106, 14, v105
    v_sub_u32 v106, v104, v106
    v_add_u32 v106, s101, v106
    v_subrev_u32 v108, 14, v106
    v_min_u32 v106, v106, v108
    v_bfe_u32 v107, v105, 2, 2
    v_lshlrev_b32 v107, 3, v107
    v_lshrrev_b32 v108, 4, v105
    v_lshl_add_u32 v107, v108, 2, v107
    v_and_b32 v108, 3, v105
    v_add3_u32 v107, v107, v108, s58
    v_mul_u32_u24 v107, s63, v107
    v_lshl_add_u32 v107, v106, 4, v107
    v_add_u32 v107, s59, v107
    v_subrev_u32 v107, 2048, v107
    v_accvgpr_write_b32 a182, v107
    v_lshlrev_b32 v104, 4, v2
    s_lshl_b32 s58, s73, 15
    v_add_u32 v105, s58, v104
    v_accvgpr_write_b32 a183, v105
    v_lshrrev_b32 v105, 2, v2
    v_mul_u32_u24 v105, 224, v105
    v_and_b32 v106, 3, v2
    v_lshl_add_u32 v105, v106, 3, v105
    v_accvgpr_write_b32 a184, v105
    v_and_b32 v105, 15, v2
    v_lshlrev_b32 v105, 4, v105
    v_lshrrev_b32 v106, 5, v2
    v_lshl_add_u32 v105, v106, 8, v105
    v_bfe_u32 v106, v2, 4, 1
    v_lshl_add_u32 v107, v106, 9, v105
    v_accvgpr_write_b32 a185, v107
    v_mul_u32_u24 v106, 114688, v106
    v_add_u32 v107, v106, v105
    v_accvgpr_write_b32 a186, v107
    s_mul_i32 s58, s86, 1792
    s_lshr_b32 s59, s30, 1
    s_mul_i32 s59, s59, 224
    s_add_u32 s58, s58, s59
    s_lshl_b32 s58, s58, 11
    s_lshl_b32 s59, s85, 8
    s_add_u32 s58, s58, s59
    s_and_b32 s59, s30, 1
    s_xor_b32 s59, s59, s86
    s_lshl_b32 s59, s59, 7
    s_add_u32 s58, s58, s59
    v_lshrrev_b32 v104, 5, v2
    v_lshlrev_b32 v104, 3, v104
    v_bfe_u32 v105, v2, 3, 2
    v_add_u32 v104, v104, v105
    v_lshlrev_b32 v104, 11, v104
    v_bfe_u32 v105, v2, 4, 2
    v_lshlrev_b32 v105, 1, v105
    v_and_b32 v106, 7, v2
    v_xor_b32 v105, v105, v106
    v_lshl_add_u32 v104, v105, 4, v104
    v_add_u32 v104, s58, v104
    v_accvgpr_write_b32 a187, v104
    v_lshrrev_b32 v104, 2, v2
    v_lshlrev_b32 v104, 7, v104
    v_and_b32 v105, 3, v2
    v_lshl_add_u32 v104, v105, 3, v104
    v_bfe_u32 v105, v2, 3, 2
    v_xor_b32 v106, 0, v105
    v_lshl_add_u32 v106, v106, 5, v104
    v_accvgpr_write_b32 a188, v106
    v_xor_b32 v106, 1, v105
    v_lshl_add_u32 v106, v106, 5, v104
    v_accvgpr_write_b32 a189, v106
    v_xor_b32 v106, 2, v105
    v_lshl_add_u32 v106, v106, 5, v104
    v_accvgpr_write_b32 a190, v106
    v_xor_b32 v106, 3, v105
    v_lshl_add_u32 v106, v106, 5, v104
    v_accvgpr_write_b32 a191, v106
    s_lshl_b32 s88, s30, 12
    v_lshlrev_b32 v104, 4, v2
    s_mul_i32 s58, s87, 114688
    s_mul_i32 s59, s86, 57344
    s_add_u32 s58, s58, s59
    v_add_u32 v105, s58, v104
    v_accvgpr_write_b32 a192, v105
    v_add_u32 v105, 114688, v105
    v_accvgpr_write_b32 a193, v105
    s_lshl_b32 s58, s87, 15
    s_lshl_b32 s59, s85, 8
    s_add_u32 s58, s58, s59
    s_lshl_b32 s59, s86, 7
    s_add_u32 s58, s58, s59
    v_and_b32 v104, 15, v2
    v_lshlrev_b32 v104, 11, v104
    v_bfe_u32 v105, v2, 4, 1
    v_lshl_add_u32 v104, v105, 5, v104
    v_lshrrev_b32 v105, 5, v2
    v_lshl_add_u32 v104, v105, 4, v104
    v_add_u32 v104, s58, v104
    v_accvgpr_write_b32 a194, v104
    v_lshrrev_b32 v104, 2, v2
    v_lshrrev_b32 v105, 1, v104
    v_and_b32 v104, 1, v104
    v_lshl_add_u32 v104, v104, 2, v105
    v_and_b32 v105, 3, v2
    v_mad_u32_u24 v104, v105, 14, v104
    v_lshlrev_b32 v104, 16, v104
    v_accvgpr_write_b32 a195, v104
    v_readlane_b32 s89, v104, 0
    v_readlane_b32 s90, v104, 1
    v_readlane_b32 s91, v104, 2
    v_readlane_b32 s93, v104, 3
    s_lshl_b32 s58, s83, 1
    s_lshr_b32 s59, s72, 4
    s_add_u32 s58, s58, s59
    s_lshl_b32 s58, s58, 2
    s_add_u32 s58, s58, s30
    s_lshl_b32 s58, s58, 8
    s_add_u32 s58, s58, 51200
    v_lshlrev_b32 v104, 7, v2
    v_add_u32 v104, s58, v104
    v_mov_b32 v105, 0x7fffff00
    v_cmp_gt_u32 vcc, 2, v2
    s_nop 1
    v_cndmask_b32 v104, v105, v104, vcc
    v_accvgpr_write_b32 a196, v104
    s_lshr_b32 s58, s84, 1
    s_lshl_b32 s58, s58, 1
    s_add_u32 s58, s58, s86
    s_lshl_b32 s58, s58, 2
    s_and_b32 s59, s84, 1
    s_lshl_b32 s59, s59, 1
    s_add_u32 s58, s58, s59
    s_lshr_b32 s59, s30, 1
    s_add_u32 s58, s58, s59
    s_lshl_b32 s58, s58, 1
    s_lshr_b32 s59, s31, 2
    s_add_u32 s58, s58, s59
    s_lshl_b32 s58, s58, 7
    s_add_u32 s58, s58, 51200
    v_mov_b32 v104, s58
    v_accvgpr_write_b32 a197, v104
    v_mov_b32 v107, 0x7fffffff
    s_lshl_b32 s58, s3, 1
    s_and_b32 s59, s30, 1
    s_add_u32 s58, s58, s59
    s_mul_i32 s62, s58, 7168
    s_mul_i32 s59, s31, 896
    s_add_u32 s62, s62, s59
    v_lshlrev_b32 v104, 7, v2
    v_add_u32 v105, s62, v104
    v_cmp_gt_u32 vcc, 7, v2
    s_nop 1
    v_cndmask_b32 v224, v107, v105, vcc
    s_and_b32 s58, s3, 7
    s_lshr_b32 s62, s3, 4
    s_lshl_b32 s62, s62, 3
    s_add_u32 s100, s58, s62
    s_lshl_b32 s58, s100, 1
    s_and_b32 s62, s30, 1
    s_add_u32 s58, s58, s62
    s_lshl_b32 s58, s58, 2
    s_add_u32 s58, s58, 512
    s_mul_i32 s58, s58, 7168
    s_add_u32 s58, s58, s59
    s_mov_b32 s62, 9363
    v_mul_u32_u24 v104, s62, v2
    v_lshrrev_b32 v104, 16, v104
    v_mul_u32_u24 v105, 7, v104
    v_sub_u32 v105, v2, v105
    v_mul_u32_u24 v104, 7168, v104
    v_lshl_add_u32 v104, v105, 7, v104
    v_add_u32 v104, s58, v104
    v_cmp_gt_u32 vcc, 28, v2
    s_nop 1
    v_cndmask_b32 v104, v107, v104, vcc
    v_accvgpr_write_b32 a198, v104
    s_lshl_b32 s58, s100, 2
    s_add_u32 s58, s58, s30
    s_mul_i32 s58, s58, 5
    s_add_u32 s58, s58, 1152
    s_mul_i32 s59, s86, 1792
    s_add_u32 s58, s58, s59
    s_lshl_b32 s58, s58, 11
    s_lshr_b32 s59, s85, 2
    s_lshl_b32 s59, s59, 10
    s_add_u32 s58, s58, s59
    v_lshrrev_b32 v104, 3, v2
    v_lshlrev_b32 v104, 11, v104
    v_and_b32 v105, 7, v2
    v_lshl_add_u32 v104, v105, 7, v104
    v_add_u32 v104, s58, v104
    v_cmp_gt_u32 vcc, 40, v2
    s_nop 1
    v_cndmask_b32 v104, v107, v104, vcc
    v_accvgpr_write_b32 a199, v104
    s_and_b32 s92, s3, 1
    s_lshr_b32 s58, s3, 3
    s_add_u32 s58, s58, 1
    s_and_b32 s58, s58, 2
    s_or_b32 s92, s92, s58
    v_and_b32 v104, 1, v2
    v_lshrrev_b32 v105, 1, v2
    v_lshlrev_b32 v106, 11, v104
    v_lshl_add_u32 v106, v105, 4, v106
    v_accvgpr_write_b32 a200, v106
    s_lshl_b32 s58, s30, 4
    s_add_u32 s58, s58, 120832
    v_lshlrev_b32 v106, 6, v2
    v_add_u32 v106, s58, v106
    v_accvgpr_write_b32 a201, v106
    s_lshl_b32 s58, s30, 5
    s_add_u32 s58, s58, 103424
    v_lshlrev_b32 v106, 7, v105
    v_lshl_add_u32 v106, v104, 4, v106
    v_add_u32 v106, s58, v106
    v_accvgpr_write_b32 a202, v106
    v_lshlrev_b32 v106, 4, v0
    v_add_u32 v106, 103424, v106
    v_accvgpr_write_b32 a203, v106
    v_lshrrev_b32 v106, 5, v0
    v_lshlrev_b32 v106, 10, v106
    v_bfe_u32 v107, v0, 3, 2
    v_lshl_add_u32 v106, v107, 8, v106
    v_and_b32 v107, 7, v0
    v_lshl_add_u32 v106, v107, 4, v106
    v_accvgpr_write_b32 a240, v106
    v_and_b32 v104, 1, v2
    v_mov_b32 v226, 0x05040100
    v_mov_b32 v105, 0x03020706
    v_cmp_eq_u32 vcc, 1, v104
    s_nop 1
    v_cndmask_b32 v226, v226, v105, vcc
    v_bfe_u32 v105, v2, 1, 3
    v_lshrrev_b32 v106, 4, v2
    v_mul_u32_u24 v227, 272, v105
    v_lshl_add_u32 v227, v106, 6, v227
    v_lshl_add_u32 v227, v104, 5, v227
    s_lshl_b32 s58, s30, 2
    s_add_u32 s58, s58, 103424
    v_add_u32 v227, s58, v227
    v_lshrrev_b32 v104, 2, v0
    v_and_b32 v105, 3, v0
    v_lshrrev_b32 v106, 4, v0
    v_lshlrev_b32 v228, 6, v104
    v_lshl_add_u32 v228, v106, 4, v228
    v_lshl_add_u32 v228, v105, 4, v228
    v_add_u32 v228, 103424, v228
    v_lshlrev_b32 v229, 14, v104
    v_lshl_add_u32 v229, v105, 4, v229
    s_lshl_b32 s58, s65, 6
    v_add_u32 v229, s58, v229
    s_waitcnt vmcnt(16)
    v_lshlrev_b32 v80, 16, v60
    v_lshlrev_b32 v81, 16, v62
    v_and_b32 v82, s56, v60
    v_and_b32 v83, s56, v62
    v_lshlrev_b32 v84, 16, v61
    v_lshlrev_b32 v85, 16, v63
    v_and_b32 v86, s56, v61
    v_and_b32 v87, s56, v63
    v_lshlrev_b32 v88, 16, v16
    v_and_b32 v89, s56, v16
    v_lshlrev_b32 v90, 16, v20
    v_and_b32 v91, s56, v20
    v_lshlrev_b32 v92, 16, v24
    v_and_b32 v93, s56, v24
    v_lshlrev_b32 v94, 16, v28
    v_and_b32 v95, s56, v28
    v_lshlrev_b32 v96, 16, v32
    v_and_b32 v97, s56, v32
    v_lshlrev_b32 v98, 16, v36
    v_and_b32 v99, s56, v36
    v_lshlrev_b32 v100, 16, v40
    v_and_b32 v101, s56, v40
    v_lshlrev_b32 v102, 16, v44
    v_and_b32 v103, s56, v44
    v_lshlrev_b32 v104, 16, v48
    v_and_b32 v105, s56, v48
    v_lshlrev_b32 v106, 16, v52
    v_and_b32 v107, s56, v52
    v_lshlrev_b32 v108, 16, v56
    v_and_b32 v109, s56, v56
    v_pk_mul_f32 v[110:111], v[88:89], v[86:87]
    v_pk_mul_f32 v[112:113], v[90:91], v[86:87]
    v_pk_mul_f32 v[114:115], v[92:93], v[86:87]
    v_pk_mul_f32 v[116:117], v[94:95], v[86:87]
    v_pk_fma_f32 v[110:111], v[90:91], v[84:85], v[110:111]
    v_pk_fma_f32 v[112:113], v[92:93], v[84:85], v[112:113]
    v_pk_fma_f32 v[114:115], v[94:95], v[84:85], v[114:115]
    v_pk_fma_f32 v[116:117], v[96:97], v[84:85], v[116:117]
    v_pk_fma_f32 v[110:111], v[92:93], v[82:83], v[110:111]
    v_pk_fma_f32 v[112:113], v[94:95], v[82:83], v[112:113]
    v_pk_fma_f32 v[114:115], v[96:97], v[82:83], v[114:115]
    v_pk_fma_f32 v[116:117], v[98:99], v[82:83], v[116:117]
    v_pk_fma_f32 v[110:111], v[94:95], v[80:81], v[110:111]
    v_pk_fma_f32 v[112:113], v[96:97], v[80:81], v[112:113]
    v_pk_fma_f32 v[114:115], v[98:99], v[80:81], v[114:115]
    v_pk_fma_f32 v[116:117], v[100:101], v[80:81], v[116:117]
    v_pk_mul_f32 v[110:111], v[110:111], v[102:103]
    v_pk_mul_f32 v[112:113], v[112:113], v[104:105]
    v_pk_mul_f32 v[114:115], v[114:115], v[106:107]
    v_pk_mul_f32 v[116:117], v[116:117], v[108:109]
    v_cvt_pk_bf16_f32 v120, v116, v114
    v_cvt_pk_bf16_f32 v121, v112, v110
    ds_write_b64 v14, v[120:121] offset:0
    v_cvt_pk_bf16_f32 v122, v117, v115
    v_cvt_pk_bf16_f32 v123, v113, v111
    ds_write_b64 v14, v[122:123] offset:256
    v_lshlrev_b32 v80, 16, v64
    v_lshlrev_b32 v81, 16, v66
    v_and_b32 v82, s56, v64
    v_and_b32 v83, s56, v66
    v_lshlrev_b32 v84, 16, v65
    v_lshlrev_b32 v85, 16, v67
    v_and_b32 v86, s56, v65
    v_and_b32 v87, s56, v67
    v_lshlrev_b32 v88, 16, v17
    v_and_b32 v89, s56, v17
    v_lshlrev_b32 v90, 16, v21
    v_and_b32 v91, s56, v21
    v_lshlrev_b32 v92, 16, v25
    v_and_b32 v93, s56, v25
    v_lshlrev_b32 v94, 16, v29
    v_and_b32 v95, s56, v29
    v_lshlrev_b32 v96, 16, v33
    v_and_b32 v97, s56, v33
    v_lshlrev_b32 v98, 16, v37
    v_and_b32 v99, s56, v37
    v_lshlrev_b32 v100, 16, v41
    v_and_b32 v101, s56, v41
    v_lshlrev_b32 v102, 16, v45
    v_and_b32 v103, s56, v45
    v_lshlrev_b32 v104, 16, v49
    v_and_b32 v105, s56, v49
    v_lshlrev_b32 v106, 16, v53
    v_and_b32 v107, s56, v53
    v_lshlrev_b32 v108, 16, v57
    v_and_b32 v109, s56, v57
    v_pk_mul_f32 v[110:111], v[88:89], v[86:87]
    v_pk_mul_f32 v[112:113], v[90:91], v[86:87]
    v_pk_mul_f32 v[114:115], v[92:93], v[86:87]
    v_pk_mul_f32 v[116:117], v[94:95], v[86:87]
    v_pk_fma_f32 v[110:111], v[90:91], v[84:85], v[110:111]
    v_pk_fma_f32 v[112:113], v[92:93], v[84:85], v[112:113]
    v_pk_fma_f32 v[114:115], v[94:95], v[84:85], v[114:115]
    v_pk_fma_f32 v[116:117], v[96:97], v[84:85], v[116:117]
    v_pk_fma_f32 v[110:111], v[92:93], v[82:83], v[110:111]
    v_pk_fma_f32 v[112:113], v[94:95], v[82:83], v[112:113]
    v_pk_fma_f32 v[114:115], v[96:97], v[82:83], v[114:115]
    v_pk_fma_f32 v[116:117], v[98:99], v[82:83], v[116:117]
    v_pk_fma_f32 v[110:111], v[94:95], v[80:81], v[110:111]
    v_pk_fma_f32 v[112:113], v[96:97], v[80:81], v[112:113]
    v_pk_fma_f32 v[114:115], v[98:99], v[80:81], v[114:115]
    v_pk_fma_f32 v[116:117], v[100:101], v[80:81], v[116:117]
    v_pk_mul_f32 v[110:111], v[110:111], v[102:103]
    v_pk_mul_f32 v[112:113], v[112:113], v[104:105]
    v_pk_mul_f32 v[114:115], v[114:115], v[106:107]
    v_pk_mul_f32 v[116:117], v[116:117], v[108:109]
    v_cvt_pk_bf16_f32 v120, v116, v114
    v_cvt_pk_bf16_f32 v121, v112, v110
    ds_write_b64 v14, v[120:121] offset:512
    v_cvt_pk_bf16_f32 v122, v117, v115
    v_cvt_pk_bf16_f32 v123, v113, v111
    ds_write_b64 v14, v[122:123] offset:768
    v_lshlrev_b32 v80, 16, v68
    v_lshlrev_b32 v81, 16, v70
    v_and_b32 v82, s56, v68
    v_and_b32 v83, s56, v70
    v_lshlrev_b32 v84, 16, v69
    v_lshlrev_b32 v85, 16, v71
    v_and_b32 v86, s56, v69
    v_and_b32 v87, s56, v71
    v_lshlrev_b32 v88, 16, v18
    v_and_b32 v89, s56, v18
    v_lshlrev_b32 v90, 16, v22
    v_and_b32 v91, s56, v22
    v_lshlrev_b32 v92, 16, v26
    v_and_b32 v93, s56, v26
    v_lshlrev_b32 v94, 16, v30
    v_and_b32 v95, s56, v30
    v_lshlrev_b32 v96, 16, v34
    v_and_b32 v97, s56, v34
    v_lshlrev_b32 v98, 16, v38
    v_and_b32 v99, s56, v38
    v_lshlrev_b32 v100, 16, v42
    v_and_b32 v101, s56, v42
    v_lshlrev_b32 v102, 16, v46
    v_and_b32 v103, s56, v46
    v_lshlrev_b32 v104, 16, v50
    v_and_b32 v105, s56, v50
    v_lshlrev_b32 v106, 16, v54
    v_and_b32 v107, s56, v54
    v_lshlrev_b32 v108, 16, v58
    v_and_b32 v109, s56, v58
    v_pk_mul_f32 v[110:111], v[88:89], v[86:87]
    v_pk_mul_f32 v[112:113], v[90:91], v[86:87]
    v_pk_mul_f32 v[114:115], v[92:93], v[86:87]
    v_pk_mul_f32 v[116:117], v[94:95], v[86:87]
    v_pk_fma_f32 v[110:111], v[90:91], v[84:85], v[110:111]
    v_pk_fma_f32 v[112:113], v[92:93], v[84:85], v[112:113]
    v_pk_fma_f32 v[114:115], v[94:95], v[84:85], v[114:115]
    v_pk_fma_f32 v[116:117], v[96:97], v[84:85], v[116:117]
    v_pk_fma_f32 v[110:111], v[92:93], v[82:83], v[110:111]
    v_pk_fma_f32 v[112:113], v[94:95], v[82:83], v[112:113]
    v_pk_fma_f32 v[114:115], v[96:97], v[82:83], v[114:115]
    v_pk_fma_f32 v[116:117], v[98:99], v[82:83], v[116:117]
    v_pk_fma_f32 v[110:111], v[94:95], v[80:81], v[110:111]
    v_pk_fma_f32 v[112:113], v[96:97], v[80:81], v[112:113]
    v_pk_fma_f32 v[114:115], v[98:99], v[80:81], v[114:115]
    v_pk_fma_f32 v[116:117], v[100:101], v[80:81], v[116:117]
    v_pk_mul_f32 v[110:111], v[110:111], v[102:103]
    v_pk_mul_f32 v[112:113], v[112:113], v[104:105]
    v_pk_mul_f32 v[114:115], v[114:115], v[106:107]
    v_pk_mul_f32 v[116:117], v[116:117], v[108:109]
    v_cvt_pk_bf16_f32 v120, v116, v114
    v_cvt_pk_bf16_f32 v121, v112, v110
    ds_write_b64 v14, v[120:121] offset:1024
    v_cvt_pk_bf16_f32 v122, v117, v115
    v_cvt_pk_bf16_f32 v123, v113, v111
    ds_write_b64 v14, v[122:123] offset:1280
    v_lshlrev_b32 v80, 16, v72
    v_lshlrev_b32 v81, 16, v74
    v_and_b32 v82, s56, v72
    v_and_b32 v83, s56, v74
    v_lshlrev_b32 v84, 16, v73
    v_lshlrev_b32 v85, 16, v75
    v_and_b32 v86, s56, v73
    v_and_b32 v87, s56, v75
    v_lshlrev_b32 v88, 16, v19
    v_and_b32 v89, s56, v19
    v_lshlrev_b32 v90, 16, v23
    v_and_b32 v91, s56, v23
    v_lshlrev_b32 v92, 16, v27
    v_and_b32 v93, s56, v27
    v_lshlrev_b32 v94, 16, v31
    v_and_b32 v95, s56, v31
    v_lshlrev_b32 v96, 16, v35
    v_and_b32 v97, s56, v35
    v_lshlrev_b32 v98, 16, v39
    v_and_b32 v99, s56, v39
    v_lshlrev_b32 v100, 16, v43
    v_and_b32 v101, s56, v43
    v_lshlrev_b32 v102, 16, v47
    v_and_b32 v103, s56, v47
    v_lshlrev_b32 v104, 16, v51
    v_and_b32 v105, s56, v51
    v_lshlrev_b32 v106, 16, v55
    v_and_b32 v107, s56, v55
    v_lshlrev_b32 v108, 16, v59
    v_and_b32 v109, s56, v59
    v_pk_mul_f32 v[110:111], v[88:89], v[86:87]
    v_pk_mul_f32 v[112:113], v[90:91], v[86:87]
    v_pk_mul_f32 v[114:115], v[92:93], v[86:87]
    v_pk_mul_f32 v[116:117], v[94:95], v[86:87]
    v_pk_fma_f32 v[110:111], v[90:91], v[84:85], v[110:111]
    v_pk_fma_f32 v[112:113], v[92:93], v[84:85], v[112:113]
    v_pk_fma_f32 v[114:115], v[94:95], v[84:85], v[114:115]
    v_pk_fma_f32 v[116:117], v[96:97], v[84:85], v[116:117]
    v_pk_fma_f32 v[110:111], v[92:93], v[82:83], v[110:111]
    v_pk_fma_f32 v[112:113], v[94:95], v[82:83], v[112:113]
    v_pk_fma_f32 v[114:115], v[96:97], v[82:83], v[114:115]
    v_pk_fma_f32 v[116:117], v[98:99], v[82:83], v[116:117]
    v_pk_fma_f32 v[110:111], v[94:95], v[80:81], v[110:111]
    v_pk_fma_f32 v[112:113], v[96:97], v[80:81], v[112:113]
    v_pk_fma_f32 v[114:115], v[98:99], v[80:81], v[114:115]
    v_pk_fma_f32 v[116:117], v[100:101], v[80:81], v[116:117]
    v_pk_mul_f32 v[110:111], v[110:111], v[102:103]
    v_pk_mul_f32 v[112:113], v[112:113], v[104:105]
    v_pk_mul_f32 v[114:115], v[114:115], v[106:107]
    v_pk_mul_f32 v[116:117], v[116:117], v[108:109]
    v_cvt_pk_bf16_f32 v120, v116, v114
    v_cvt_pk_bf16_f32 v121, v112, v110
    ds_write_b64 v14, v[120:121] offset:1536
    v_cvt_pk_bf16_f32 v122, v117, v115
    v_cvt_pk_bf16_f32 v123, v113, v111
    ds_write_b64 v14, v[122:123] offset:1792
    v_lshrrev_b32 v16, 4, v0
    v_and_b32 v17, 15, v0
    v_lshrrev_b32 v18, 7, v0
    s_lshl_b32 s62, s61, 18
    s_lshl_b32 s63, s60, 8
    s_sub_u32 s62, s62, s63
    s_add_u32 s62, s62, 3840
    v_lshlrev_b32 v19, 12, v16
    v_lshl_add_u32 v19, v17, 4, v19
    v_add_u32 v19, s62, v19
    s_waitcnt lgkmcnt(0)
    s_barrier
    v_add_u32 v20, 0, v18
    v_xor_b32 v20, v20, v17
    v_lshlrev_b32 v20, 4, v20
    v_lshl_add_u32 v20, v16, 8, v20
    v_add_u32 v20, 120832, v20
    ds_read_b128 v[24:27], v20 offset:0
    v_add_u32 v20, 2, v18
    v_xor_b32 v20, v20, v17
    v_lshlrev_b32 v20, 4, v20
    v_lshl_add_u32 v20, v16, 8, v20
    v_add_u32 v20, 120832, v20
    ds_read_b128 v[28:31], v20 offset:4096
    v_add_u32 v20, 4, v18
    v_xor_b32 v20, v20, v17
    v_lshlrev_b32 v20, 4, v20
    v_lshl_add_u32 v20, v16, 8, v20
    v_add_u32 v20, 120832, v20
    ds_read_b128 v[32:35], v20 offset:8192
    v_add_u32 v20, 6, v18
    v_xor_b32 v20, v20, v17
    v_lshlrev_b32 v20, 4, v20
    v_lshl_add_u32 v20, v16, 8, v20
    v_add_u32 v20, 120832, v20
    ds_read_b128 v[36:39], v20 offset:12288
    v_mov_b32 v6, 0
    buffer_load_dword v15, v6, s[48:51], 0 offen sc1
    s_mov_b32 s63, 0
    s_waitcnt lgkmcnt(3)
    buffer_store_dwordx4 v[24:27], v19, s[40:43], s63 offen sc1
    s_mov_b32 s63, 65536
    s_waitcnt lgkmcnt(2)
    buffer_store_dwordx4 v[28:31], v19, s[40:43], s63 offen sc1
    s_mov_b32 s63, 131072
    s_waitcnt lgkmcnt(1)
    buffer_store_dwordx4 v[32:35], v19, s[40:43], s63 offen sc1
    s_mov_b32 s63, 196608
    s_waitcnt lgkmcnt(0)
    buffer_store_dwordx4 v[36:39], v19, s[40:43], s63 offen sc1
    s_lshl_b32 s58, s61, 7
    s_add_u32 s60, s58, 0
    v_mov_b32 v7, s60
    s_waitcnt vmcnt(0)
    s_barrier
    s_cmp_lg_u32 s30, 0
    s_cbranch_scc1 L_arr_3
    s_mov_b32 s59, 0
L_inip_5:
    v_readfirstlane_b32 s58, v15
    s_cmp_ge_u32 s58, 13
    s_cbranch_scc1 L_ini_4
    s_add_u32 s59, s59, 1
    s_cmp_gt_u32 s59, 131072
    s_cbranch_scc1 L_ini_4
    v_mov_b32 v6, 0
    buffer_load_dword v15, v6, s[48:51], 0 offen sc1
    s_waitcnt vmcnt(0)
    s_branch L_inip_5
L_ini_4:
    v_mov_b32 v6, 1
    s_mov_b64 exec, 0x1
    buffer_atomic_add v6, v7, s[52:55], 0 offen
    s_mov_b64 exec, -1
L_arr_3:
    s_add_u32 s58, s68, 0x0
    s_add_u32 s32, s28, s58
    s_addc_u32 s33, s29, 0
    s_and_b32 s33, s33, 0xffff
    s_mov_b32 s34, 4096
    s_mov_b32 s35, 0x00020000
    s_add_u32 s36, s28, 0x400000
    s_addc_u32 s37, s29, 0
    s_and_b32 s37, s37, 0xffff
    s_mov_b32 s38, 0x400000
    s_mov_b32 s39, 0x00020000
    v_and_b32 v8, 15, v2
    v_lshrrev_b32 v9, 4, v2
    v_and_b32 v3, 3, v8
    v_lshrrev_b32 v4, 2, v8
    v_mul_u32_u24 v12, 4160, v3
    v_add_u32 v13, v4, v9
    v_lshl_add_u32 v12, v13, 4, v12
    v_add_u32 v12, s67, v12
    v_and_b32 v13, 1, v8
    v_lshrrev_b32 v14, 1, v8
    v_mul_u32_u24 v15, 4576, v13
    v_lshl_add_u32 v15, v9, 4, v15
    v_lshlrev_b32 v14, 6, v14
    v_sub_u32 v15, v15, v14
    s_add_u32 s58, s67, 17088
    v_add_u32 v14, s58, v15
    v_lshlrev_b32 v15, 3, v4
    v_lshl_add_u32 v15, v3, 1, v15
    v_lshl_add_u32 v15, v9, 3, v15
    v_cmp_eq_u32 vcc, 30, v15
    s_nop 1
    v_cndmask_b32 v60, 0, v200, vcc
    v_cmp_eq_u32 vcc, 28, v15
    s_nop 1
    v_cndmask_b32 v61, 0, v200, vcc
    v_cmp_eq_u32 vcc, 26, v15
    s_nop 1
    v_cndmask_b32 v62, 0, v200, vcc
    v_cmp_eq_u32 vcc, 24, v15
    s_nop 1
    v_cndmask_b32 v63, 0, v200, vcc
    v_lshrrev_b32 v4, 4, v2
    v_mul_u32_u24 v4, 4160, v4
    v_and_b32 v5, 15, v2
    v_lshl_add_u32 v4, v5, 2, v4
    v_add_u32 v4, s67, v4
    v_mov_b32 v5, 0
    ds_write_b32 v4, v5
    s_add_u32 s58, s67, 60
    v_add_u32 v3, s58, v11
    ds_write2st64_b32 v3, v128, v129 offset0:0 offset1:1
    ds_write2st64_b32 v3, v130, v131 offset0:2 offset1:3
    ds_write2st64_b32 v3, v132, v133 offset0:4 offset1:5
    ds_write2st64_b32 v3, v134, v135 offset0:6 offset1:7
    ds_write2st64_b32 v3, v136, v137 offset0:8 offset1:9
    ds_write2st64_b32 v3, v138, v139 offset0:10 offset1:11
    ds_write2st64_b32 v3, v140, v141 offset0:12 offset1:13
    ds_write2st64_b32 v3, v142, v143 offset0:14 offset1:15
    v_add_u32 v3, 4156, v3
    ds_write2st64_b32 v3, v128, v129 offset0:0 offset1:1
    ds_write2st64_b32 v3, v130, v131 offset0:2 offset1:3
    ds_write2st64_b32 v3, v132, v133 offset0:4 offset1:5
    ds_write2st64_b32 v3, v134, v135 offset0:6 offset1:7
    ds_write2st64_b32 v3, v136, v137 offset0:8 offset1:9
    ds_write2st64_b32 v3, v138, v139 offset0:10 offset1:11
    ds_write2st64_b32 v3, v140, v141 offset0:12 offset1:13
    ds_write2st64_b32 v3, v142, v143 offset0:14 offset1:15
    v_add_u32 v3, 4156, v3
    ds_write2st64_b32 v3, v128, v129 offset0:0 offset1:1
    ds_write2st64_b32 v3, v130, v131 offset0:2 offset1:3
    ds_write2st64_b32 v3, v132, v133 offset0:4 offset1:5
    ds_write2st64_b32 v3, v134, v135 offset0:6 offset1:7
    ds_write2st64_b32 v3, v136, v137 offset0:8 offset1:9
    ds_write2st64_b32 v3, v138, v139 offset0:10 offset1:11
    ds_write2st64_b32 v3, v140, v141 offset0:12 offset1:13
    ds_write2st64_b32 v3, v142, v143 offset0:14 offset1:15
    v_add_u32 v3, 4156, v3
    ds_write2st64_b32 v3, v128, v129 offset0:0 offset1:1
    ds_write2st64_b32 v3, v130, v131 offset0:2 offset1:3
    ds_write2st64_b32 v3, v132, v133 offset0:4 offset1:5
    ds_write2st64_b32 v3, v134, v135 offset0:6 offset1:7
    ds_write2st64_b32 v3, v136, v137 offset0:8 offset1:9
    ds_write2st64_b32 v3, v138, v139 offset0:10 offset1:11
    ds_write2st64_b32 v3, v140, v141 offset0:12 offset1:13
    ds_write2st64_b32 v3, v142, v143 offset0:14 offset1:15
    s_add_u32 s58, s67, 16640
    v_add_u32 v4, s58, v10
    v_mov_b32 v56, 0
    v_mov_b32 v57, 0
    v_mov_b32 v58, 0
    v_mov_b32 v59, 0
    s_mov_b64 exec, 0xfffffff
    ds_write_b128 v4, v[56:59] offset:4096
    ds_write_b128 v4, v[56:59] offset:8672
    s_mov_b64 exec, -1
    v_add_u32 v5, 16, v10
    s_lshr_b32 s58, s65, 4
    s_lshl_b32 s58, s58, 7
    s_add_u32 s60, s58, 0
    s_cmp_lg_u32 s30, 0
    s_cbranch_scc1 L_wt0_8
    v_min_u32 v6, 0, v2
    v_lshlrev_b32 v6, 7, v6
    v_add_u32 v6, s60, v6
    s_mov_b64 exec, 0x1
    buffer_load_dword v7, v6, s[52:55], 0 offen sc1
    s_mov_b64 exec, -1
L_wt0_8:
    s_cmp_lg_u32 s30, 0
    s_cbranch_scc1 L_wt_6
    s_mov_b32 s59, 0
    s_mov_b64 exec, 0x1
L_wtp_7:
    s_waitcnt vmcnt(0)
    v_cmp_gt_u32 vcc, 16, v7
    s_add_u32 s59, s59, 1
    s_cmp_gt_u32 s59, 131072
    s_cbranch_scc1 L_wt_6x
    s_cbranch_vccz L_wt_6x
    buffer_load_dword v7, v6, s[52:55], 0 offen sc1
    s_branch L_wtp_7
L_wt_6x:
    s_mov_b64 exec, -1
L_wt_6:
    s_barrier
    buffer_load_dwordx4 v[16:19], v10, s[32:35], 0 offen offset:0
    buffer_load_dwordx4 v[24:27], v10, s[32:35], 0 offen offset:1024
    buffer_load_dwordx4 v[32:35], v10, s[32:35], 0 offen offset:2048
    buffer_load_dwordx4 v[40:43], v10, s[32:35], 0 offen offset:3072
    buffer_load_dword v20, v5, s[32:35], 0 offen offset:0
    buffer_load_dword v28, v5, s[32:35], 0 offen offset:1024
    buffer_load_dword v36, v5, s[32:35], 0 offen offset:2048
    buffer_load_dword v44, v5, s[32:35], 0 offen offset:3072
    s_waitcnt vmcnt(7)
    ds_write_b128 v4, v[16:19] offset:4576
    s_waitcnt vmcnt(6)
    ds_write_b128 v4, v[24:27] offset:5600
    s_waitcnt vmcnt(5)
    ds_write_b128 v4, v[32:35] offset:6624
    s_waitcnt vmcnt(4)
    ds_write_b128 v4, v[40:43] offset:7648
    s_waitcnt vmcnt(3)
    v_alignbit_b32 v48, v17, v16, 16
    v_alignbit_b32 v49, v18, v17, 16
    v_alignbit_b32 v50, v19, v18, 16
    v_alignbit_b32 v51, v20, v19, 16
    ds_write_b128 v4, v[48:51] offset:0
    s_waitcnt vmcnt(2)
    v_alignbit_b32 v52, v25, v24, 16
    v_alignbit_b32 v53, v26, v25, 16
    v_alignbit_b32 v54, v27, v26, 16
    v_alignbit_b32 v55, v28, v27, 16
    ds_write_b128 v4, v[52:55] offset:1024
    s_waitcnt vmcnt(1)
    v_alignbit_b32 v48, v33, v32, 16
    v_alignbit_b32 v49, v34, v33, 16
    v_alignbit_b32 v50, v35, v34, 16
    v_alignbit_b32 v51, v36, v35, 16
    ds_write_b128 v4, v[48:51] offset:2048
    s_waitcnt vmcnt(0)
    v_alignbit_b32 v52, v41, v40, 16
    v_alignbit_b32 v53, v42, v41, 16
    v_alignbit_b32 v54, v43, v42, 16
    v_alignbit_b32 v55, v44, v43, 16
    ds_write_b128 v4, v[52:55] offset:3072
    s_cmp_lt_u32 s30, 2
    s_cselect_b32 s40, s18, s20
    s_cselect_b32 s41, s19, s21
    s_and_b32 s41, s41, 0xffff
    s_mov_b32 s42, 7340032
    s_mov_b32 s43, 0x00020000
    s_lshl_b32 s58, s2, 2
    s_add_u32 s58, s58, s30
    s_mul_i32 s58, s58, 5248
    s_add_u32 s58, s58, 0x2100000
    s_add_u32 s48, s28, s58
    s_addc_u32 s49, s29, 0
    s_and_b32 s49, s49, 0xffff
    s_mov_b32 s50, 4096
    s_mov_b32 s51, 0x00020000
    s_mov_b32 s59, 0
    s_waitcnt lgkmcnt(0)
    ds_read_b128 v[96:99], v14 offset:3584
    ds_read_b128 v[64:67], v12 offset:0
    ds_read_b128 v[100:103], v14 offset:3072
    ds_read_b128 v[68:71], v12 offset:512
    ds_read_b128 v[104:107], v14 offset:2560
    ds_read_b128 v[72:75], v12 offset:1024
    ds_read_b128 v[108:111], v14 offset:2048
    ds_read_b128 v[76:79], v12 offset:1536
    ds_read_b128 v[112:115], v14 offset:1536
    ds_read_b128 v[80:83], v12 offset:2048
    ds_read_b128 v[116:119], v14 offset:1024
    ds_read_b128 v[84:87], v12 offset:2560
    ds_read_b128 v[120:123], v14 offset:512
    ds_read_b128 v[88:91], v12 offset:3072
    ds_read_b128 v[124:127], v14 offset:0
    ds_read_b128 v[92:95], v12 offset:3584
    s_waitcnt lgkmcnt(0)
    v_mfma_f32_16x16x32_bf16 v[192:195], v[60:63], v[96:99], 0
    v_mfma_f32_16x16x32_bf16 v[196:199], v[60:63], v[100:103], 0
    v_mfma_f32_16x16x32_bf16 v[200:203], v[60:63], v[104:107], 0
    v_mfma_f32_16x16x32_bf16 v[204:207], v[60:63], v[108:111], 0
    v_mfma_f32_16x16x32_bf16 v[208:211], v[60:63], v[112:115], 0
    v_mfma_f32_16x16x32_bf16 v[212:215], v[60:63], v[116:119], 0
    v_mfma_f32_16x16x32_bf16 v[216:219], v[60:63], v[120:123], 0
    v_mfma_f32_16x16x32_bf16 v[220:223], v[60:63], v[124:127], 0
    s_mov_b32 s58, 4
L_conv_9:
    s_cmp_lg_u32 s58, 3
    s_cbranch_scc1 L_noq_10
    s_mov_b32 s44, s4
    s_and_b32 s45, s5, 0xffff
    s_mov_b32 s46, 0x400000
    s_mov_b32 s47, 0x00020000
    v_lshlrev_b32 v13, 3, v2
    buffer_load_dwordx2 a[160:161], v13, s[44:47], s70 offen offset:0 nt
    buffer_load_dwordx2 a[162:163], v13, s[44:47], s70 offen offset:512 nt
    buffer_load_dwordx2 a[164:165], v13, s[44:47], s70 offen offset:1024 nt
    buffer_load_dwordx2 a[166:167], v13, s[44:47], s70 offen offset:1536 nt
    buffer_load_dwordx2 a[168:169], v13, s[44:47], s70 offen offset:2048 nt
    buffer_load_dwordx2 a[170:171], v13, s[44:47], s70 offen offset:2560 nt
    buffer_load_dwordx2 a[172:173], v13, s[44:47], s70 offen offset:3072 nt
    buffer_load_dwordx2 a[174:175], v13, s[44:47], s70 offen offset:3584 nt
L_noq_10:
    buffer_load_dword v15, v224, s[40:43], 0 offen
    v_add_u32 v224, 458752, v224
    v_mfma_f32_16x16x32_bf16 v[192:195], v[64:67], v[96:99], v[192:195]
    ds_read_b128 v[160:163], v14 offset:3648
    v_mfma_f32_16x16x32_bf16 v[196:199], v[64:67], v[100:103], v[196:199]
    v_mfma_f32_16x16x32_bf16 v[200:203], v[68:71], v[100:103], v[200:203]
    ds_read_b128 v[128:131], v12 offset:64
    v_mfma_f32_16x16x32_bf16 v[196:199], v[68:71], v[96:99], v[196:199]
    v_mfma_f32_16x16x32_bf16 v[200:203], v[64:67], v[104:107], v[200:203]
    ds_read_b128 v[164:167], v14 offset:3136
    v_mfma_f32_16x16x32_bf16 v[204:207], v[68:71], v[104:107], v[204:207]
    v_mfma_f32_16x16x32_bf16 v[208:211], v[72:75], v[104:107], v[208:211]
    ds_read_b128 v[132:135], v12 offset:576
    v_mfma_f32_16x16x32_bf16 v[200:203], v[72:75], v[96:99], v[200:203]
    v_mfma_f32_16x16x32_bf16 v[204:207], v[72:75], v[100:103], v[204:207]
    ds_read_b128 v[168:171], v14 offset:2624
    v_mfma_f32_16x16x32_bf16 v[204:207], v[64:67], v[108:111], v[204:207]
    v_mfma_f32_16x16x32_bf16 v[208:211], v[68:71], v[108:111], v[208:211]
    ds_read_b128 v[136:139], v12 offset:1088
    v_mfma_f32_16x16x32_bf16 v[212:215], v[72:75], v[108:111], v[212:215]
    v_mfma_f32_16x16x32_bf16 v[216:219], v[76:79], v[108:111], v[216:219]
    ds_read_b128 v[172:175], v14 offset:2112
    v_mfma_f32_16x16x32_bf16 v[204:207], v[76:79], v[96:99], v[204:207]
    v_mfma_f32_16x16x32_bf16 v[208:211], v[76:79], v[100:103], v[208:211]
    ds_read_b128 v[140:143], v12 offset:1600
    v_mfma_f32_16x16x32_bf16 v[212:215], v[76:79], v[104:107], v[212:215]
    v_mfma_f32_16x16x32_bf16 v[208:211], v[64:67], v[112:115], v[208:211]
    ds_read_b128 v[176:179], v14 offset:1600
    v_mfma_f32_16x16x32_bf16 v[212:215], v[68:71], v[112:115], v[212:215]
    v_mfma_f32_16x16x32_bf16 v[216:219], v[72:75], v[112:115], v[216:219]
    ds_read_b128 v[144:147], v12 offset:2112
    v_mfma_f32_16x16x32_bf16 v[220:223], v[76:79], v[112:115], v[220:223]
    v_mfma_f32_16x16x32_bf16 v[208:211], v[80:83], v[96:99], v[208:211]
    ds_read_b128 v[180:183], v14 offset:1088
    v_mfma_f32_16x16x32_bf16 v[212:215], v[80:83], v[100:103], v[212:215]
    v_mfma_f32_16x16x32_bf16 v[216:219], v[80:83], v[104:107], v[216:219]
    ds_read_b128 v[148:151], v12 offset:2624
    v_mfma_f32_16x16x32_bf16 v[220:223], v[80:83], v[108:111], v[220:223]
    v_mfma_f32_16x16x32_bf16 v[212:215], v[64:67], v[116:119], v[212:215]
    ds_read_b128 v[184:187], v14 offset:576
    v_mfma_f32_16x16x32_bf16 v[216:219], v[68:71], v[116:119], v[216:219]
    v_mfma_f32_16x16x32_bf16 v[220:223], v[72:75], v[116:119], v[220:223]
    ds_read_b128 v[152:155], v12 offset:3136
    v_mfma_f32_16x16x32_bf16 v[212:215], v[84:87], v[96:99], v[212:215]
    v_mfma_f32_16x16x32_bf16 v[216:219], v[84:87], v[100:103], v[216:219]
    ds_read_b128 v[188:191], v14 offset:64
    v_mfma_f32_16x16x32_bf16 v[220:223], v[84:87], v[104:107], v[220:223]
    v_mfma_f32_16x16x32_bf16 v[216:219], v[64:67], v[120:123], v[216:219]
    ds_read_b128 v[156:159], v12 offset:3648
    v_mfma_f32_16x16x32_bf16 v[220:223], v[68:71], v[120:123], v[220:223]
    v_mfma_f32_16x16x32_bf16 v[216:219], v[88:91], v[96:99], v[216:219]
    v_mfma_f32_16x16x32_bf16 v[220:223], v[88:91], v[100:103], v[220:223]
    buffer_store_dwordx4 a[236:239], v10, s[48:51], s59 offen sc1
    v_mfma_f32_16x16x32_bf16 v[220:223], v[64:67], v[124:127], v[220:223]
    v_mfma_f32_16x16x32_bf16 v[220:223], v[92:95], v[96:99], v[220:223]
    s_add_u32 s59, s59, 1024
    s_waitcnt lgkmcnt(0)
    buffer_load_dword v15, v224, s[40:43], 0 offen
    v_add_u32 v224, 458752, v224
    v_mfma_f32_16x16x32_bf16 v[192:195], v[128:131], v[160:163], v[192:195]
    ds_read_b128 v[96:99], v14 offset:3712
    v_mfma_f32_16x16x32_bf16 v[196:199], v[128:131], v[164:167], v[196:199]
    v_mfma_f32_16x16x32_bf16 v[200:203], v[132:135], v[164:167], v[200:203]
    ds_read_b128 v[64:67], v12 offset:128
    v_mfma_f32_16x16x32_bf16 v[196:199], v[132:135], v[160:163], v[196:199]
    v_mfma_f32_16x16x32_bf16 v[200:203], v[128:131], v[168:171], v[200:203]
    ds_read_b128 v[100:103], v14 offset:3200
    v_mfma_f32_16x16x32_bf16 v[204:207], v[132:135], v[168:171], v[204:207]
    v_mfma_f32_16x16x32_bf16 v[208:211], v[136:139], v[168:171], v[208:211]
    ds_read_b128 v[68:71], v12 offset:640
    v_mfma_f32_16x16x32_bf16 v[200:203], v[136:139], v[160:163], v[200:203]
    v_mfma_f32_16x16x32_bf16 v[204:207], v[136:139], v[164:167], v[204:207]
    ds_read_b128 v[104:107], v14 offset:2688
    v_mfma_f32_16x16x32_bf16 v[204:207], v[128:131], v[172:175], v[204:207]
    v_mfma_f32_16x16x32_bf16 v[208:211], v[132:135], v[172:175], v[208:211]
    ds_read_b128 v[72:75], v12 offset:1152
    v_mfma_f32_16x16x32_bf16 v[212:215], v[136:139], v[172:175], v[212:215]
    v_mfma_f32_16x16x32_bf16 v[216:219], v[140:143], v[172:175], v[216:219]
    ds_read_b128 v[108:111], v14 offset:2176
    v_mfma_f32_16x16x32_bf16 v[204:207], v[140:143], v[160:163], v[204:207]
    v_mfma_f32_16x16x32_bf16 v[208:211], v[140:143], v[164:167], v[208:211]
    ds_read_b128 v[76:79], v12 offset:1664
    v_mfma_f32_16x16x32_bf16 v[212:215], v[140:143], v[168:171], v[212:215]
    v_mfma_f32_16x16x32_bf16 v[208:211], v[128:131], v[176:179], v[208:211]
    ds_read_b128 v[112:115], v14 offset:1664
    v_mfma_f32_16x16x32_bf16 v[212:215], v[132:135], v[176:179], v[212:215]
    v_mfma_f32_16x16x32_bf16 v[216:219], v[136:139], v[176:179], v[216:219]
    ds_read_b128 v[80:83], v12 offset:2176
    v_mfma_f32_16x16x32_bf16 v[220:223], v[140:143], v[176:179], v[220:223]
    v_mfma_f32_16x16x32_bf16 v[208:211], v[144:147], v[160:163], v[208:211]
    ds_read_b128 v[116:119], v14 offset:1152
    v_mfma_f32_16x16x32_bf16 v[212:215], v[144:147], v[164:167], v[212:215]
    v_mfma_f32_16x16x32_bf16 v[216:219], v[144:147], v[168:171], v[216:219]
    ds_read_b128 v[84:87], v12 offset:2688
    v_mfma_f32_16x16x32_bf16 v[220:223], v[144:147], v[172:175], v[220:223]
    v_mfma_f32_16x16x32_bf16 v[212:215], v[128:131], v[180:183], v[212:215]
    ds_read_b128 v[120:123], v14 offset:640
    v_mfma_f32_16x16x32_bf16 v[216:219], v[132:135], v[180:183], v[216:219]
    v_mfma_f32_16x16x32_bf16 v[220:223], v[136:139], v[180:183], v[220:223]
    ds_read_b128 v[88:91], v12 offset:3200
    v_mfma_f32_16x16x32_bf16 v[212:215], v[148:151], v[160:163], v[212:215]
    v_mfma_f32_16x16x32_bf16 v[216:219], v[148:151], v[164:167], v[216:219]
    ds_read_b128 v[124:127], v14 offset:128
    v_mfma_f32_16x16x32_bf16 v[220:223], v[148:151], v[168:171], v[220:223]
    v_mfma_f32_16x16x32_bf16 v[216:219], v[128:131], v[184:187], v[216:219]
    ds_read_b128 v[92:95], v12 offset:3712
    v_mfma_f32_16x16x32_bf16 v[220:223], v[132:135], v[184:187], v[220:223]
    v_mfma_f32_16x16x32_bf16 v[216:219], v[152:155], v[160:163], v[216:219]
    v_mfma_f32_16x16x32_bf16 v[220:223], v[152:155], v[164:167], v[220:223]
    v_mfma_f32_16x16x32_bf16 v[220:223], v[128:131], v[188:191], v[220:223]
    v_mfma_f32_16x16x32_bf16 v[220:223], v[156:159], v[160:163], v[220:223]
    s_waitcnt lgkmcnt(0)
    v_add_u32 v12, 128, v12
    v_add_u32 v14, 128, v14
    s_sub_u32 s58, s58, 1
    s_cmp_lg_u32 s58, 0
    s_cbranch_scc1 L_conv_9
    s_nop 7
    v_cvt_pk_bf16_f32 v16, v192, v194
    v_cvt_pk_bf16_f32 v17, v193, v195
    s_nop 1
    v_mov_b32_dpp v18, v16 quad_perm:[1,0,3,2] row_mask:0xf bank_mask:0xf
    v_mov_b32_dpp v19, v17 quad_perm:[1,0,3,2] row_mask:0xf bank_mask:0xf
    v_perm_b32 v20, v18, v16, v226
    v_perm_b32 v21, v19, v17, v226
    ds_write_b32 v227, v20 offset:0
    ds_write_b32 v227, v21 offset:16
    v_cvt_pk_bf16_f32 v24, v196, v198
    v_cvt_pk_bf16_f32 v25, v197, v199
    s_nop 1
    v_mov_b32_dpp v26, v24 quad_perm:[1,0,3,2] row_mask:0xf bank_mask:0xf
    v_mov_b32_dpp v27, v25 quad_perm:[1,0,3,2] row_mask:0xf bank_mask:0xf
    v_perm_b32 v28, v26, v24, v226
    v_perm_b32 v29, v27, v25, v226
    ds_write_b32 v227, v28 offset:2176
    ds_write_b32 v227, v29 offset:2192
    v_cvt_pk_bf16_f32 v16, v200, v202
    v_cvt_pk_bf16_f32 v17, v201, v203
    s_nop 1
    v_mov_b32_dpp v18, v16 quad_perm:[1,0,3,2] row_mask:0xf bank_mask:0xf
    v_mov_b32_dpp v19, v17 quad_perm:[1,0,3,2] row_mask:0xf bank_mask:0xf
    v_perm_b32 v20, v18, v16, v226
    v_perm_b32 v21, v19, v17, v226
    ds_write_b32 v227, v20 offset:4352
    ds_write_b32 v227, v21 offset:4368
    v_cvt_pk_bf16_f32 v24, v204, v206
    v_cvt_pk_bf16_f32 v25, v205, v207
    s_nop 1
    v_mov_b32_dpp v26, v24 quad_perm:[1,0,3,2] row_mask:0xf bank_mask:0xf
    v_mov_b32_dpp v27, v25 quad_perm:[1,0,3,2] row_mask:0xf bank_mask:0xf
    v_perm_b32 v28, v26, v24, v226
    v_perm_b32 v29, v27, v25, v226
    ds_write_b32 v227, v28 offset:6528
    ds_write_b32 v227, v29 offset:6544
    v_cvt_pk_bf16_f32 v16, v208, v210
    v_cvt_pk_bf16_f32 v17, v209, v211
    s_nop 1
    v_mov_b32_dpp v18, v16 quad_perm:[1,0,3,2] row_mask:0xf bank_mask:0xf
    v_mov_b32_dpp v19, v17 quad_perm:[1,0,3,2] row_mask:0xf bank_mask:0xf
    v_perm_b32 v20, v18, v16, v226
    v_perm_b32 v21, v19, v17, v226
    ds_write_b32 v227, v20 offset:8704
    ds_write_b32 v227, v21 offset:8720
    v_cvt_pk_bf16_f32 v24, v212, v214
    v_cvt_pk_bf16_f32 v25, v213, v215
    s_nop 1
    v_mov_b32_dpp v26, v24 quad_perm:[1,0,3,2] row_mask:0xf bank_mask:0xf
    v_mov_b32_dpp v27, v25 quad_perm:[1,0,3,2] row_mask:0xf bank_mask:0xf
    v_perm_b32 v28, v26, v24, v226
    v_perm_b32 v29, v27, v25, v226
    ds_write_b32 v227, v28 offset:10880
    ds_write_b32 v227, v29 offset:10896
    v_cvt_pk_bf16_f32 v16, v216, v218
    v_cvt_pk_bf16_f32 v17, v217, v219
    s_nop 1
    v_mov_b32_dpp v18, v16 quad_perm:[1,0,3,2] row_mask:0xf bank_mask:0xf
    v_mov_b32_dpp v19, v17 quad_perm:[1,0,3,2] row_mask:0xf bank_mask:0xf
    v_perm_b32 v20, v18, v16, v226
    v_perm_b32 v21, v19, v17, v226
    ds_write_b32 v227, v20 offset:13056
    ds_write_b32 v227, v21 offset:13072
    v_cvt_pk_bf16_f32 v24, v220, v222
    v_cvt_pk_bf16_f32 v25, v221, v223
    s_nop 1
    v_mov_b32_dpp v26, v24 quad_perm:[1,0,3,2] row_mask:0xf bank_mask:0xf
    v_mov_b32_dpp v27, v25 quad_perm:[1,0,3,2] row_mask:0xf bank_mask:0xf
    v_perm_b32 v28, v26, v24, v226
    v_perm_b32 v29, v27, v25, v226
    ds_write_b32 v227, v28 offset:15232
    ds_write_b32 v227, v29 offset:15248
    s_waitcnt lgkmcnt(0)
    s_barrier
    ds_read_b128 v[16:19], v228 offset:0
    ds_read_b128 v[20:23], v228 offset:4352
    ds_read_b128 v[24:27], v228 offset:8704
    ds_read_b128 v[28:31], v228 offset:13056
    s_mov_b32 s58, 0
    s_waitcnt lgkmcnt(3)
    buffer_store_dwordx4 v[16:19], v229, s[36:39], s58 offen sc1
    s_mov_b32 s58, 1048576
    s_waitcnt lgkmcnt(2)
    buffer_store_dwordx4 v[20:23], v229, s[36:39], s58 offen sc1
    s_mov_b32 s58, 2097152
    s_waitcnt lgkmcnt(1)
    buffer_store_dwordx4 v[24:27], v229, s[36:39], s58 offen sc1
    s_mov_b32 s58, 3145728
    s_waitcnt lgkmcnt(0)
    buffer_store_dwordx4 v[28:31], v229, s[36:39], s58 offen sc1
    s_and_b32 s58, s2, 15
    s_lshl_b32 s58, s58, 7
    s_add_u32 s60, s58, 2048
    v_lshlrev_b32 v7, 11, v2
    v_add_u32 v7, s60, v7
    s_waitcnt vmcnt(0)
    s_barrier
    s_cmp_lg_u32 s30, 0
    s_cbranch_scc1 L_arr_11
    v_mov_b32 v6, 1
    s_mov_b64 exec, 0xffff
    buffer_atomic_add v6, v7, s[52:55], 0 offen
    s_mov_b64 exec, -1
L_arr_11:
    s_cmp_lt_u32 s30, 2
    s_cselect_b32 s32, s18, s20
    s_cselect_b32 s33, s19, s21
    s_and_b32 s33, s33, 0xffff
    s_mov_b32 s34, 7340032
    s_mov_b32 s35, 0x00020000
    v_accvgpr_read_b32 v8, a176
    v_accvgpr_read_b32 v9, a177
    v_accvgpr_read_b32 v10, a178
    v_accvgpr_read_b32 v11, a179
    v_accvgpr_read_b32 v12, a180
    v_accvgpr_read_b32 v13, a181
    v_accvgpr_read_b32 v14, a182
    s_mov_b32 s48, s22
    s_and_b32 s49, s23, 0xffff
    s_mov_b32 s50, 0x700000
    s_mov_b32 s51, 0x00020000
    v_mov_b32 v182, 0x3a800000
    v_accvgpr_read_b32 v3, a160
    v_lshlrev_b32 v32, 16, v3
    v_and_b32 v33, s56, v3
    s_add_u32 m0, s75, s74
    v_accvgpr_read_b32 v3, a161
    v_lshlrev_b32 v34, 16, v3
    v_and_b32 v35, s56, v3
    v_accvgpr_read_b32 v3, a162
    buffer_load_dwordx4 v8, s[32:35], s77 offen offset:0  lds
    v_lshlrev_b32 v36, 16, v3
    v_and_b32 v37, s56, v3
    v_accvgpr_read_b32 v3, a163
    v_lshlrev_b32 v38, 16, v3
    buffer_load_dwordx4 v9, s[32:35], s77 offen offset:1024  lds
    v_and_b32 v39, s56, v3
    v_accvgpr_read_b32 v3, a164
    v_lshlrev_b32 v40, 16, v3
    v_and_b32 v41, s56, v3
    buffer_load_dwordx4 v10, s[32:35], s77 offen offset:2048  lds
    v_accvgpr_read_b32 v3, a165
    v_lshlrev_b32 v42, 16, v3
    v_and_b32 v43, s56, v3
    v_accvgpr_read_b32 v3, a166
    buffer_load_dwordx4 v11, s[32:35], s77 offen offset:3072  lds
    v_lshlrev_b32 v44, 16, v3
    v_and_b32 v45, s56, v3
    v_accvgpr_read_b32 v3, a167
    v_lshlrev_b32 v46, 16, v3
    s_add_u32 m0, m0, 4096
    v_and_b32 v47, s56, v3
    v_accvgpr_read_b32 v3, a168
    v_lshlrev_b32 v48, 16, v3
    v_and_b32 v49, s56, v3
    buffer_load_dwordx4 v12, s[32:35], s77 offen offset:0  lds
    v_accvgpr_read_b32 v3, a169
    v_lshlrev_b32 v50, 16, v3
    v_and_b32 v51, s56, v3
    v_accvgpr_read_b32 v3, a170
    buffer_load_dwordx4 v13, s[32:35], s77 offen offset:1024  lds
    v_lshlrev_b32 v52, 16, v3
    v_and_b32 v53, s56, v3
    v_accvgpr_read_b32 v3, a171
    v_lshlrev_b32 v54, 16, v3
    buffer_load_dwordx4 v14, s[32:35], s77 offen offset:2048  lds
    v_and_b32 v55, s56, v3
    v_accvgpr_read_b32 v3, a172
    v_lshlrev_b32 v56, 16, v3
    v_and_b32 v57, s56, v3
    s_add_u32 s77, s77, 458752
    v_accvgpr_read_b32 v3, a173
    v_lshlrev_b32 v58, 16, v3
    v_and_b32 v59, s56, v3
    v_accvgpr_read_b32 v3, a174
    s_add_u32 s75, s75, 28672
    v_lshlrev_b32 v60, 16, v3
    v_and_b32 v61, s56, v3
    v_accvgpr_read_b32 v3, a175
    v_lshlrev_b32 v62, 16, v3
    s_add_u32 m0, s75, s74
    v_and_b32 v63, s56, v3
    v_pk_add_f32 v[160:161], v[32:33], v[34:35]
    v_pk_mul_f32 v[162:163], v[32:33], v[32:33]
    v_pk_add_f32 v[164:165], v[48:49], v[50:51]
    buffer_load_dwordx4 v8, s[32:35], s77 offen offset:0  lds
    v_pk_mul_f32 v[166:167], v[48:49], v[48:49]
    v_pk_fma_f32 v[162:163], v[34:35], v[34:35], v[162:163]
    v_pk_fma_f32 v[166:167], v[50:51], v[50:51], v[166:167]
    v_pk_add_f32 v[160:161], v[160:161], v[36:37]
    buffer_load_dwordx4 v9, s[32:35], s77 offen offset:1024  lds
    v_pk_fma_f32 v[162:163], v[36:37], v[36:37], v[162:163]
    v_pk_add_f32 v[164:165], v[164:165], v[52:53]
    v_pk_fma_f32 v[166:167], v[52:53], v[52:53], v[166:167]
    v_pk_add_f32 v[160:161], v[160:161], v[38:39]
    buffer_load_dwordx4 v10, s[32:35], s77 offen offset:2048  lds
    v_pk_fma_f32 v[162:163], v[38:39], v[38:39], v[162:163]
    v_pk_add_f32 v[164:165], v[164:165], v[54:55]
    v_pk_fma_f32 v[166:167], v[54:55], v[54:55], v[166:167]
    v_pk_add_f32 v[160:161], v[160:161], v[40:41]
    buffer_load_dwordx4 v11, s[32:35], s77 offen offset:3072  lds
    v_pk_fma_f32 v[162:163], v[40:41], v[40:41], v[162:163]
    v_pk_add_f32 v[164:165], v[164:165], v[56:57]
    v_pk_fma_f32 v[166:167], v[56:57], v[56:57], v[166:167]
    v_pk_add_f32 v[160:161], v[160:161], v[42:43]
    s_add_u32 m0, m0, 4096
    v_pk_fma_f32 v[162:163], v[42:43], v[42:43], v[162:163]
    v_pk_add_f32 v[164:165], v[164:165], v[58:59]
    v_pk_fma_f32 v[166:167], v[58:59], v[58:59], v[166:167]
    v_pk_add_f32 v[160:161], v[160:161], v[44:45]
    buffer_load_dwordx4 v12, s[32:35], s77 offen offset:0  lds
    v_pk_fma_f32 v[162:163], v[44:45], v[44:45], v[162:163]
    v_pk_add_f32 v[164:165], v[164:165], v[60:61]
    v_pk_fma_f32 v[166:167], v[60:61], v[60:61], v[166:167]
    v_pk_add_f32 v[160:161], v[160:161], v[46:47]
    buffer_load_dwordx4 v13, s[32:35], s77 offen offset:1024  lds
    v_pk_fma_f32 v[162:163], v[46:47], v[46:47], v[162:163]
    v_pk_add_f32 v[164:165], v[164:165], v[62:63]
    v_pk_fma_f32 v[166:167], v[62:63], v[62:63], v[166:167]
    v_add_f32 v160, v160, v161
    buffer_load_dwordx4 v14, s[32:35], s77 offen offset:2048  lds
    v_add_f32 v162, v162, v163
    v_add_f32 v164, v164, v165
    v_add_f32 v166, v166, v167
    s_nop 1
    s_add_u32 s77, s77, 458752
    v_add_f32_dpp v160, v160, v160 quad_perm:[1,0,3,2] row_mask:0xf bank_mask:0xf
    v_add_f32_dpp v162, v162, v162 quad_perm:[1,0,3,2] row_mask:0xf bank_mask:0xf
    v_add_f32_dpp v164, v164, v164 quad_perm:[1,0,3,2] row_mask:0xf bank_mask:0xf
    v_add_f32_dpp v166, v166, v166 quad_perm:[1,0,3,2] row_mask:0xf bank_mask:0xf
    s_add_u32 s75, s75, 28672
    v_add_f32_dpp v160, v160, v160 quad_perm:[2,3,0,1] row_mask:0xf bank_mask:0xf
    v_add_f32_dpp v162, v162, v162 quad_perm:[2,3,0,1] row_mask:0xf bank_mask:0xf
    v_add_f32_dpp v164, v164, v164 quad_perm:[2,3,0,1] row_mask:0xf bank_mask:0xf
    v_add_f32_dpp v166, v166, v166 quad_perm:[2,3,0,1] row_mask:0xf bank_mask:0xf
    s_add_u32 m0, s75, s74
    v_add_f32_dpp v160, v160, v160 row_half_mirror row_mask:0xf bank_mask:0xf
    v_add_f32_dpp v162, v162, v162 row_half_mirror row_mask:0xf bank_mask:0xf
    v_add_f32_dpp v164, v164, v164 row_half_mirror row_mask:0xf bank_mask:0xf
    v_add_f32_dpp v166, v166, v166 row_half_mirror row_mask:0xf bank_mask:0xf
    buffer_load_dwordx4 v8, s[32:35], s77 offen offset:0  lds
    v_add_f32_dpp v160, v160, v160 row_mirror row_mask:0xf bank_mask:0xf
    v_add_f32_dpp v162, v162, v162 row_mirror row_mask:0xf bank_mask:0xf
    v_add_f32_dpp v164, v164, v164 row_mirror row_mask:0xf bank_mask:0xf
    v_add_f32_dpp v166, v166, v166 row_mirror row_mask:0xf bank_mask:0xf
    buffer_load_dwordx4 v9, s[32:35], s77 offen offset:1024  lds
    v_add_f32_dpp v160, v160, v160 row_bcast:15 row_mask:0xa bank_mask:0xf
    v_add_f32_dpp v162, v162, v162 row_bcast:15 row_mask:0xa bank_mask:0xf
    v_add_f32_dpp v164, v164, v164 row_bcast:15 row_mask:0xa bank_mask:0xf
    v_add_f32_dpp v166, v166, v166 row_bcast:15 row_mask:0xa bank_mask:0xf
    buffer_load_dwordx4 v10, s[32:35], s77 offen offset:2048  lds
    v_add_f32_dpp v160, v160, v160 row_bcast:31 row_mask:0xc bank_mask:0xf
    v_add_f32_dpp v162, v162, v162 row_bcast:31 row_mask:0xc bank_mask:0xf
    v_add_f32_dpp v164, v164, v164 row_bcast:31 row_mask:0xc bank_mask:0xf
    v_add_f32_dpp v166, v166, v166 row_bcast:31 row_mask:0xc bank_mask:0xf
    buffer_load_dwordx4 v11, s[32:35], s77 offen offset:3072  lds
    s_nop 0
    v_readlane_b32 s60, v160, 63
    v_readlane_b32 s61, v162, 63
    v_readlane_b32 s62, v164, 63
    s_add_u32 m0, m0, 4096
    v_readlane_b32 s63, v166, 63
    s_nop 1
    v_mul_f32 v176, s60, v182
    v_mul_f32 v177, s62, v182
    buffer_load_dwordx4 v12, s[32:35], s77 offen offset:0  lds
    v_mul_f32 v178, s61, v182
    v_mul_f32 v179, s63, v182
    v_fma_f32 v178, -v176, v176, v178
    v_fma_f32 v179, -v177, v177, v179
    buffer_load_dwordx4 v13, s[32:35], s77 offen offset:1024  lds
    v_max_f32 v178, 0, v178
    v_max_f32 v179, 0, v179
    v_cvt_pk_bf16_f32 v180, v176, v177
    v_cvt_pk_bf16_f32 v181, v178, v179
    buffer_load_dwordx4 v14, s[32:35], s77 offen offset:2048  lds
    v_lshlrev_b32 v176, 16, v180
    v_and_b32 v177, s56, v180
    v_lshlrev_b32 v178, 16, v181
    v_and_b32 v179, s56, v181
    s_add_u32 s77, s77, 458752
    v_add_f32 v178, s57, v178
    v_add_f32 v179, s57, v179
    v_cvt_pk_bf16_f32 v181, v178, v179
    v_lshlrev_b32 v178, 16, v181
    s_add_u32 s75, s75, 28672
    v_and_b32 v179, s56, v181
    v_sqrt_f32 v178, v178
    v_sqrt_f32 v179, v179
    s_nop 0
    v_cvt_pk_bf16_f32 v181, v178, v179
    v_lshlrev_b32 v178, 16, v181
    v_and_b32 v179, s56, v181
    v_rcp_f32 v168, v178
    v_rcp_f32 v172, v179
    s_nop 0
    v_mul_f32 v170, v176, v168
    v_mul_f32 v174, v177, v172
    v_sub_f32 v170, 0, v170
    v_sub_f32 v174, 0, v174
    v_pk_fma_f32 v[64:65], v[32:33], v[168:169], v[170:171] op_sel_hi:[1,0,0]
    v_pk_fma_f32 v[66:67], v[34:35], v[168:169], v[170:171] op_sel_hi:[1,0,0]
    v_pk_fma_f32 v[68:69], v[36:37], v[168:169], v[170:171] op_sel_hi:[1,0,0]
    v_pk_fma_f32 v[70:71], v[38:39], v[168:169], v[170:171] op_sel_hi:[1,0,0]
    v_pk_fma_f32 v[72:73], v[40:41], v[168:169], v[170:171] op_sel_hi:[1,0,0]
    v_pk_fma_f32 v[74:75], v[42:43], v[168:169], v[170:171] op_sel_hi:[1,0,0]
    v_pk_fma_f32 v[76:77], v[44:45], v[168:169], v[170:171] op_sel_hi:[1,0,0]
    v_pk_fma_f32 v[78:79], v[46:47], v[168:169], v[170:171] op_sel_hi:[1,0,0]
    v_pk_fma_f32 v[80:81], v[48:49], v[172:173], v[174:175] op_sel_hi:[1,0,0]
    v_pk_fma_f32 v[82:83], v[50:51], v[172:173], v[174:175] op_sel_hi:[1,0,0]
    v_pk_fma_f32 v[84:85], v[52:53], v[172:173], v[174:175] op_sel_hi:[1,0,0]
    v_pk_fma_f32 v[86:87], v[54:55], v[172:173], v[174:175] op_sel_hi:[1,0,0]
    v_pk_fma_f32 v[88:89], v[56:57], v[172:173], v[174:175] op_sel_hi:[1,0,0]
    v_pk_fma_f32 v[90:91], v[58:59], v[172:173], v[174:175] op_sel_hi:[1,0,0]
    v_pk_fma_f32 v[92:93], v[60:61], v[172:173], v[174:175] op_sel_hi:[1,0,0]
    v_pk_fma_f32 v[94:95], v[62:63], v[172:173], v[174:175] op_sel_hi:[1,0,0]
    s_add_u32 s36, s28, 0x400000
    s_addc_u32 s37, s29, 0
    s_and_b32 s37, s37, 0xffff
    s_mov_b32 s38, 0x400000
    s_mov_b32 s39, 0x00020000
    s_add_u32 s40, s28, 0x800000
    s_addc_u32 s41, s29, 0
    s_and_b32 s41, s41, 0xffff
    s_mov_b32 s42, 0x400000
    s_mov_b32 s43, 0x00020000
    s_add_u32 s44, s28, 0xc00000
    s_addc_u32 s45, s29, 0
    s_and_b32 s45, s45, 0xffff
    s_mov_b32 s46, 0x400000
    s_mov_b32 s47, 0x00020000
    v_lshlrev_b32 v24, 4, v2
    v_accvgpr_read_b32 v4, a200
    v_accvgpr_read_b32 v5, a201
    v_accvgpr_read_b32 v16, a202
    v_accvgpr_read_b32 v17, a203
    v_accvgpr_read_b32 v18, a240
    s_lshl_b32 s61, s30, 12
    s_lshl_b32 s62, s2, 14
    s_add_u32 s62, s62, s61
    s_add_u32 s61, s61, 120832
    s_and_b32 s60, s2, 15
    s_lshl_b32 s60, s60, 11
    s_add_u32 s60, s60, 2048
    s_cmp_lg_u32 s30, 0
    s_cbranch_scc1 L_wt0_1014
    v_min_u32 v6, 15, v2
    v_lshlrev_b32 v6, 7, v6
    v_add_u32 v6, s60, v6
    s_mov_b64 exec, 0xffff
    buffer_load_dword v7, v6, s[52:55], 0 offen sc1
    s_mov_b64 exec, -1
L_wt0_1014:
    s_cmp_lg_u32 s30, 0
    s_cbranch_scc1 L_wt_1012
    s_mov_b32 s59, 0
    s_mov_b64 exec, 0xffff
L_wtp_1013:
    s_waitcnt vmcnt(0)
    v_cmp_gt_u32 vcc, 16, v7
    s_add_u32 s59, s59, 1
    s_cmp_gt_u32 s59, 131072
    s_cbranch_scc1 L_wt_1012x
    s_cbranch_vccz L_wt_1012x
    buffer_load_dword v7, v6, s[52:55], 0 offen sc1
    s_branch L_wtp_1013
L_wt_1012x:
    s_mov_b64 exec, -1
L_wt_1012:
    s_barrier
    s_mov_b32 m0, s61
    s_nop 0
    buffer_load_dwordx4 v24, s[36:39], s62 offen offset:0 lds
    buffer_load_dwordx4 v24, s[36:39], s62 offen offset:1024 lds
    buffer_load_dwordx4 v24, s[36:39], s62 offen offset:2048 lds
    buffer_load_dwordx4 v24, s[36:39], s62 offen offset:3072 lds
    s_waitcnt vmcnt(0)
    s_barrier
    ds_read_b128 v[128:131], v5 offset:0
    ds_read_b128 v[132:135], v5 offset:4096
    ds_read_b128 v[136:139], v5 offset:8192
    ds_read_b128 v[140:143], v5 offset:12288
    s_waitcnt lgkmcnt(3)
    v_lshlrev_b32 v96, 16, v128
    v_and_b32 v112, s56, v128
    v_lshlrev_b32 v97, 16, v129
    v_and_b32 v113, s56, v129
    v_lshlrev_b32 v98, 16, v130
    v_and_b32 v114, s56, v130
    v_lshlrev_b32 v99, 16, v131
    v_and_b32 v115, s56, v131
    s_waitcnt lgkmcnt(2)
    v_lshlrev_b32 v100, 16, v132
    v_and_b32 v116, s56, v132
    v_lshlrev_b32 v101, 16, v133
    v_and_b32 v117, s56, v133
    v_lshlrev_b32 v102, 16, v134
    v_and_b32 v118, s56, v134
    v_lshlrev_b32 v103, 16, v135
    v_and_b32 v119, s56, v135
    s_waitcnt lgkmcnt(1)
    v_lshlrev_b32 v104, 16, v136
    v_and_b32 v120, s56, v136
    v_lshlrev_b32 v105, 16, v137
    v_and_b32 v121, s56, v137
    v_lshlrev_b32 v106, 16, v138
    v_and_b32 v122, s56, v138
    v_lshlrev_b32 v107, 16, v139
    v_and_b32 v123, s56, v139
    s_waitcnt lgkmcnt(0)
    v_lshlrev_b32 v108, 16, v140
    v_and_b32 v124, s56, v140
    v_lshlrev_b32 v109, 16, v141
    v_and_b32 v125, s56, v141
    v_lshlrev_b32 v110, 16, v142
    v_and_b32 v126, s56, v142
    v_lshlrev_b32 v111, 16, v143
    v_and_b32 v127, s56, v143
    v_pk_fma_f32 v[64:65], v[64:65], v[96:97], v[32:33]
    v_cvt_pk_bf16_f32 v144, v64, v65
    v_pk_fma_f32 v[66:67], v[66:67], v[98:99], v[34:35]
    v_cvt_pk_bf16_f32 v145, v66, v67
    v_pk_fma_f32 v[68:69], v[68:69], v[100:101], v[36:37]
    v_cvt_pk_bf16_f32 v146, v68, v69
    v_pk_fma_f32 v[70:71], v[70:71], v[102:103], v[38:39]
    v_cvt_pk_bf16_f32 v147, v70, v71
    v_pk_fma_f32 v[72:73], v[72:73], v[104:105], v[40:41]
    v_cvt_pk_bf16_f32 v148, v72, v73
    v_pk_fma_f32 v[74:75], v[74:75], v[106:107], v[42:43]
    v_cvt_pk_bf16_f32 v149, v74, v75
    v_pk_fma_f32 v[76:77], v[76:77], v[108:109], v[44:45]
    v_cvt_pk_bf16_f32 v150, v76, v77
    v_pk_fma_f32 v[78:79], v[78:79], v[110:111], v[46:47]
    v_cvt_pk_bf16_f32 v151, v78, v79
    v_pk_fma_f32 v[80:81], v[80:81], v[112:113], v[48:49]
    v_cvt_pk_bf16_f32 v152, v80, v81
    v_pk_fma_f32 v[82:83], v[82:83], v[114:115], v[50:51]
    v_cvt_pk_bf16_f32 v153, v82, v83
    v_pk_fma_f32 v[84:85], v[84:85], v[116:117], v[52:53]
    v_cvt_pk_bf16_f32 v154, v84, v85
    v_pk_fma_f32 v[86:87], v[86:87], v[118:119], v[54:55]
    v_cvt_pk_bf16_f32 v155, v86, v87
    v_pk_fma_f32 v[88:89], v[88:89], v[120:121], v[56:57]
    v_cvt_pk_bf16_f32 v156, v88, v89
    v_pk_fma_f32 v[90:91], v[90:91], v[122:123], v[58:59]
    v_cvt_pk_bf16_f32 v157, v90, v91
    v_pk_fma_f32 v[92:93], v[92:93], v[124:125], v[60:61]
    v_cvt_pk_bf16_f32 v158, v92, v93
    v_pk_fma_f32 v[94:95], v[94:95], v[126:127], v[62:63]
    v_cvt_pk_bf16_f32 v159, v94, v95
    s_mov_b32 vcc_lo, 0x55555555
    s_mov_b32 vcc_hi, 0x55555555
    s_nop 1
    v_cndmask_b32_dpp v184, v152, v144, vcc quad_perm:[1,0,3,2] row_mask:0xf bank_mask:0xf
    v_cndmask_b32_dpp v185, v153, v145, vcc quad_perm:[1,0,3,2] row_mask:0xf bank_mask:0xf
    v_cndmask_b32_dpp v188, v154, v146, vcc quad_perm:[1,0,3,2] row_mask:0xf bank_mask:0xf
    v_cndmask_b32_dpp v189, v155, v147, vcc quad_perm:[1,0,3,2] row_mask:0xf bank_mask:0xf
    v_cndmask_b32_dpp v192, v156, v148, vcc quad_perm:[1,0,3,2] row_mask:0xf bank_mask:0xf
    v_cndmask_b32_dpp v193, v157, v149, vcc quad_perm:[1,0,3,2] row_mask:0xf bank_mask:0xf
    v_cndmask_b32_dpp v196, v158, v150, vcc quad_perm:[1,0,3,2] row_mask:0xf bank_mask:0xf
    v_cndmask_b32_dpp v197, v159, v151, vcc quad_perm:[1,0,3,2] row_mask:0xf bank_mask:0xf
    s_mov_b32 vcc_lo, 0xaaaaaaaa
    s_mov_b32 vcc_hi, 0xaaaaaaaa
    s_nop 1
    v_cndmask_b32_dpp v186, v144, v152, vcc quad_perm:[1,0,3,2] row_mask:0xf bank_mask:0xf
    v_cndmask_b32_dpp v187, v145, v153, vcc quad_perm:[1,0,3,2] row_mask:0xf bank_mask:0xf
    v_cndmask_b32_dpp v190, v146, v154, vcc quad_perm:[1,0,3,2] row_mask:0xf bank_mask:0xf
    v_cndmask_b32_dpp v191, v147, v155, vcc quad_perm:[1,0,3,2] row_mask:0xf bank_mask:0xf
    v_cndmask_b32_dpp v194, v148, v156, vcc quad_perm:[1,0,3,2] row_mask:0xf bank_mask:0xf
    v_cndmask_b32_dpp v195, v149, v157, vcc quad_perm:[1,0,3,2] row_mask:0xf bank_mask:0xf
    v_cndmask_b32_dpp v198, v150, v158, vcc quad_perm:[1,0,3,2] row_mask:0xf bank_mask:0xf
    v_cndmask_b32_dpp v199, v151, v159, vcc quad_perm:[1,0,3,2] row_mask:0xf bank_mask:0xf
    buffer_store_dwordx4 v[184:187], v4, s[40:43], s70 offen offset:0 sc1
    buffer_store_dwordx4 v[188:191], v4, s[40:43], s70 offen offset:512 sc1
    buffer_store_dwordx4 v[192:195], v4, s[40:43], s70 offen offset:1024 sc1
    buffer_store_dwordx4 v[196:199], v4, s[40:43], s70 offen offset:1536 sc1
    v_lshlrev_b32 v32, 16, v144
    v_and_b32 v33, s56, v144
    v_lshlrev_b32 v34, 16, v145
    v_and_b32 v35, s56, v145
    v_lshlrev_b32 v36, 16, v146
    v_and_b32 v37, s56, v146
    v_lshlrev_b32 v38, 16, v147
    v_and_b32 v39, s56, v147
    v_lshlrev_b32 v40, 16, v148
    v_and_b32 v41, s56, v148
    v_lshlrev_b32 v42, 16, v149
    v_and_b32 v43, s56, v149
    v_lshlrev_b32 v44, 16, v150
    v_and_b32 v45, s56, v150
    v_lshlrev_b32 v46, 16, v151
    v_and_b32 v47, s56, v151
    v_lshlrev_b32 v48, 16, v152
    v_and_b32 v49, s56, v152
    v_lshlrev_b32 v50, 16, v153
    v_and_b32 v51, s56, v153
    v_lshlrev_b32 v52, 16, v154
    v_and_b32 v53, s56, v154
    v_lshlrev_b32 v54, 16, v155
    v_and_b32 v55, s56, v155
    v_lshlrev_b32 v56, 16, v156
    v_and_b32 v57, s56, v156
    v_lshlrev_b32 v58, 16, v157
    v_and_b32 v59, s56, v157
    v_lshlrev_b32 v60, 16, v158
    v_and_b32 v61, s56, v158
    v_lshlrev_b32 v62, 16, v159
    v_and_b32 v63, s56, v159
    v_pk_add_f32 v[160:161], v[32:33], v[34:35]
    v_pk_mul_f32 v[162:163], v[32:33], v[32:33]
    v_pk_add_f32 v[164:165], v[48:49], v[50:51]
    v_pk_mul_f32 v[166:167], v[48:49], v[48:49]
    v_pk_fma_f32 v[162:163], v[34:35], v[34:35], v[162:163]
    v_pk_fma_f32 v[166:167], v[50:51], v[50:51], v[166:167]
    v_pk_add_f32 v[160:161], v[160:161], v[36:37]
    v_pk_fma_f32 v[162:163], v[36:37], v[36:37], v[162:163]
    v_pk_add_f32 v[164:165], v[164:165], v[52:53]
    v_pk_fma_f32 v[166:167], v[52:53], v[52:53], v[166:167]
    v_pk_add_f32 v[160:161], v[160:161], v[38:39]
    v_pk_fma_f32 v[162:163], v[38:39], v[38:39], v[162:163]
    v_pk_add_f32 v[164:165], v[164:165], v[54:55]
    v_pk_fma_f32 v[166:167], v[54:55], v[54:55], v[166:167]
    v_pk_add_f32 v[160:161], v[160:161], v[40:41]
    v_pk_fma_f32 v[162:163], v[40:41], v[40:41], v[162:163]
    v_pk_add_f32 v[164:165], v[164:165], v[56:57]
    v_pk_fma_f32 v[166:167], v[56:57], v[56:57], v[166:167]
    v_pk_add_f32 v[160:161], v[160:161], v[42:43]
    v_pk_fma_f32 v[162:163], v[42:43], v[42:43], v[162:163]
    v_pk_add_f32 v[164:165], v[164:165], v[58:59]
    v_pk_fma_f32 v[166:167], v[58:59], v[58:59], v[166:167]
    v_pk_add_f32 v[160:161], v[160:161], v[44:45]
    v_pk_fma_f32 v[162:163], v[44:45], v[44:45], v[162:163]
    v_pk_add_f32 v[164:165], v[164:165], v[60:61]
    v_pk_fma_f32 v[166:167], v[60:61], v[60:61], v[166:167]
    v_pk_add_f32 v[160:161], v[160:161], v[46:47]
    v_pk_fma_f32 v[162:163], v[46:47], v[46:47], v[162:163]
    v_pk_add_f32 v[164:165], v[164:165], v[62:63]
    v_pk_fma_f32 v[166:167], v[62:63], v[62:63], v[166:167]
    v_add_f32 v160, v160, v161
    v_add_f32 v162, v162, v163
    v_add_f32 v164, v164, v165
    v_add_f32 v166, v166, v167
    s_nop 1
    v_add_f32_dpp v160, v160, v160 quad_perm:[1,0,3,2] row_mask:0xf bank_mask:0xf
    v_add_f32_dpp v162, v162, v162 quad_perm:[1,0,3,2] row_mask:0xf bank_mask:0xf
    v_add_f32_dpp v164, v164, v164 quad_perm:[1,0,3,2] row_mask:0xf bank_mask:0xf
    v_add_f32_dpp v166, v166, v166 quad_perm:[1,0,3,2] row_mask:0xf bank_mask:0xf
    v_add_f32_dpp v160, v160, v160 quad_perm:[2,3,0,1] row_mask:0xf bank_mask:0xf
    v_add_f32_dpp v162, v162, v162 quad_perm:[2,3,0,1] row_mask:0xf bank_mask:0xf
    v_add_f32_dpp v164, v164, v164 quad_perm:[2,3,0,1] row_mask:0xf bank_mask:0xf
    v_add_f32_dpp v166, v166, v166 quad_perm:[2,3,0,1] row_mask:0xf bank_mask:0xf
    v_add_f32_dpp v160, v160, v160 row_half_mirror row_mask:0xf bank_mask:0xf
    v_add_f32_dpp v162, v162, v162 row_half_mirror row_mask:0xf bank_mask:0xf
    v_add_f32_dpp v164, v164, v164 row_half_mirror row_mask:0xf bank_mask:0xf
    v_add_f32_dpp v166, v166, v166 row_half_mirror row_mask:0xf bank_mask:0xf
    v_add_f32_dpp v160, v160, v160 row_mirror row_mask:0xf bank_mask:0xf
    v_add_f32_dpp v162, v162, v162 row_mirror row_mask:0xf bank_mask:0xf
    v_add_f32_dpp v164, v164, v164 row_mirror row_mask:0xf bank_mask:0xf
    v_add_f32_dpp v166, v166, v166 row_mirror row_mask:0xf bank_mask:0xf
    v_add_f32_dpp v160, v160, v160 row_bcast:15 row_mask:0xa bank_mask:0xf
    v_add_f32_dpp v162, v162, v162 row_bcast:15 row_mask:0xa bank_mask:0xf
    v_add_f32_dpp v164, v164, v164 row_bcast:15 row_mask:0xa bank_mask:0xf
    v_add_f32_dpp v166, v166, v166 row_bcast:15 row_mask:0xa bank_mask:0xf
    v_add_f32_dpp v160, v160, v160 row_bcast:31 row_mask:0xc bank_mask:0xf
    v_add_f32_dpp v162, v162, v162 row_bcast:31 row_mask:0xc bank_mask:0xf
    v_add_f32_dpp v164, v164, v164 row_bcast:31 row_mask:0xc bank_mask:0xf
    v_add_f32_dpp v166, v166, v166 row_bcast:31 row_mask:0xc bank_mask:0xf
    s_nop 0
    v_readlane_b32 s60, v160, 63
    v_readlane_b32 s61, v162, 63
    v_readlane_b32 s62, v164, 63
    v_readlane_b32 s63, v166, 63
    s_nop 1
    v_mul_f32 v176, s60, v182
    v_mul_f32 v177, s62, v182
    v_mul_f32 v178, s61, v182
    v_mul_f32 v179, s63, v182
    v_fma_f32 v178, -v176, v176, v178
    v_fma_f32 v179, -v177, v177, v179
    v_max_f32 v178, 0, v178
    v_max_f32 v179, 0, v179
    v_cvt_pk_bf16_f32 v180, v176, v177
    v_cvt_pk_bf16_f32 v181, v178, v179
    v_lshlrev_b32 v176, 16, v180
    v_and_b32 v177, s56, v180
    v_lshlrev_b32 v178, 16, v181
    v_and_b32 v179, s56, v181
    v_add_f32 v178, s57, v178
    v_add_f32 v179, s57, v179
    v_cvt_pk_bf16_f32 v181, v178, v179
    v_lshlrev_b32 v178, 16, v181
    v_and_b32 v179, s56, v181
    v_sqrt_f32 v178, v178
    v_sqrt_f32 v179, v179
    s_nop 0
    v_cvt_pk_bf16_f32 v181, v178, v179
    v_lshlrev_b32 v178, 16, v181
    v_and_b32 v179, s56, v181
    v_rcp_f32 v168, v178
    v_rcp_f32 v172, v179
    s_nop 0
    v_mul_f32 v170, v176, v168
    v_mul_f32 v174, v177, v172
    v_sub_f32 v170, 0, v170
    v_sub_f32 v174, 0, v174
    v_pk_fma_f32 v[160:161], v[32:33], v[168:169], v[170:171] op_sel_hi:[1,0,0]
    v_cvt_pk_bf16_f32 v128, v160, v161
    v_pk_fma_f32 v[160:161], v[34:35], v[168:169], v[170:171] op_sel_hi:[1,0,0]
    v_cvt_pk_bf16_f32 v129, v160, v161
    v_pk_fma_f32 v[160:161], v[36:37], v[168:169], v[170:171] op_sel_hi:[1,0,0]
    v_cvt_pk_bf16_f32 v130, v160, v161
    v_pk_fma_f32 v[160:161], v[38:39], v[168:169], v[170:171] op_sel_hi:[1,0,0]
    v_cvt_pk_bf16_f32 v131, v160, v161
    v_pk_fma_f32 v[160:161], v[40:41], v[168:169], v[170:171] op_sel_hi:[1,0,0]
    v_cvt_pk_bf16_f32 v132, v160, v161
    v_pk_fma_f32 v[160:161], v[42:43], v[168:169], v[170:171] op_sel_hi:[1,0,0]
    v_cvt_pk_bf16_f32 v133, v160, v161
    v_pk_fma_f32 v[160:161], v[44:45], v[168:169], v[170:171] op_sel_hi:[1,0,0]
    v_cvt_pk_bf16_f32 v134, v160, v161
    v_pk_fma_f32 v[160:161], v[46:47], v[168:169], v[170:171] op_sel_hi:[1,0,0]
    v_cvt_pk_bf16_f32 v135, v160, v161
    v_pk_fma_f32 v[160:161], v[48:49], v[172:173], v[174:175] op_sel_hi:[1,0,0]
    v_cvt_pk_bf16_f32 v136, v160, v161
    v_pk_fma_f32 v[160:161], v[50:51], v[172:173], v[174:175] op_sel_hi:[1,0,0]
    v_cvt_pk_bf16_f32 v137, v160, v161
    v_pk_fma_f32 v[160:161], v[52:53], v[172:173], v[174:175] op_sel_hi:[1,0,0]
    v_cvt_pk_bf16_f32 v138, v160, v161
    v_pk_fma_f32 v[160:161], v[54:55], v[172:173], v[174:175] op_sel_hi:[1,0,0]
    v_cvt_pk_bf16_f32 v139, v160, v161
    v_pk_fma_f32 v[160:161], v[56:57], v[172:173], v[174:175] op_sel_hi:[1,0,0]
    v_cvt_pk_bf16_f32 v140, v160, v161
    v_pk_fma_f32 v[160:161], v[58:59], v[172:173], v[174:175] op_sel_hi:[1,0,0]
    v_cvt_pk_bf16_f32 v141, v160, v161
    v_pk_fma_f32 v[160:161], v[60:61], v[172:173], v[174:175] op_sel_hi:[1,0,0]
    v_cvt_pk_bf16_f32 v142, v160, v161
    v_pk_fma_f32 v[160:161], v[62:63], v[172:173], v[174:175] op_sel_hi:[1,0,0]
    v_cvt_pk_bf16_f32 v143, v160, v161
    s_mov_b32 vcc_lo, 0x55555555
    s_mov_b32 vcc_hi, 0x55555555
    s_nop 1
    v_cndmask_b32_dpp v96, v136, v128, vcc quad_perm:[1,0,3,2] row_mask:0xf bank_mask:0xf
    v_cndmask_b32_dpp v97, v137, v129, vcc quad_perm:[1,0,3,2] row_mask:0xf bank_mask:0xf
    v_cndmask_b32_dpp v100, v138, v130, vcc quad_perm:[1,0,3,2] row_mask:0xf bank_mask:0xf
    v_cndmask_b32_dpp v101, v139, v131, vcc quad_perm:[1,0,3,2] row_mask:0xf bank_mask:0xf
    v_cndmask_b32_dpp v104, v140, v132, vcc quad_perm:[1,0,3,2] row_mask:0xf bank_mask:0xf
    v_cndmask_b32_dpp v105, v141, v133, vcc quad_perm:[1,0,3,2] row_mask:0xf bank_mask:0xf
    v_cndmask_b32_dpp v108, v142, v134, vcc quad_perm:[1,0,3,2] row_mask:0xf bank_mask:0xf
    v_cndmask_b32_dpp v109, v143, v135, vcc quad_perm:[1,0,3,2] row_mask:0xf bank_mask:0xf
    s_mov_b32 vcc_lo, 0xaaaaaaaa
    s_mov_b32 vcc_hi, 0xaaaaaaaa
    s_nop 1
    v_cndmask_b32_dpp v98, v128, v136, vcc quad_perm:[1,0,3,2] row_mask:0xf bank_mask:0xf
    v_cndmask_b32_dpp v99, v129, v137, vcc quad_perm:[1,0,3,2] row_mask:0xf bank_mask:0xf
    v_cndmask_b32_dpp v102, v130, v138, vcc quad_perm:[1,0,3,2] row_mask:0xf bank_mask:0xf
    v_cndmask_b32_dpp v103, v131, v139, vcc quad_perm:[1,0,3,2] row_mask:0xf bank_mask:0xf
    v_cndmask_b32_dpp v106, v132, v140, vcc quad_perm:[1,0,3,2] row_mask:0xf bank_mask:0xf
    v_cndmask_b32_dpp v107, v133, v141, vcc quad_perm:[1,0,3,2] row_mask:0xf bank_mask:0xf
    v_cndmask_b32_dpp v110, v134, v142, vcc quad_perm:[1,0,3,2] row_mask:0xf bank_mask:0xf
    v_cndmask_b32_dpp v111, v135, v143, vcc quad_perm:[1,0,3,2] row_mask:0xf bank_mask:0xf
    ds_write_b128 v16, v[96:99] offset:0
    ds_write_b128 v16, v[100:103] offset:4096
    ds_write_b128 v16, v[104:107] offset:8192
    ds_write_b128 v16, v[108:111] offset:12288
    s_lshr_b32 s58, s2, 1
    s_lshl_b32 s58, s58, 15
    s_and_b32 s59, s2, 1
    s_lshl_b32 s59, s59, 7
    s_add_u32 s58, s58, s59
    s_waitcnt lgkmcnt(0)
    s_barrier
    ds_read_b128 v[128:131], v17 offset:0
    ds_read_b128 v[132:135], v17 offset:4096
    ds_read_b128 v[136:139], v17 offset:8192
    ds_read_b128 v[140:143], v17 offset:12288
    s_add_u32 s59, s58, 0
    s_waitcnt lgkmcnt(3)
    buffer_store_dwordx4 v[128:131], v18, s[44:47], s59 offen sc1
    s_add_u32 s59, s58, 8192
    s_waitcnt lgkmcnt(2)
    buffer_store_dwordx4 v[132:135], v18, s[44:47], s59 offen sc1
    s_add_u32 s59, s58, 16384
    s_waitcnt lgkmcnt(1)
    buffer_store_dwordx4 v[136:139], v18, s[44:47], s59 offen sc1
    s_add_u32 s59, s58, 24576
    s_waitcnt lgkmcnt(0)
    buffer_store_dwordx4 v[140:143], v18, s[44:47], s59 offen sc1
    v_accvgpr_read_b32 v20, a183
    v_accvgpr_read_b32 v15, a184
    v_accvgpr_read_b32 v30, a199
    v_accvgpr_read_b32 v31, a198
    v_add_u32 v21, 32768, v20
    v_add_u32 v22, 65536, v20
    v_add_u32 v23, 98304, v20
    s_lshr_b32 s58, s2, 5
    s_lshl_b32 s58, s58, 4
    s_and_b32 s59, s2, 1
    s_add_u32 s58, s58, s59
    s_lshl_b32 s58, s58, 7
    s_add_u32 s60, s58, 34816
    v_lshlrev_b32 v7, 8, v2
    v_add_u32 v7, s60, v7
    s_waitcnt vmcnt(0)
    s_barrier
    s_cmp_lg_u32 s30, 0
    s_cbranch_scc1 L_arr_1015
    v_mov_b32 v6, 1
    s_mov_b64 exec, 0xff
    buffer_atomic_add v6, v7, s[52:55], 0 offen
    s_mov_b64 exec, -1
L_arr_1015:
    s_mov_b32 s40, s32
    s_mov_b32 s41, s33
    s_mov_b32 s42, s34
    s_mov_b32 s43, s35
    s_mov_b32 s42, 0
    s_mov_b32 s50, 0
    s_add_u32 s36, s28, 0x1000000
    s_addc_u32 s37, s29, 0
    s_and_b32 s37, s37, 0xffff
    s_mov_b32 s38, 0xe00000
    s_mov_b32 s39, 0x00020000
    s_lshl_b32 s58, s83, 4
    s_lshl_b32 s59, s31, 1
    s_add_u32 s58, s58, s59
    s_lshl_b32 s58, s58, 7
    s_add_u32 s60, s58, 34816
    s_cmp_lg_u32 s30, 0
    s_cbranch_scc1 L_wt0_1018
    v_min_u32 v6, 1, v2
    v_lshlrev_b32 v6, 7, v6
    v_add_u32 v6, s60, v6
    s_mov_b64 exec, 0x3
    buffer_load_dword v7, v6, s[52:55], 0 offen sc1
    s_mov_b64 exec, -1
L_wt0_1018:
    v_accvgpr_read_b32 v25, a187
    v_accvgpr_read_b32 v26, a188
    v_accvgpr_read_b32 v27, a189
    v_accvgpr_read_b32 v28, a190
    v_accvgpr_read_b32 v29, a191
    v_pk_mov_b32 v[32:33], 0, 0
    v_pk_mov_b32 v[34:35], 0, 0
    v_pk_mov_b32 v[36:37], 0, 0
    v_pk_mov_b32 v[38:39], 0, 0
    v_pk_mov_b32 v[40:41], 0, 0
    v_pk_mov_b32 v[42:43], 0, 0
    v_pk_mov_b32 v[44:45], 0, 0
    v_pk_mov_b32 v[46:47], 0, 0
    v_pk_mov_b32 v[48:49], 0, 0
    v_pk_mov_b32 v[50:51], 0, 0
    v_pk_mov_b32 v[52:53], 0, 0
    v_pk_mov_b32 v[54:55], 0, 0
    v_pk_mov_b32 v[56:57], 0, 0
    v_pk_mov_b32 v[58:59], 0, 0
    v_pk_mov_b32 v[60:61], 0, 0
    v_pk_mov_b32 v[62:63], 0, 0
    v_pk_mov_b32 v[64:65], 0, 0
    v_pk_mov_b32 v[66:67], 0, 0
    v_pk_mov_b32 v[68:69], 0, 0
    v_pk_mov_b32 v[70:71], 0, 0
    v_pk_mov_b32 v[72:73], 0, 0
    v_pk_mov_b32 v[74:75], 0, 0
    v_pk_mov_b32 v[76:77], 0, 0
    v_pk_mov_b32 v[78:79], 0, 0
    v_pk_mov_b32 v[80:81], 0, 0
    v_pk_mov_b32 v[82:83], 0, 0
    v_pk_mov_b32 v[84:85], 0, 0
    v_pk_mov_b32 v[86:87], 0, 0
    v_pk_mov_b32 v[88:89], 0, 0
    v_pk_mov_b32 v[90:91], 0, 0
    v_pk_mov_b32 v[92:93], 0, 0
    v_pk_mov_b32 v[94:95], 0, 0
    v_pk_mov_b32 v[96:97], 0, 0
    v_pk_mov_b32 v[98:99], 0, 0
    v_pk_mov_b32 v[100:101], 0, 0
    v_pk_mov_b32 v[102:103], 0, 0
    v_pk_mov_b32 v[104:105], 0, 0
    v_pk_mov_b32 v[106:107], 0, 0
    v_pk_mov_b32 v[108:109], 0, 0
    v_pk_mov_b32 v[110:111], 0, 0
    v_pk_mov_b32 v[112:113], 0, 0
    v_pk_mov_b32 v[114:115], 0, 0
    v_pk_mov_b32 v[116:117], 0, 0
    v_pk_mov_b32 v[118:119], 0, 0
    v_pk_mov_b32 v[120:121], 0, 0
    v_pk_mov_b32 v[122:123], 0, 0
    v_pk_mov_b32 v[124:125], 0, 0
    v_pk_mov_b32 v[126:127], 0, 0
    v_pk_mov_b32 v[128:129], 0, 0
    v_pk_mov_b32 v[130:131], 0, 0
    v_pk_mov_b32 v[132:133], 0, 0
    v_pk_mov_b32 v[134:135], 0, 0
    v_pk_mov_b32 v[136:137], 0, 0
    v_pk_mov_b32 v[138:139], 0, 0
    v_pk_mov_b32 v[140:141], 0, 0
    v_pk_mov_b32 v[142:143], 0, 0
    v_pk_mov_b32 v[144:145], 0, 0
    v_pk_mov_b32 v[146:147], 0, 0
    v_pk_mov_b32 v[148:149], 0, 0
    v_pk_mov_b32 v[150:151], 0, 0
    v_pk_mov_b32 v[152:153], 0, 0
    v_pk_mov_b32 v[154:155], 0, 0
    v_pk_mov_b32 v[156:157], 0, 0
    v_pk_mov_b32 v[158:159], 0, 0
    v_pk_mov_b32 v[160:161], 0, 0
    v_pk_mov_b32 v[162:163], 0, 0
    v_pk_mov_b32 v[164:165], 0, 0
    v_pk_mov_b32 v[166:167], 0, 0
    v_pk_mov_b32 v[168:169], 0, 0
    v_pk_mov_b32 v[170:171], 0, 0
    v_pk_mov_b32 v[172:173], 0, 0
    v_pk_mov_b32 v[174:175], 0, 0
    v_pk_mov_b32 v[176:177], 0, 0
    v_pk_mov_b32 v[178:179], 0, 0
    v_pk_mov_b32 v[180:181], 0, 0
    v_pk_mov_b32 v[182:183], 0, 0
    v_pk_mov_b32 v[184:185], 0, 0
    v_pk_mov_b32 v[186:187], 0, 0
    v_pk_mov_b32 v[188:189], 0, 0
    v_pk_mov_b32 v[190:191], 0, 0
    v_pk_mov_b32 v[192:193], 0, 0
    v_pk_mov_b32 v[194:195], 0, 0
    v_pk_mov_b32 v[196:197], 0, 0
    v_pk_mov_b32 v[198:199], 0, 0
    v_pk_mov_b32 v[200:201], 0, 0
    v_pk_mov_b32 v[202:203], 0, 0
    v_pk_mov_b32 v[204:205], 0, 0
    v_pk_mov_b32 v[206:207], 0, 0
    v_pk_mov_b32 v[208:209], 0, 0
    v_pk_mov_b32 v[210:211], 0, 0
    v_pk_mov_b32 v[212:213], 0, 0
    v_pk_mov_b32 v[214:215], 0, 0
    v_pk_mov_b32 v[216:217], 0, 0
    v_pk_mov_b32 v[218:219], 0, 0
    v_pk_mov_b32 v[220:221], 0, 0
    v_pk_mov_b32 v[222:223], 0, 0
    v_pk_mov_b32 v[224:225], 0, 0
    v_pk_mov_b32 v[226:227], 0, 0
    v_pk_mov_b32 v[228:229], 0, 0
    v_pk_mov_b32 v[230:231], 0, 0
    v_pk_mov_b32 v[232:233], 0, 0
    v_pk_mov_b32 v[234:235], 0, 0
    v_pk_mov_b32 v[236:237], 0, 0
    v_pk_mov_b32 v[238:239], 0, 0
    v_pk_mov_b32 v[240:241], 0, 0
    v_pk_mov_b32 v[242:243], 0, 0
    v_pk_mov_b32 v[244:245], 0, 0
    v_pk_mov_b32 v[246:247], 0, 0
    v_pk_mov_b32 v[248:249], 0, 0
    v_pk_mov_b32 v[250:251], 0, 0
    v_pk_mov_b32 v[252:253], 0, 0
    v_pk_mov_b32 v[254:255], 0, 0
    s_cmp_lg_u32 s30, 0
    s_cbranch_scc1 L_wt_1016
    s_mov_b32 s59, 0
    s_mov_b64 exec, 0x3
L_wtp_1017:
    s_waitcnt vmcnt(0)
    v_cmp_gt_u32 vcc, 16, v7
    s_add_u32 s59, s59, 1
    s_cmp_gt_u32 s59, 131072
    s_cbranch_scc1 L_wt_1016x
    s_cbranch_vccz L_wt_1016x
    buffer_load_dword v7, v6, s[52:55], 0 offen sc1
    s_branch L_wtp_1017
L_wt_1016x:
    s_mov_b64 exec, -1
L_wt_1016:
    s_barrier
    buffer_load_dwordx4 a[0:3], v20, s[44:47], s78 offen offset:0 sc1
    buffer_load_dwordx4 a[4:7], v21, s[44:47], s78 offen offset:0 sc1
    buffer_load_dwordx4 a[8:11], v22, s[44:47], s78 offen offset:0 sc1
    buffer_load_dwordx4 a[12:15], v23, s[44:47], s78 offen offset:0 sc1
    buffer_load_dwordx4 a[16:19], v20, s[44:47], s78 offen offset:1024 sc1
    buffer_load_dwordx4 a[20:23], v21, s[44:47], s78 offen offset:1024 sc1
    buffer_load_dwordx4 a[24:27], v22, s[44:47], s78 offen offset:1024 sc1
    buffer_load_dwordx4 a[28:31], v23, s[44:47], s78 offen offset:1024 sc1
    s_add_u32 s78, s78, 2048
    buffer_load_dwordx4 a[32:35], v20, s[44:47], s78 offen offset:0 sc1
    buffer_load_dwordx4 a[36:39], v21, s[44:47], s78 offen offset:0 sc1
    buffer_load_dwordx4 a[40:43], v22, s[44:47], s78 offen offset:0 sc1
    buffer_load_dwordx4 a[44:47], v23, s[44:47], s78 offen offset:0 sc1
    buffer_load_dwordx4 a[48:51], v20, s[44:47], s78 offen offset:1024 sc1
    buffer_load_dwordx4 a[52:55], v21, s[44:47], s78 offen offset:1024 sc1
    buffer_load_dwordx4 a[56:59], v22, s[44:47], s78 offen offset:1024 sc1
    buffer_load_dwordx4 a[60:63], v23, s[44:47], s78 offen offset:1024 sc1
    s_add_u32 s78, s78, 2048
    buffer_load_dwordx4 a[64:67], v20, s[44:47], s78 offen offset:0 sc1
    buffer_load_dwordx4 a[68:71], v21, s[44:47], s78 offen offset:0 sc1
    buffer_load_dwordx4 a[72:75], v22, s[44:47], s78 offen offset:0 sc1
    buffer_load_dwordx4 a[76:79], v23, s[44:47], s78 offen offset:0 sc1
    buffer_load_dwordx4 a[80:83], v20, s[44:47], s78 offen offset:1024 sc1
    buffer_load_dwordx4 a[84:87], v21, s[44:47], s78 offen offset:1024 sc1
    buffer_load_dwordx4 a[88:91], v22, s[44:47], s78 offen offset:1024 sc1
    buffer_load_dwordx4 a[92:95], v23, s[44:47], s78 offen offset:1024 sc1
    s_add_u32 s78, s78, 2048
    buffer_load_dword v7, v30, s[48:51], 0 offen
    buffer_load_dword v7, v31, s[40:43], 0 offen
    v_mov_b32 v16, v15
    ds_read_b64_tr_b16 a[128:129], v16 offset:0
    ds_read_b64_tr_b16 a[130:131], v16 offset:3584
    ds_read_b64_tr_b16 a[132:133], v16 offset:32
    ds_read_b64_tr_b16 a[134:135], v16 offset:3616
    ds_read_b64_tr_b16 a[136:137], v16 offset:64
    ds_read_b64_tr_b16 a[138:139], v16 offset:3648
    ds_read_b64_tr_b16 a[140:141], v16 offset:96
    ds_read_b64_tr_b16 a[142:143], v16 offset:3680
    ds_read_b64_tr_b16 a[144:145], v16 offset:128
    ds_read_b64_tr_b16 a[146:147], v16 offset:3712
    s_waitcnt vmcnt(22) lgkmcnt(8)
    s_mov_b32 s80, 3
L_g1_1019:
    v_mfma_f32_16x16x32_bf16 v[32:35], a[128:131], a[0:3], v[32:35]
    ds_read_b64_tr_b16 a[148:149], v16 offset:160
    v_mfma_f32_16x16x32_bf16 v[36:39], a[128:131], a[4:7], v[36:39]
    ds_read_b64_tr_b16 a[150:151], v16 offset:3744
    s_add_u32 m0, s75, s74
    v_mfma_f32_16x16x32_bf16 v[40:43], a[128:131], a[8:11], v[40:43]
    buffer_load_dwordx4 v8, s[32:35], s77 offen offset:0  lds
    v_mfma_f32_16x16x32_bf16 v[44:47], a[128:131], a[12:15], v[44:47]
    s_waitcnt lgkmcnt(8)
    v_mfma_f32_16x16x32_bf16 v[48:51], a[132:135], a[0:3], v[48:51]
    ds_read_b64_tr_b16 a[152:153], v16 offset:192
    v_mfma_f32_16x16x32_bf16 v[52:55], a[132:135], a[4:7], v[52:55]
    ds_read_b64_tr_b16 a[154:155], v16 offset:3776
    v_mfma_f32_16x16x32_bf16 v[56:59], a[132:135], a[8:11], v[56:59]
    buffer_load_dwordx4 v9, s[32:35], s77 offen offset:1024  lds
    v_mfma_f32_16x16x32_bf16 v[60:63], a[132:135], a[12:15], v[60:63]
    s_waitcnt lgkmcnt(8)
    v_mfma_f32_16x16x32_bf16 v[64:67], a[136:139], a[0:3], v[64:67]
    ds_read_b64_tr_b16 a[128:129], v16 offset:14336
    v_mfma_f32_16x16x32_bf16 v[68:71], a[136:139], a[4:7], v[68:71]
    ds_read_b64_tr_b16 a[130:131], v16 offset:17920
    v_mfma_f32_16x16x32_bf16 v[72:75], a[136:139], a[8:11], v[72:75]
    buffer_load_dwordx4 v10, s[32:35], s77 offen offset:2048  lds
    v_mfma_f32_16x16x32_bf16 v[76:79], a[136:139], a[12:15], v[76:79]
    s_waitcnt lgkmcnt(8)
    v_mfma_f32_16x16x32_bf16 v[80:83], a[140:143], a[0:3], v[80:83]
    ds_read_b64_tr_b16 a[132:133], v16 offset:14368
    v_mfma_f32_16x16x32_bf16 v[84:87], a[140:143], a[4:7], v[84:87]
    ds_read_b64_tr_b16 a[134:135], v16 offset:17952
    v_mfma_f32_16x16x32_bf16 v[88:91], a[140:143], a[8:11], v[88:91]
    buffer_load_dwordx4 v11, s[32:35], s77 offen offset:3072  lds
    v_mfma_f32_16x16x32_bf16 v[92:95], a[140:143], a[12:15], v[92:95]
    s_waitcnt lgkmcnt(8)
    v_mfma_f32_16x16x32_bf16 v[96:99], a[144:147], a[0:3], v[96:99]
    ds_read_b64_tr_b16 a[136:137], v16 offset:14400
    s_add_u32 m0, m0, 4096
    v_mfma_f32_16x16x32_bf16 v[100:103], a[144:147], a[4:7], v[100:103]
    ds_read_b64_tr_b16 a[138:139], v16 offset:17984
    v_mfma_f32_16x16x32_bf16 v[104:107], a[144:147], a[8:11], v[104:107]
    buffer_load_dwordx4 v12, s[32:35], s77 offen offset:0  lds
    v_mfma_f32_16x16x32_bf16 v[108:111], a[144:147], a[12:15], v[108:111]
    s_waitcnt lgkmcnt(8)
    v_mfma_f32_16x16x32_bf16 v[112:115], a[148:151], a[0:3], v[112:115]
    ds_read_b64_tr_b16 a[140:141], v16 offset:14432
    v_mfma_f32_16x16x32_bf16 v[116:119], a[148:151], a[4:7], v[116:119]
    ds_read_b64_tr_b16 a[142:143], v16 offset:18016
    v_mfma_f32_16x16x32_bf16 v[120:123], a[148:151], a[8:11], v[120:123]
    buffer_load_dwordx4 v13, s[32:35], s77 offen offset:1024  lds
    v_mfma_f32_16x16x32_bf16 v[124:127], a[148:151], a[12:15], v[124:127]
    s_waitcnt lgkmcnt(8)
    v_mfma_f32_16x16x32_bf16 v[128:131], a[152:155], a[0:3], v[128:131]
    ds_read_b64_tr_b16 a[144:145], v16 offset:14464
    v_mfma_f32_16x16x32_bf16 v[132:135], a[152:155], a[4:7], v[132:135]
    ds_read_b64_tr_b16 a[146:147], v16 offset:18048
    v_mfma_f32_16x16x32_bf16 v[136:139], a[152:155], a[8:11], v[136:139]
    buffer_load_dwordx4 v14, s[32:35], s77 offen offset:2048  lds
    v_mfma_f32_16x16x32_bf16 v[140:143], a[152:155], a[12:15], v[140:143]
    s_waitcnt lgkmcnt(8)
    v_mfma_f32_16x16x32_bf16 v[144:147], a[128:131], a[0:3], v[144:147]
    ds_read_b64_tr_b16 a[148:149], v16 offset:14496
    v_mfma_f32_16x16x32_bf16 v[148:151], a[128:131], a[4:7], v[148:151]
    ds_read_b64_tr_b16 a[150:151], v16 offset:18080
    v_mfma_f32_16x16x32_bf16 v[152:155], a[128:131], a[8:11], v[152:155]
    buffer_load_dwordx4 a[96:99], v20, s[44:47], s78 offen offset:0 sc1
    v_mfma_f32_16x16x32_bf16 v[156:159], a[128:131], a[12:15], v[156:159]
    s_waitcnt lgkmcnt(8)
    v_mfma_f32_16x16x32_bf16 v[160:163], a[132:135], a[0:3], v[160:163]
    ds_read_b64_tr_b16 a[152:153], v16 offset:14528
    s_add_u32 s77, s77, 458752
    v_mfma_f32_16x16x32_bf16 v[164:167], a[132:135], a[4:7], v[164:167]
    ds_read_b64_tr_b16 a[154:155], v16 offset:18112
    v_mfma_f32_16x16x32_bf16 v[168:171], a[132:135], a[8:11], v[168:171]
    buffer_load_dwordx4 a[100:103], v21, s[44:47], s78 offen offset:0 sc1
    v_mfma_f32_16x16x32_bf16 v[172:175], a[132:135], a[12:15], v[172:175]
    s_waitcnt lgkmcnt(8)
    v_mfma_f32_16x16x32_bf16 v[176:179], a[136:139], a[0:3], v[176:179]
    ds_read_b64_tr_b16 a[128:129], v16 offset:7168
    s_add_u32 s75, s75, 28672
    v_mfma_f32_16x16x32_bf16 v[180:183], a[136:139], a[4:7], v[180:183]
    ds_read_b64_tr_b16 a[130:131], v16 offset:10752
    v_mfma_f32_16x16x32_bf16 v[184:187], a[136:139], a[8:11], v[184:187]
    buffer_load_dwordx4 a[104:107], v22, s[44:47], s78 offen offset:0 sc1
    v_mfma_f32_16x16x32_bf16 v[188:191], a[136:139], a[12:15], v[188:191]
    s_waitcnt lgkmcnt(8)
    v_mfma_f32_16x16x32_bf16 v[192:195], a[140:143], a[0:3], v[192:195]
    ds_read_b64_tr_b16 a[132:133], v16 offset:7200
    s_cmp_eq_u32 s75, 143360
    v_mfma_f32_16x16x32_bf16 v[196:199], a[140:143], a[4:7], v[196:199]
    ds_read_b64_tr_b16 a[134:135], v16 offset:10784
    v_mfma_f32_16x16x32_bf16 v[200:203], a[140:143], a[8:11], v[200:203]
    buffer_load_dwordx4 a[108:111], v23, s[44:47], s78 offen offset:0 sc1
    v_mfma_f32_16x16x32_bf16 v[204:207], a[140:143], a[12:15], v[204:207]
    s_waitcnt lgkmcnt(8)
    v_mfma_f32_16x16x32_bf16 v[208:211], a[144:147], a[0:3], v[208:211]
    ds_read_b64_tr_b16 a[136:137], v16 offset:7232
    s_cselect_b32 s75, 0, s75
    v_mfma_f32_16x16x32_bf16 v[212:215], a[144:147], a[4:7], v[212:215]
    ds_read_b64_tr_b16 a[138:139], v16 offset:10816
    s_cmp_lg_u32 s80, 3
    v_mfma_f32_16x16x32_bf16 v[216:219], a[144:147], a[8:11], v[216:219]
    buffer_load_dwordx4 a[112:115], v20, s[44:47], s78 offen offset:1024 sc1
    v_mfma_f32_16x16x32_bf16 v[220:223], a[144:147], a[12:15], v[220:223]
    s_waitcnt lgkmcnt(8)
    s_cbranch_scc1 L_fk_1020
    s_waitcnt vmcnt(30)
L_fk_1020:
    v_mfma_f32_16x16x32_bf16 v[224:227], a[148:151], a[0:3], v[224:227]
    ds_read_b64_tr_b16 a[140:141], v16 offset:7264
    s_cmp_eq_u32 s92, 1
    v_mfma_f32_16x16x32_bf16 v[228:231], a[148:151], a[4:7], v[228:231]
    ds_read_b64_tr_b16 a[142:143], v16 offset:10848
    v_mfma_f32_16x16x32_bf16 v[232:235], a[148:151], a[8:11], v[232:235]
    buffer_load_dwordx4 a[116:119], v21, s[44:47], s78 offen offset:1024 sc1
    v_mfma_f32_16x16x32_bf16 v[236:239], a[148:151], a[12:15], v[236:239]
    s_waitcnt lgkmcnt(8)
    v_mfma_f32_16x16x32_bf16 v[240:243], a[152:155], a[0:3], v[240:243]
    ds_read_b64_tr_b16 a[144:145], v16 offset:7296
    s_cselect_b32 s50, 7340032, 0
    v_mfma_f32_16x16x32_bf16 v[244:247], a[152:155], a[4:7], v[244:247]
    ds_read_b64_tr_b16 a[146:147], v16 offset:10880
    v_mfma_f32_16x16x32_bf16 v[248:251], a[152:155], a[8:11], v[248:251]
    buffer_load_dwordx4 a[120:123], v22, s[44:47], s78 offen offset:1024 sc1
    v_mfma_f32_16x16x32_bf16 v[252:255], a[152:155], a[12:15], v[252:255]
    s_waitcnt lgkmcnt(8)
    v_mfma_f32_16x16x32_bf16 v[32:35], a[128:131], a[16:19], v[32:35]
    ds_read_b64_tr_b16 a[148:149], v16 offset:7328
    s_cselect_b32 s42, 7340032, 0
    v_mfma_f32_16x16x32_bf16 v[36:39], a[128:131], a[20:23], v[36:39]
    ds_read_b64_tr_b16 a[150:151], v16 offset:10912
    v_mfma_f32_16x16x32_bf16 v[40:43], a[128:131], a[24:27], v[40:43]
    buffer_load_dwordx4 a[124:127], v23, s[44:47], s78 offen offset:1024 sc1
    v_mfma_f32_16x16x32_bf16 v[44:47], a[128:131], a[28:31], v[44:47]
    s_waitcnt lgkmcnt(8)
    v_mfma_f32_16x16x32_bf16 v[48:51], a[132:135], a[16:19], v[48:51]
    ds_read_b64_tr_b16 a[152:153], v16 offset:7360
    v_mfma_f32_16x16x32_bf16 v[52:55], a[132:135], a[20:23], v[52:55]
    ds_read_b64_tr_b16 a[154:155], v16 offset:10944
    v_mfma_f32_16x16x32_bf16 v[56:59], a[132:135], a[24:27], v[56:59]
    buffer_load_dword v7, v30, s[48:51], 0 offen
    v_mfma_f32_16x16x32_bf16 v[60:63], a[132:135], a[28:31], v[60:63]
    s_waitcnt lgkmcnt(8)
    v_mfma_f32_16x16x32_bf16 v[64:67], a[136:139], a[16:19], v[64:67]
    ds_read_b64_tr_b16 a[128:129], v16 offset:21504
    s_add_u32 s78, s78, 2048
    v_mfma_f32_16x16x32_bf16 v[68:71], a[136:139], a[20:23], v[68:71]
    ds_read_b64_tr_b16 a[130:131], v16 offset:25088
    v_mfma_f32_16x16x32_bf16 v[72:75], a[136:139], a[24:27], v[72:75]
    buffer_load_dword v7, v31, s[40:43], 0 offen
    v_mfma_f32_16x16x32_bf16 v[76:79], a[136:139], a[28:31], v[76:79]
    s_waitcnt lgkmcnt(8)
    v_mfma_f32_16x16x32_bf16 v[80:83], a[140:143], a[16:19], v[80:83]
    ds_read_b64_tr_b16 a[132:133], v16 offset:21536
    v_mfma_f32_16x16x32_bf16 v[84:87], a[140:143], a[20:23], v[84:87]
    ds_read_b64_tr_b16 a[134:135], v16 offset:25120
    v_mfma_f32_16x16x32_bf16 v[88:91], a[140:143], a[24:27], v[88:91]
    v_mfma_f32_16x16x32_bf16 v[92:95], a[140:143], a[28:31], v[92:95]
    s_waitcnt lgkmcnt(8)
    v_mfma_f32_16x16x32_bf16 v[96:99], a[144:147], a[16:19], v[96:99]
    ds_read_b64_tr_b16 a[136:137], v16 offset:21568
    v_mfma_f32_16x16x32_bf16 v[100:103], a[144:147], a[20:23], v[100:103]
    ds_read_b64_tr_b16 a[138:139], v16 offset:25152
    v_mfma_f32_16x16x32_bf16 v[104:107], a[144:147], a[24:27], v[104:107]
    v_mfma_f32_16x16x32_bf16 v[108:111], a[144:147], a[28:31], v[108:111]
    s_waitcnt lgkmcnt(8)
    v_mfma_f32_16x16x32_bf16 v[112:115], a[148:151], a[16:19], v[112:115]
    ds_read_b64_tr_b16 a[140:141], v16 offset:21600
    s_add_u32 s76, s76, 28672
    v_mfma_f32_16x16x32_bf16 v[116:119], a[148:151], a[20:23], v[116:119]
    ds_read_b64_tr_b16 a[142:143], v16 offset:25184
    v_mfma_f32_16x16x32_bf16 v[120:123], a[148:151], a[24:27], v[120:123]
    v_mfma_f32_16x16x32_bf16 v[124:127], a[148:151], a[28:31], v[124:127]
    s_waitcnt lgkmcnt(8)
    v_mfma_f32_16x16x32_bf16 v[128:131], a[152:155], a[16:19], v[128:131]
    ds_read_b64_tr_b16 a[144:145], v16 offset:21632
    s_cmp_eq_u32 s76, 143360
    v_mfma_f32_16x16x32_bf16 v[132:135], a[152:155], a[20:23], v[132:135]
    ds_read_b64_tr_b16 a[146:147], v16 offset:25216
    v_mfma_f32_16x16x32_bf16 v[136:139], a[152:155], a[24:27], v[136:139]
    v_mfma_f32_16x16x32_bf16 v[140:143], a[152:155], a[28:31], v[140:143]
    s_waitcnt lgkmcnt(8)
    v_mfma_f32_16x16x32_bf16 v[144:147], a[128:131], a[16:19], v[144:147]
    ds_read_b64_tr_b16 a[148:149], v16 offset:21664
    s_cselect_b32 s76, 0, s76
    v_mfma_f32_16x16x32_bf16 v[148:151], a[128:131], a[20:23], v[148:151]
    ds_read_b64_tr_b16 a[150:151], v16 offset:25248
    v_mfma_f32_16x16x32_bf16 v[152:155], a[128:131], a[24:27], v[152:155]
    s_cmp_lg_u32 s80, 3
    v_mfma_f32_16x16x32_bf16 v[156:159], a[128:131], a[28:31], v[156:159]
    s_waitcnt lgkmcnt(8)
    v_mfma_f32_16x16x32_bf16 v[160:163], a[132:135], a[16:19], v[160:163]
    ds_read_b64_tr_b16 a[152:153], v16 offset:21696
    s_cbranch_scc1 L_fw_1021
    s_waitcnt vmcnt(27)
L_fw_1021:
    v_mfma_f32_16x16x32_bf16 v[164:167], a[132:135], a[20:23], v[164:167]
    ds_read_b64_tr_b16 a[154:155], v16 offset:25280
    v_mfma_f32_16x16x32_bf16 v[168:171], a[132:135], a[24:27], v[168:171]
    v_add_u32 v16, s76, v15
    s_waitcnt vmcnt(36)
    v_mfma_f32_16x16x32_bf16 v[172:175], a[132:135], a[28:31], v[172:175]
    s_barrier
    s_waitcnt lgkmcnt(8)
    v_mfma_f32_16x16x32_bf16 v[176:179], a[136:139], a[16:19], v[176:179]
    ds_read_b64_tr_b16 a[128:129], v16 offset:0
    v_mfma_f32_16x16x32_bf16 v[180:183], a[136:139], a[20:23], v[180:183]
    ds_read_b64_tr_b16 a[130:131], v16 offset:3584
    v_mfma_f32_16x16x32_bf16 v[184:187], a[136:139], a[24:27], v[184:187]
    v_mfma_f32_16x16x32_bf16 v[188:191], a[136:139], a[28:31], v[188:191]
    s_waitcnt lgkmcnt(8)
    v_mfma_f32_16x16x32_bf16 v[192:195], a[140:143], a[16:19], v[192:195]
    ds_read_b64_tr_b16 a[132:133], v16 offset:32
    v_mfma_f32_16x16x32_bf16 v[196:199], a[140:143], a[20:23], v[196:199]
    ds_read_b64_tr_b16 a[134:135], v16 offset:3616
    v_mfma_f32_16x16x32_bf16 v[200:203], a[140:143], a[24:27], v[200:203]
    v_mfma_f32_16x16x32_bf16 v[204:207], a[140:143], a[28:31], v[204:207]
    s_waitcnt lgkmcnt(8)
    v_mfma_f32_16x16x32_bf16 v[208:211], a[144:147], a[16:19], v[208:211]
    ds_read_b64_tr_b16 a[136:137], v16 offset:64
    v_mfma_f32_16x16x32_bf16 v[212:215], a[144:147], a[20:23], v[212:215]
    ds_read_b64_tr_b16 a[138:139], v16 offset:3648
    v_mfma_f32_16x16x32_bf16 v[216:219], a[144:147], a[24:27], v[216:219]
    v_mfma_f32_16x16x32_bf16 v[220:223], a[144:147], a[28:31], v[220:223]
    s_waitcnt lgkmcnt(8)
    v_mfma_f32_16x16x32_bf16 v[224:227], a[148:151], a[16:19], v[224:227]
    ds_read_b64_tr_b16 a[140:141], v16 offset:96
    v_mfma_f32_16x16x32_bf16 v[228:231], a[148:151], a[20:23], v[228:231]
    ds_read_b64_tr_b16 a[142:143], v16 offset:3680
    v_mfma_f32_16x16x32_bf16 v[232:235], a[148:151], a[24:27], v[232:235]
    v_mfma_f32_16x16x32_bf16 v[236:239], a[148:151], a[28:31], v[236:239]
    s_waitcnt lgkmcnt(8)
    v_mfma_f32_16x16x32_bf16 v[240:243], a[152:155], a[16:19], v[240:243]
    ds_read_b64_tr_b16 a[144:145], v16 offset:128
    v_mfma_f32_16x16x32_bf16 v[244:247], a[152:155], a[20:23], v[244:247]
    ds_read_b64_tr_b16 a[146:147], v16 offset:3712
    v_mfma_f32_16x16x32_bf16 v[248:251], a[152:155], a[24:27], v[248:251]
    v_mfma_f32_16x16x32_bf16 v[252:255], a[152:155], a[28:31], v[252:255]
    s_waitcnt lgkmcnt(8)
    v_mfma_f32_16x16x32_bf16 v[32:35], a[128:131], a[32:35], v[32:35]
    ds_read_b64_tr_b16 a[148:149], v16 offset:160
    v_mfma_f32_16x16x32_bf16 v[36:39], a[128:131], a[36:39], v[36:39]
    ds_read_b64_tr_b16 a[150:151], v16 offset:3744
    s_add_u32 m0, s75, s74
    v_mfma_f32_16x16x32_bf16 v[40:43], a[128:131], a[40:43], v[40:43]
    buffer_load_dwordx4 v8, s[32:35], s77 offen offset:0  lds
    v_mfma_f32_16x16x32_bf16 v[44:47], a[128:131], a[44:47], v[44:47]
    s_waitcnt lgkmcnt(8)
    v_mfma_f32_16x16x32_bf16 v[48:51], a[132:135], a[32:35], v[48:51]
    ds_read_b64_tr_b16 a[152:153], v16 offset:192
    v_mfma_f32_16x16x32_bf16 v[52:55], a[132:135], a[36:39], v[52:55]
    ds_read_b64_tr_b16 a[154:155], v16 offset:3776
    v_mfma_f32_16x16x32_bf16 v[56:59], a[132:135], a[40:43], v[56:59]
    buffer_load_dwordx4 v9, s[32:35], s77 offen offset:1024  lds
    v_mfma_f32_16x16x32_bf16 v[60:63], a[132:135], a[44:47], v[60:63]
    s_waitcnt lgkmcnt(8)
    v_mfma_f32_16x16x32_bf16 v[64:67], a[136:139], a[32:35], v[64:67]
    ds_read_b64_tr_b16 a[128:129], v16 offset:14336
    v_mfma_f32_16x16x32_bf16 v[68:71], a[136:139], a[36:39], v[68:71]
    ds_read_b64_tr_b16 a[130:131], v16 offset:17920
    v_mfma_f32_16x16x32_bf16 v[72:75], a[136:139], a[40:43], v[72:75]
    buffer_load_dwordx4 v10, s[32:35], s77 offen offset:2048  lds
    v_mfma_f32_16x16x32_bf16 v[76:79], a[136:139], a[44:47], v[76:79]
    s_waitcnt lgkmcnt(8)
    v_mfma_f32_16x16x32_bf16 v[80:83], a[140:143], a[32:35], v[80:83]
    ds_read_b64_tr_b16 a[132:133], v16 offset:14368
    v_mfma_f32_16x16x32_bf16 v[84:87], a[140:143], a[36:39], v[84:87]
    ds_read_b64_tr_b16 a[134:135], v16 offset:17952
    v_mfma_f32_16x16x32_bf16 v[88:91], a[140:143], a[40:43], v[88:91]
    buffer_load_dwordx4 v11, s[32:35], s77 offen offset:3072  lds
    v_mfma_f32_16x16x32_bf16 v[92:95], a[140:143], a[44:47], v[92:95]
    s_waitcnt lgkmcnt(8)
    v_mfma_f32_16x16x32_bf16 v[96:99], a[144:147], a[32:35], v[96:99]
    ds_read_b64_tr_b16 a[136:137], v16 offset:14400
    s_add_u32 m0, m0, 4096
    v_mfma_f32_16x16x32_bf16 v[100:103], a[144:147], a[36:39], v[100:103]
    ds_read_b64_tr_b16 a[138:139], v16 offset:17984
    v_mfma_f32_16x16x32_bf16 v[104:107], a[144:147], a[40:43], v[104:107]
    buffer_load_dwordx4 v12, s[32:35], s77 offen offset:0  lds
    v_mfma_f32_16x16x32_bf16 v[108:111], a[144:147], a[44:47], v[108:111]
    s_waitcnt lgkmcnt(8)
    v_mfma_f32_16x16x32_bf16 v[112:115], a[148:151], a[32:35], v[112:115]
    ds_read_b64_tr_b16 a[140:141], v16 offset:14432
    v_mfma_f32_16x16x32_bf16 v[116:119], a[148:151], a[36:39], v[116:119]
    ds_read_b64_tr_b16 a[142:143], v16 offset:18016
    v_mfma_f32_16x16x32_bf16 v[120:123], a[148:151], a[40:43], v[120:123]
    buffer_load_dwordx4 v13, s[32:35], s77 offen offset:1024  lds
    v_mfma_f32_16x16x32_bf16 v[124:127], a[148:151], a[44:47], v[124:127]
    s_waitcnt lgkmcnt(8)
    v_mfma_f32_16x16x32_bf16 v[128:131], a[152:155], a[32:35], v[128:131]
    ds_read_b64_tr_b16 a[144:145], v16 offset:14464
    v_mfma_f32_16x16x32_bf16 v[132:135], a[152:155], a[36:39], v[132:135]
    ds_read_b64_tr_b16 a[146:147], v16 offset:18048
    v_mfma_f32_16x16x32_bf16 v[136:139], a[152:155], a[40:43], v[136:139]
    buffer_load_dwordx4 v14, s[32:35], s77 offen offset:2048  lds
    v_mfma_f32_16x16x32_bf16 v[140:143], a[152:155], a[44:47], v[140:143]
    s_waitcnt lgkmcnt(8)
    v_mfma_f32_16x16x32_bf16 v[144:147], a[128:131], a[32:35], v[144:147]
    ds_read_b64_tr_b16 a[148:149], v16 offset:14496
    v_mfma_f32_16x16x32_bf16 v[148:151], a[128:131], a[36:39], v[148:151]
    ds_read_b64_tr_b16 a[150:151], v16 offset:18080
    v_mfma_f32_16x16x32_bf16 v[152:155], a[128:131], a[40:43], v[152:155]
    buffer_load_dwordx4 a[0:3], v20, s[44:47], s78 offen offset:0 sc1
    v_mfma_f32_16x16x32_bf16 v[156:159], a[128:131], a[44:47], v[156:159]
    s_waitcnt lgkmcnt(8)
    v_mfma_f32_16x16x32_bf16 v[160:163], a[132:135], a[32:35], v[160:163]
    ds_read_b64_tr_b16 a[152:153], v16 offset:14528
    s_add_u32 s77, s77, 458752
    v_mfma_f32_16x16x32_bf16 v[164:167], a[132:135], a[36:39], v[164:167]
    ds_read_b64_tr_b16 a[154:155], v16 offset:18112
    v_mfma_f32_16x16x32_bf16 v[168:171], a[132:135], a[40:43], v[168:171]
    buffer_load_dwordx4 a[4:7], v21, s[44:47], s78 offen offset:0 sc1
    v_mfma_f32_16x16x32_bf16 v[172:175], a[132:135], a[44:47], v[172:175]
    s_waitcnt lgkmcnt(8)
    v_mfma_f32_16x16x32_bf16 v[176:179], a[136:139], a[32:35], v[176:179]
    ds_read_b64_tr_b16 a[128:129], v16 offset:7168
    s_add_u32 s75, s75, 28672
    v_mfma_f32_16x16x32_bf16 v[180:183], a[136:139], a[36:39], v[180:183]
    ds_read_b64_tr_b16 a[130:131], v16 offset:10752
    v_mfma_f32_16x16x32_bf16 v[184:187], a[136:139], a[40:43], v[184:187]
    buffer_load_dwordx4 a[8:11], v22, s[44:47], s78 offen offset:0 sc1
    v_mfma_f32_16x16x32_bf16 v[188:191], a[136:139], a[44:47], v[188:191]
    s_waitcnt lgkmcnt(8)
    v_mfma_f32_16x16x32_bf16 v[192:195], a[140:143], a[32:35], v[192:195]
    ds_read_b64_tr_b16 a[132:133], v16 offset:7200
    s_cmp_eq_u32 s75, 143360
    v_mfma_f32_16x16x32_bf16 v[196:199], a[140:143], a[36:39], v[196:199]
    ds_read_b64_tr_b16 a[134:135], v16 offset:10784
    v_mfma_f32_16x16x32_bf16 v[200:203], a[140:143], a[40:43], v[200:203]
    buffer_load_dwordx4 a[12:15], v23, s[44:47], s78 offen offset:0 sc1
    v_mfma_f32_16x16x32_bf16 v[204:207], a[140:143], a[44:47], v[204:207]
    s_waitcnt lgkmcnt(8)
    v_mfma_f32_16x16x32_bf16 v[208:211], a[144:147], a[32:35], v[208:211]
    ds_read_b64_tr_b16 a[136:137], v16 offset:7232
    s_cselect_b32 s75, 0, s75
    v_mfma_f32_16x16x32_bf16 v[212:215], a[144:147], a[36:39], v[212:215]
    ds_read_b64_tr_b16 a[138:139], v16 offset:10816
    v_mfma_f32_16x16x32_bf16 v[216:219], a[144:147], a[40:43], v[216:219]
    buffer_load_dwordx4 a[16:19], v20, s[44:47], s78 offen offset:1024 sc1
    v_mfma_f32_16x16x32_bf16 v[220:223], a[144:147], a[44:47], v[220:223]
    s_waitcnt lgkmcnt(8)
    v_mfma_f32_16x16x32_bf16 v[224:227], a[148:151], a[32:35], v[224:227]
    ds_read_b64_tr_b16 a[140:141], v16 offset:7264
    s_cmp_eq_u32 s92, 0
    v_mfma_f32_16x16x32_bf16 v[228:231], a[148:151], a[36:39], v[228:231]
    ds_read_b64_tr_b16 a[142:143], v16 offset:10848
    v_mfma_f32_16x16x32_bf16 v[232:235], a[148:151], a[40:43], v[232:235]
    buffer_load_dwordx4 a[20:23], v21, s[44:47], s78 offen offset:1024 sc1
    v_mfma_f32_16x16x32_bf16 v[236:239], a[148:151], a[44:47], v[236:239]
    s_waitcnt lgkmcnt(8)
    v_mfma_f32_16x16x32_bf16 v[240:243], a[152:155], a[32:35], v[240:243]
    ds_read_b64_tr_b16 a[144:145], v16 offset:7296
    s_cselect_b32 s50, 7340032, 0
    v_mfma_f32_16x16x32_bf16 v[244:247], a[152:155], a[36:39], v[244:247]
    ds_read_b64_tr_b16 a[146:147], v16 offset:10880
    v_mfma_f32_16x16x32_bf16 v[248:251], a[152:155], a[40:43], v[248:251]
    buffer_load_dwordx4 a[24:27], v22, s[44:47], s78 offen offset:1024 sc1
    v_mfma_f32_16x16x32_bf16 v[252:255], a[152:155], a[44:47], v[252:255]
    s_waitcnt lgkmcnt(8)
    v_mfma_f32_16x16x32_bf16 v[32:35], a[128:131], a[48:51], v[32:35]
    ds_read_b64_tr_b16 a[148:149], v16 offset:7328
    s_cselect_b32 s42, 7340032, 0
    v_mfma_f32_16x16x32_bf16 v[36:39], a[128:131], a[52:55], v[36:39]
    ds_read_b64_tr_b16 a[150:151], v16 offset:10912
    v_mfma_f32_16x16x32_bf16 v[40:43], a[128:131], a[56:59], v[40:43]
    buffer_load_dwordx4 a[28:31], v23, s[44:47], s78 offen offset:1024 sc1
    v_mfma_f32_16x16x32_bf16 v[44:47], a[128:131], a[60:63], v[44:47]
    s_waitcnt lgkmcnt(8)
    v_mfma_f32_16x16x32_bf16 v[48:51], a[132:135], a[48:51], v[48:51]
    ds_read_b64_tr_b16 a[152:153], v16 offset:7360
    v_mfma_f32_16x16x32_bf16 v[52:55], a[132:135], a[52:55], v[52:55]
    ds_read_b64_tr_b16 a[154:155], v16 offset:10944
    v_mfma_f32_16x16x32_bf16 v[56:59], a[132:135], a[56:59], v[56:59]
    buffer_load_dword v7, v30, s[48:51], 0 offen
    v_mfma_f32_16x16x32_bf16 v[60:63], a[132:135], a[60:63], v[60:63]
    s_waitcnt lgkmcnt(8)
    v_mfma_f32_16x16x32_bf16 v[64:67], a[136:139], a[48:51], v[64:67]
    ds_read_b64_tr_b16 a[128:129], v16 offset:21504
    s_add_u32 s78, s78, 2048
    v_mfma_f32_16x16x32_bf16 v[68:71], a[136:139], a[52:55], v[68:71]
    ds_read_b64_tr_b16 a[130:131], v16 offset:25088
    v_mfma_f32_16x16x32_bf16 v[72:75], a[136:139], a[56:59], v[72:75]
    buffer_load_dword v7, v31, s[40:43], 0 offen
    v_mfma_f32_16x16x32_bf16 v[76:79], a[136:139], a[60:63], v[76:79]
    s_waitcnt lgkmcnt(8)
    v_mfma_f32_16x16x32_bf16 v[80:83], a[140:143], a[48:51], v[80:83]
    ds_read_b64_tr_b16 a[132:133], v16 offset:21536
    v_add_u32 v30, 655360, v30
    v_mfma_f32_16x16x32_bf16 v[84:87], a[140:143], a[52:55], v[84:87]
    ds_read_b64_tr_b16 a[134:135], v16 offset:25120
    v_mfma_f32_16x16x32_bf16 v[88:91], a[140:143], a[56:59], v[88:91]
    v_mfma_f32_16x16x32_bf16 v[92:95], a[140:143], a[60:63], v[92:95]
    s_waitcnt lgkmcnt(8)
    v_mfma_f32_16x16x32_bf16 v[96:99], a[144:147], a[48:51], v[96:99]
    ds_read_b64_tr_b16 a[136:137], v16 offset:21568
    v_add_u32 v31, 917504, v31
    v_mfma_f32_16x16x32_bf16 v[100:103], a[144:147], a[52:55], v[100:103]
    ds_read_b64_tr_b16 a[138:139], v16 offset:25152
    v_mfma_f32_16x16x32_bf16 v[104:107], a[144:147], a[56:59], v[104:107]
    v_mfma_f32_16x16x32_bf16 v[108:111], a[144:147], a[60:63], v[108:111]
    s_waitcnt lgkmcnt(8)
    v_mfma_f32_16x16x32_bf16 v[112:115], a[148:151], a[48:51], v[112:115]
    ds_read_b64_tr_b16 a[140:141], v16 offset:21600
    s_add_u32 s76, s76, 28672
    v_mfma_f32_16x16x32_bf16 v[116:119], a[148:151], a[52:55], v[116:119]
    ds_read_b64_tr_b16 a[142:143], v16 offset:25184
    v_mfma_f32_16x16x32_bf16 v[120:123], a[148:151], a[56:59], v[120:123]
    v_mfma_f32_16x16x32_bf16 v[124:127], a[148:151], a[60:63], v[124:127]
    s_waitcnt lgkmcnt(8)
    v_mfma_f32_16x16x32_bf16 v[128:131], a[152:155], a[48:51], v[128:131]
    ds_read_b64_tr_b16 a[144:145], v16 offset:21632
    s_cmp_eq_u32 s76, 143360
    v_mfma_f32_16x16x32_bf16 v[132:135], a[152:155], a[52:55], v[132:135]
    ds_read_b64_tr_b16 a[146:147], v16 offset:25216
    v_mfma_f32_16x16x32_bf16 v[136:139], a[152:155], a[56:59], v[136:139]
    v_mfma_f32_16x16x32_bf16 v[140:143], a[152:155], a[60:63], v[140:143]
    s_waitcnt lgkmcnt(8)
    v_mfma_f32_16x16x32_bf16 v[144:147], a[128:131], a[48:51], v[144:147]
    ds_read_b64_tr_b16 a[148:149], v16 offset:21664
    s_cselect_b32 s76, 0, s76
    v_mfma_f32_16x16x32_bf16 v[148:151], a[128:131], a[52:55], v[148:151]
    ds_read_b64_tr_b16 a[150:151], v16 offset:25248
    v_mfma_f32_16x16x32_bf16 v[152:155], a[128:131], a[56:59], v[152:155]
    v_mfma_f32_16x16x32_bf16 v[156:159], a[128:131], a[60:63], v[156:159]
    s_waitcnt lgkmcnt(8)
    v_mfma_f32_16x16x32_bf16 v[160:163], a[132:135], a[48:51], v[160:163]
    ds_read_b64_tr_b16 a[152:153], v16 offset:21696
    v_mfma_f32_16x16x32_bf16 v[164:167], a[132:135], a[52:55], v[164:167]
    ds_read_b64_tr_b16 a[154:155], v16 offset:25280
    v_mfma_f32_16x16x32_bf16 v[168:171], a[132:135], a[56:59], v[168:171]
    v_add_u32 v16, s76, v15
    s_waitcnt vmcnt(36)
    v_mfma_f32_16x16x32_bf16 v[172:175], a[132:135], a[60:63], v[172:175]
    s_barrier
    s_waitcnt lgkmcnt(8)
    v_mfma_f32_16x16x32_bf16 v[176:179], a[136:139], a[48:51], v[176:179]
    ds_read_b64_tr_b16 a[128:129], v16 offset:0
    v_mfma_f32_16x16x32_bf16 v[180:183], a[136:139], a[52:55], v[180:183]
    ds_read_b64_tr_b16 a[130:131], v16 offset:3584
    v_mfma_f32_16x16x32_bf16 v[184:187], a[136:139], a[56:59], v[184:187]
    v_mfma_f32_16x16x32_bf16 v[188:191], a[136:139], a[60:63], v[188:191]
    s_waitcnt lgkmcnt(8)
    v_mfma_f32_16x16x32_bf16 v[192:195], a[140:143], a[48:51], v[192:195]
    ds_read_b64_tr_b16 a[132:133], v16 offset:32
    v_mfma_f32_16x16x32_bf16 v[196:199], a[140:143], a[52:55], v[196:199]
    ds_read_b64_tr_b16 a[134:135], v16 offset:3616
    v_mfma_f32_16x16x32_bf16 v[200:203], a[140:143], a[56:59], v[200:203]
    v_mfma_f32_16x16x32_bf16 v[204:207], a[140:143], a[60:63], v[204:207]
    s_waitcnt lgkmcnt(8)
    v_mfma_f32_16x16x32_bf16 v[208:211], a[144:147], a[48:51], v[208:211]
    ds_read_b64_tr_b16 a[136:137], v16 offset:64
    v_mfma_f32_16x16x32_bf16 v[212:215], a[144:147], a[52:55], v[212:215]
    ds_read_b64_tr_b16 a[138:139], v16 offset:3648
    v_mfma_f32_16x16x32_bf16 v[216:219], a[144:147], a[56:59], v[216:219]
    v_mfma_f32_16x16x32_bf16 v[220:223], a[144:147], a[60:63], v[220:223]
    s_waitcnt lgkmcnt(8)
    v_mfma_f32_16x16x32_bf16 v[224:227], a[148:151], a[48:51], v[224:227]
    ds_read_b64_tr_b16 a[140:141], v16 offset:96
    v_mfma_f32_16x16x32_bf16 v[228:231], a[148:151], a[52:55], v[228:231]
    ds_read_b64_tr_b16 a[142:143], v16 offset:3680
    v_mfma_f32_16x16x32_bf16 v[232:235], a[148:151], a[56:59], v[232:235]
    v_mfma_f32_16x16x32_bf16 v[236:239], a[148:151], a[60:63], v[236:239]
    s_waitcnt lgkmcnt(8)
    v_mfma_f32_16x16x32_bf16 v[240:243], a[152:155], a[48:51], v[240:243]
    ds_read_b64_tr_b16 a[144:145], v16 offset:128
    v_mfma_f32_16x16x32_bf16 v[244:247], a[152:155], a[52:55], v[244:247]
    ds_read_b64_tr_b16 a[146:147], v16 offset:3712
    v_mfma_f32_16x16x32_bf16 v[248:251], a[152:155], a[56:59], v[248:251]
    v_mfma_f32_16x16x32_bf16 v[252:255], a[152:155], a[60:63], v[252:255]
    s_waitcnt lgkmcnt(8)
    v_mfma_f32_16x16x32_bf16 v[32:35], a[128:131], a[64:67], v[32:35]
    ds_read_b64_tr_b16 a[148:149], v16 offset:160
    v_mfma_f32_16x16x32_bf16 v[36:39], a[128:131], a[68:71], v[36:39]
    ds_read_b64_tr_b16 a[150:151], v16 offset:3744
    s_add_u32 m0, s75, s74
    v_mfma_f32_16x16x32_bf16 v[40:43], a[128:131], a[72:75], v[40:43]
    buffer_load_dwordx4 v8, s[32:35], s77 offen offset:0  lds
    v_mfma_f32_16x16x32_bf16 v[44:47], a[128:131], a[76:79], v[44:47]
    s_waitcnt lgkmcnt(8)
    v_mfma_f32_16x16x32_bf16 v[48:51], a[132:135], a[64:67], v[48:51]
    ds_read_b64_tr_b16 a[152:153], v16 offset:192
    v_mfma_f32_16x16x32_bf16 v[52:55], a[132:135], a[68:71], v[52:55]
    ds_read_b64_tr_b16 a[154:155], v16 offset:3776
    v_mfma_f32_16x16x32_bf16 v[56:59], a[132:135], a[72:75], v[56:59]
    buffer_load_dwordx4 v9, s[32:35], s77 offen offset:1024  lds
    v_mfma_f32_16x16x32_bf16 v[60:63], a[132:135], a[76:79], v[60:63]
    s_waitcnt lgkmcnt(8)
    v_mfma_f32_16x16x32_bf16 v[64:67], a[136:139], a[64:67], v[64:67]
    ds_read_b64_tr_b16 a[128:129], v16 offset:14336
    v_mfma_f32_16x16x32_bf16 v[68:71], a[136:139], a[68:71], v[68:71]
    ds_read_b64_tr_b16 a[130:131], v16 offset:17920
    v_mfma_f32_16x16x32_bf16 v[72:75], a[136:139], a[72:75], v[72:75]
    buffer_load_dwordx4 v10, s[32:35], s77 offen offset:2048  lds
    v_mfma_f32_16x16x32_bf16 v[76:79], a[136:139], a[76:79], v[76:79]
    s_waitcnt lgkmcnt(8)
    v_mfma_f32_16x16x32_bf16 v[80:83], a[140:143], a[64:67], v[80:83]
    ds_read_b64_tr_b16 a[132:133], v16 offset:14368
    v_mfma_f32_16x16x32_bf16 v[84:87], a[140:143], a[68:71], v[84:87]
    ds_read_b64_tr_b16 a[134:135], v16 offset:17952
    v_mfma_f32_16x16x32_bf16 v[88:91], a[140:143], a[72:75], v[88:91]
    buffer_load_dwordx4 v11, s[32:35], s77 offen offset:3072  lds
    v_mfma_f32_16x16x32_bf16 v[92:95], a[140:143], a[76:79], v[92:95]
    s_waitcnt lgkmcnt(8)
    v_mfma_f32_16x16x32_bf16 v[96:99], a[144:147], a[64:67], v[96:99]
    ds_read_b64_tr_b16 a[136:137], v16 offset:14400
    s_add_u32 m0, m0, 4096
    v_mfma_f32_16x16x32_bf16 v[100:103], a[144:147], a[68:71], v[100:103]
    ds_read_b64_tr_b16 a[138:139], v16 offset:17984
    v_mfma_f32_16x16x32_bf16 v[104:107], a[144:147], a[72:75], v[104:107]
    buffer_load_dwordx4 v12, s[32:35], s77 offen offset:0  lds
    v_mfma_f32_16x16x32_bf16 v[108:111], a[144:147], a[76:79], v[108:111]
    s_waitcnt lgkmcnt(8)
    v_mfma_f32_16x16x32_bf16 v[112:115], a[148:151], a[64:67], v[112:115]
    ds_read_b64_tr_b16 a[140:141], v16 offset:14432
    v_mfma_f32_16x16x32_bf16 v[116:119], a[148:151], a[68:71], v[116:119]
    ds_read_b64_tr_b16 a[142:143], v16 offset:18016
    v_mfma_f32_16x16x32_bf16 v[120:123], a[148:151], a[72:75], v[120:123]
    buffer_load_dwordx4 v13, s[32:35], s77 offen offset:1024  lds
    v_mfma_f32_16x16x32_bf16 v[124:127], a[148:151], a[76:79], v[124:127]
    s_waitcnt lgkmcnt(8)
    v_mfma_f32_16x16x32_bf16 v[128:131], a[152:155], a[64:67], v[128:131]
    ds_read_b64_tr_b16 a[144:145], v16 offset:14464
    v_mfma_f32_16x16x32_bf16 v[132:135], a[152:155], a[68:71], v[132:135]
    ds_read_b64_tr_b16 a[146:147], v16 offset:18048
    v_mfma_f32_16x16x32_bf16 v[136:139], a[152:155], a[72:75], v[136:139]
    buffer_load_dwordx4 v14, s[32:35], s77 offen offset:2048  lds
    v_mfma_f32_16x16x32_bf16 v[140:143], a[152:155], a[76:79], v[140:143]
    s_waitcnt lgkmcnt(8)
    v_mfma_f32_16x16x32_bf16 v[144:147], a[128:131], a[64:67], v[144:147]
    ds_read_b64_tr_b16 a[148:149], v16 offset:14496
    v_mfma_f32_16x16x32_bf16 v[148:151], a[128:131], a[68:71], v[148:151]
    ds_read_b64_tr_b16 a[150:151], v16 offset:18080
    v_mfma_f32_16x16x32_bf16 v[152:155], a[128:131], a[72:75], v[152:155]
    buffer_load_dwordx4 a[32:35], v20, s[44:47], s78 offen offset:0 sc1
    v_mfma_f32_16x16x32_bf16 v[156:159], a[128:131], a[76:79], v[156:159]
    s_waitcnt lgkmcnt(8)
    v_mfma_f32_16x16x32_bf16 v[160:163], a[132:135], a[64:67], v[160:163]
    ds_read_b64_tr_b16 a[152:153], v16 offset:14528
    s_add_u32 s77, s77, 458752
    v_mfma_f32_16x16x32_bf16 v[164:167], a[132:135], a[68:71], v[164:167]
    ds_read_b64_tr_b16 a[154:155], v16 offset:18112
    v_mfma_f32_16x16x32_bf16 v[168:171], a[132:135], a[72:75], v[168:171]
    buffer_load_dwordx4 a[36:39], v21, s[44:47], s78 offen offset:0 sc1
    v_mfma_f32_16x16x32_bf16 v[172:175], a[132:135], a[76:79], v[172:175]
    s_waitcnt lgkmcnt(8)
    v_mfma_f32_16x16x32_bf16 v[176:179], a[136:139], a[64:67], v[176:179]
    ds_read_b64_tr_b16 a[128:129], v16 offset:7168
    s_add_u32 s75, s75, 28672
    v_mfma_f32_16x16x32_bf16 v[180:183], a[136:139], a[68:71], v[180:183]
    ds_read_b64_tr_b16 a[130:131], v16 offset:10752
    v_mfma_f32_16x16x32_bf16 v[184:187], a[136:139], a[72:75], v[184:187]
    buffer_load_dwordx4 a[40:43], v22, s[44:47], s78 offen offset:0 sc1
    v_mfma_f32_16x16x32_bf16 v[188:191], a[136:139], a[76:79], v[188:191]
    s_waitcnt lgkmcnt(8)
    v_mfma_f32_16x16x32_bf16 v[192:195], a[140:143], a[64:67], v[192:195]
    ds_read_b64_tr_b16 a[132:133], v16 offset:7200
    s_cmp_eq_u32 s75, 143360
    v_mfma_f32_16x16x32_bf16 v[196:199], a[140:143], a[68:71], v[196:199]
    ds_read_b64_tr_b16 a[134:135], v16 offset:10784
    v_mfma_f32_16x16x32_bf16 v[200:203], a[140:143], a[72:75], v[200:203]
    buffer_load_dwordx4 a[44:47], v23, s[44:47], s78 offen offset:0 sc1
    v_mfma_f32_16x16x32_bf16 v[204:207], a[140:143], a[76:79], v[204:207]
    s_waitcnt lgkmcnt(8)
    v_mfma_f32_16x16x32_bf16 v[208:211], a[144:147], a[64:67], v[208:211]
    ds_read_b64_tr_b16 a[136:137], v16 offset:7232
    s_cselect_b32 s75, 0, s75
    v_mfma_f32_16x16x32_bf16 v[212:215], a[144:147], a[68:71], v[212:215]
    ds_read_b64_tr_b16 a[138:139], v16 offset:10816
    v_mfma_f32_16x16x32_bf16 v[216:219], a[144:147], a[72:75], v[216:219]
    buffer_load_dwordx4 a[48:51], v20, s[44:47], s78 offen offset:1024 sc1
    v_mfma_f32_16x16x32_bf16 v[220:223], a[144:147], a[76:79], v[220:223]
    s_waitcnt lgkmcnt(8)
    v_mfma_f32_16x16x32_bf16 v[224:227], a[148:151], a[64:67], v[224:227]
    ds_read_b64_tr_b16 a[140:141], v16 offset:7264
    s_cmp_eq_u32 s92, 1
    v_mfma_f32_16x16x32_bf16 v[228:231], a[148:151], a[68:71], v[228:231]
    ds_read_b64_tr_b16 a[142:143], v16 offset:10848
    v_mfma_f32_16x16x32_bf16 v[232:235], a[148:151], a[72:75], v[232:235]
    buffer_load_dwordx4 a[52:55], v21, s[44:47], s78 offen offset:1024 sc1
    v_mfma_f32_16x16x32_bf16 v[236:239], a[148:151], a[76:79], v[236:239]
    s_waitcnt lgkmcnt(8)
    v_mfma_f32_16x16x32_bf16 v[240:243], a[152:155], a[64:67], v[240:243]
    ds_read_b64_tr_b16 a[144:145], v16 offset:7296
    s_cselect_b32 s50, 7340032, 0
    v_mfma_f32_16x16x32_bf16 v[244:247], a[152:155], a[68:71], v[244:247]
    ds_read_b64_tr_b16 a[146:147], v16 offset:10880
    v_mfma_f32_16x16x32_bf16 v[248:251], a[152:155], a[72:75], v[248:251]
    buffer_load_dwordx4 a[56:59], v22, s[44:47], s78 offen offset:1024 sc1
    v_mfma_f32_16x16x32_bf16 v[252:255], a[152:155], a[76:79], v[252:255]
    s_waitcnt lgkmcnt(8)
    v_mfma_f32_16x16x32_bf16 v[32:35], a[128:131], a[80:83], v[32:35]
    ds_read_b64_tr_b16 a[148:149], v16 offset:7328
    s_cselect_b32 s42, 7340032, 0
    v_mfma_f32_16x16x32_bf16 v[36:39], a[128:131], a[84:87], v[36:39]
    ds_read_b64_tr_b16 a[150:151], v16 offset:10912
    v_mfma_f32_16x16x32_bf16 v[40:43], a[128:131], a[88:91], v[40:43]
    buffer_load_dwordx4 a[60:63], v23, s[44:47], s78 offen offset:1024 sc1
    v_mfma_f32_16x16x32_bf16 v[44:47], a[128:131], a[92:95], v[44:47]
    s_waitcnt lgkmcnt(8)
    v_mfma_f32_16x16x32_bf16 v[48:51], a[132:135], a[80:83], v[48:51]
    ds_read_b64_tr_b16 a[152:153], v16 offset:7360
    v_mfma_f32_16x16x32_bf16 v[52:55], a[132:135], a[84:87], v[52:55]
    ds_read_b64_tr_b16 a[154:155], v16 offset:10944
    v_mfma_f32_16x16x32_bf16 v[56:59], a[132:135], a[88:91], v[56:59]
    buffer_load_dword v7, v30, s[48:51], 0 offen
    v_mfma_f32_16x16x32_bf16 v[60:63], a[132:135], a[92:95], v[60:63]
    s_waitcnt lgkmcnt(8)
    v_mfma_f32_16x16x32_bf16 v[64:67], a[136:139], a[80:83], v[64:67]
    ds_read_b64_tr_b16 a[128:129], v16 offset:21504
    s_add_u32 s78, s78, 2048
    v_mfma_f32_16x16x32_bf16 v[68:71], a[136:139], a[84:87], v[68:71]
    ds_read_b64_tr_b16 a[130:131], v16 offset:25088
    v_mfma_f32_16x16x32_bf16 v[72:75], a[136:139], a[88:91], v[72:75]
    buffer_load_dword v7, v31, s[40:43], 0 offen
    v_mfma_f32_16x16x32_bf16 v[76:79], a[136:139], a[92:95], v[76:79]
    s_waitcnt lgkmcnt(8)
    v_mfma_f32_16x16x32_bf16 v[80:83], a[140:143], a[80:83], v[80:83]
    ds_read_b64_tr_b16 a[132:133], v16 offset:21536
    v_mfma_f32_16x16x32_bf16 v[84:87], a[140:143], a[84:87], v[84:87]
    ds_read_b64_tr_b16 a[134:135], v16 offset:25120
    v_mfma_f32_16x16x32_bf16 v[88:91], a[140:143], a[88:91], v[88:91]
    v_mfma_f32_16x16x32_bf16 v[92:95], a[140:143], a[92:95], v[92:95]
    s_waitcnt lgkmcnt(8)
    v_mfma_f32_16x16x32_bf16 v[96:99], a[144:147], a[80:83], v[96:99]
    ds_read_b64_tr_b16 a[136:137], v16 offset:21568
    v_mfma_f32_16x16x32_bf16 v[100:103], a[144:147], a[84:87], v[100:103]
    ds_read_b64_tr_b16 a[138:139], v16 offset:25152
    v_mfma_f32_16x16x32_bf16 v[104:107], a[144:147], a[88:91], v[104:107]
    v_mfma_f32_16x16x32_bf16 v[108:111], a[144:147], a[92:95], v[108:111]
    s_waitcnt lgkmcnt(8)
    v_mfma_f32_16x16x32_bf16 v[112:115], a[148:151], a[80:83], v[112:115]
    ds_read_b64_tr_b16 a[140:141], v16 offset:21600
    s_add_u32 s76, s76, 28672
    v_mfma_f32_16x16x32_bf16 v[116:119], a[148:151], a[84:87], v[116:119]
    ds_read_b64_tr_b16 a[142:143], v16 offset:25184
    v_mfma_f32_16x16x32_bf16 v[120:123], a[148:151], a[88:91], v[120:123]
    v_mfma_f32_16x16x32_bf16 v[124:127], a[148:151], a[92:95], v[124:127]
    s_waitcnt lgkmcnt(8)
    v_mfma_f32_16x16x32_bf16 v[128:131], a[152:155], a[80:83], v[128:131]
    ds_read_b64_tr_b16 a[144:145], v16 offset:21632
    s_cmp_eq_u32 s76, 143360
    v_mfma_f32_16x16x32_bf16 v[132:135], a[152:155], a[84:87], v[132:135]
    ds_read_b64_tr_b16 a[146:147], v16 offset:25216
    v_mfma_f32_16x16x32_bf16 v[136:139], a[152:155], a[88:91], v[136:139]
    v_mfma_f32_16x16x32_bf16 v[140:143], a[152:155], a[92:95], v[140:143]
    s_waitcnt lgkmcnt(8)
    v_mfma_f32_16x16x32_bf16 v[144:147], a[128:131], a[80:83], v[144:147]
    ds_read_b64_tr_b16 a[148:149], v16 offset:21664
    s_cselect_b32 s76, 0, s76
    v_mfma_f32_16x16x32_bf16 v[148:151], a[128:131], a[84:87], v[148:151]
    ds_read_b64_tr_b16 a[150:151], v16 offset:25248
    v_mfma_f32_16x16x32_bf16 v[152:155], a[128:131], a[88:91], v[152:155]
    v_mfma_f32_16x16x32_bf16 v[156:159], a[128:131], a[92:95], v[156:159]
    s_waitcnt lgkmcnt(8)
    v_mfma_f32_16x16x32_bf16 v[160:163], a[132:135], a[80:83], v[160:163]
    ds_read_b64_tr_b16 a[152:153], v16 offset:21696
    v_mfma_f32_16x16x32_bf16 v[164:167], a[132:135], a[84:87], v[164:167]
    ds_read_b64_tr_b16 a[154:155], v16 offset:25280
    v_mfma_f32_16x16x32_bf16 v[168:171], a[132:135], a[88:91], v[168:171]
    v_add_u32 v16, s76, v15
    s_waitcnt vmcnt(36)
    v_mfma_f32_16x16x32_bf16 v[172:175], a[132:135], a[92:95], v[172:175]
    s_barrier
    s_waitcnt lgkmcnt(8)
    v_mfma_f32_16x16x32_bf16 v[176:179], a[136:139], a[80:83], v[176:179]
    ds_read_b64_tr_b16 a[128:129], v16 offset:0
    v_mfma_f32_16x16x32_bf16 v[180:183], a[136:139], a[84:87], v[180:183]
    ds_read_b64_tr_b16 a[130:131], v16 offset:3584
    v_mfma_f32_16x16x32_bf16 v[184:187], a[136:139], a[88:91], v[184:187]
    v_mfma_f32_16x16x32_bf16 v[188:191], a[136:139], a[92:95], v[188:191]
    s_waitcnt lgkmcnt(8)
    v_mfma_f32_16x16x32_bf16 v[192:195], a[140:143], a[80:83], v[192:195]
    ds_read_b64_tr_b16 a[132:133], v16 offset:32
    v_mfma_f32_16x16x32_bf16 v[196:199], a[140:143], a[84:87], v[196:199]
    ds_read_b64_tr_b16 a[134:135], v16 offset:3616
    v_mfma_f32_16x16x32_bf16 v[200:203], a[140:143], a[88:91], v[200:203]
    v_mfma_f32_16x16x32_bf16 v[204:207], a[140:143], a[92:95], v[204:207]
    s_waitcnt lgkmcnt(8)
    v_mfma_f32_16x16x32_bf16 v[208:211], a[144:147], a[80:83], v[208:211]
    ds_read_b64_tr_b16 a[136:137], v16 offset:64
    v_mfma_f32_16x16x32_bf16 v[212:215], a[144:147], a[84:87], v[212:215]
    ds_read_b64_tr_b16 a[138:139], v16 offset:3648
    v_mfma_f32_16x16x32_bf16 v[216:219], a[144:147], a[88:91], v[216:219]
    v_mfma_f32_16x16x32_bf16 v[220:223], a[144:147], a[92:95], v[220:223]
    s_waitcnt lgkmcnt(8)
    v_mfma_f32_16x16x32_bf16 v[224:227], a[148:151], a[80:83], v[224:227]
    ds_read_b64_tr_b16 a[140:141], v16 offset:96
    v_mfma_f32_16x16x32_bf16 v[228:231], a[148:151], a[84:87], v[228:231]
    ds_read_b64_tr_b16 a[142:143], v16 offset:3680
    v_mfma_f32_16x16x32_bf16 v[232:235], a[148:151], a[88:91], v[232:235]
    v_mfma_f32_16x16x32_bf16 v[236:239], a[148:151], a[92:95], v[236:239]
    s_waitcnt lgkmcnt(8)
    v_mfma_f32_16x16x32_bf16 v[240:243], a[152:155], a[80:83], v[240:243]
    ds_read_b64_tr_b16 a[144:145], v16 offset:128
    v_mfma_f32_16x16x32_bf16 v[244:247], a[152:155], a[84:87], v[244:247]
    ds_read_b64_tr_b16 a[146:147], v16 offset:3712
    v_mfma_f32_16x16x32_bf16 v[248:251], a[152:155], a[88:91], v[248:251]
    v_mfma_f32_16x16x32_bf16 v[252:255], a[152:155], a[92:95], v[252:255]
    s_waitcnt lgkmcnt(8)
    v_mfma_f32_16x16x32_bf16 v[32:35], a[128:131], a[96:99], v[32:35]
    ds_read_b64_tr_b16 a[148:149], v16 offset:160
    v_mfma_f32_16x16x32_bf16 v[36:39], a[128:131], a[100:103], v[36:39]
    ds_read_b64_tr_b16 a[150:151], v16 offset:3744
    s_add_u32 m0, s75, s74
    v_mfma_f32_16x16x32_bf16 v[40:43], a[128:131], a[104:107], v[40:43]
    buffer_load_dwordx4 v8, s[32:35], s77 offen offset:0  lds
    v_mfma_f32_16x16x32_bf16 v[44:47], a[128:131], a[108:111], v[44:47]
    s_waitcnt lgkmcnt(8)
    v_mfma_f32_16x16x32_bf16 v[48:51], a[132:135], a[96:99], v[48:51]
    ds_read_b64_tr_b16 a[152:153], v16 offset:192
    v_mfma_f32_16x16x32_bf16 v[52:55], a[132:135], a[100:103], v[52:55]
    ds_read_b64_tr_b16 a[154:155], v16 offset:3776
    v_mfma_f32_16x16x32_bf16 v[56:59], a[132:135], a[104:107], v[56:59]
    buffer_load_dwordx4 v9, s[32:35], s77 offen offset:1024  lds
    v_mfma_f32_16x16x32_bf16 v[60:63], a[132:135], a[108:111], v[60:63]
    s_waitcnt lgkmcnt(8)
    v_mfma_f32_16x16x32_bf16 v[64:67], a[136:139], a[96:99], v[64:67]
    ds_read_b64_tr_b16 a[128:129], v16 offset:14336
    v_mfma_f32_16x16x32_bf16 v[68:71], a[136:139], a[100:103], v[68:71]
    ds_read_b64_tr_b16 a[130:131], v16 offset:17920
    v_mfma_f32_16x16x32_bf16 v[72:75], a[136:139], a[104:107], v[72:75]
    buffer_load_dwordx4 v10, s[32:35], s77 offen offset:2048  lds
    v_mfma_f32_16x16x32_bf16 v[76:79], a[136:139], a[108:111], v[76:79]
    s_waitcnt lgkmcnt(8)
    v_mfma_f32_16x16x32_bf16 v[80:83], a[140:143], a[96:99], v[80:83]
    ds_read_b64_tr_b16 a[132:133], v16 offset:14368
    v_mfma_f32_16x16x32_bf16 v[84:87], a[140:143], a[100:103], v[84:87]
    ds_read_b64_tr_b16 a[134:135], v16 offset:17952
    v_mfma_f32_16x16x32_bf16 v[88:91], a[140:143], a[104:107], v[88:91]
    buffer_load_dwordx4 v11, s[32:35], s77 offen offset:3072  lds
    v_mfma_f32_16x16x32_bf16 v[92:95], a[140:143], a[108:111], v[92:95]
    s_waitcnt lgkmcnt(8)
    v_mfma_f32_16x16x32_bf16 v[96:99], a[144:147], a[96:99], v[96:99]
    ds_read_b64_tr_b16 a[136:137], v16 offset:14400
    s_add_u32 m0, m0, 4096
    v_mfma_f32_16x16x32_bf16 v[100:103], a[144:147], a[100:103], v[100:103]
    ds_read_b64_tr_b16 a[138:139], v16 offset:17984
    v_mfma_f32_16x16x32_bf16 v[104:107], a[144:147], a[104:107], v[104:107]
    buffer_load_dwordx4 v12, s[32:35], s77 offen offset:0  lds
    v_mfma_f32_16x16x32_bf16 v[108:111], a[144:147], a[108:111], v[108:111]
    s_waitcnt lgkmcnt(8)
    v_mfma_f32_16x16x32_bf16 v[112:115], a[148:151], a[96:99], v[112:115]
    ds_read_b64_tr_b16 a[140:141], v16 offset:14432
    v_mfma_f32_16x16x32_bf16 v[116:119], a[148:151], a[100:103], v[116:119]
    ds_read_b64_tr_b16 a[142:143], v16 offset:18016
    v_mfma_f32_16x16x32_bf16 v[120:123], a[148:151], a[104:107], v[120:123]
    buffer_load_dwordx4 v13, s[32:35], s77 offen offset:1024  lds
    v_mfma_f32_16x16x32_bf16 v[124:127], a[148:151], a[108:111], v[124:127]
    s_waitcnt lgkmcnt(8)
    v_mfma_f32_16x16x32_bf16 v[128:131], a[152:155], a[96:99], v[128:131]
    ds_read_b64_tr_b16 a[144:145], v16 offset:14464
    v_mfma_f32_16x16x32_bf16 v[132:135], a[152:155], a[100:103], v[132:135]
    ds_read_b64_tr_b16 a[146:147], v16 offset:18048
    v_mfma_f32_16x16x32_bf16 v[136:139], a[152:155], a[104:107], v[136:139]
    buffer_load_dwordx4 v14, s[32:35], s77 offen offset:2048  lds
    v_mfma_f32_16x16x32_bf16 v[140:143], a[152:155], a[108:111], v[140:143]
    s_waitcnt lgkmcnt(8)
    v_mfma_f32_16x16x32_bf16 v[144:147], a[128:131], a[96:99], v[144:147]
    ds_read_b64_tr_b16 a[148:149], v16 offset:14496
    v_mfma_f32_16x16x32_bf16 v[148:151], a[128:131], a[100:103], v[148:151]
    ds_read_b64_tr_b16 a[150:151], v16 offset:18080
    v_mfma_f32_16x16x32_bf16 v[152:155], a[128:131], a[104:107], v[152:155]
    buffer_load_dwordx4 a[64:67], v20, s[44:47], s78 offen offset:0 sc1
    v_mfma_f32_16x16x32_bf16 v[156:159], a[128:131], a[108:111], v[156:159]
    s_waitcnt lgkmcnt(8)
    v_mfma_f32_16x16x32_bf16 v[160:163], a[132:135], a[96:99], v[160:163]
    ds_read_b64_tr_b16 a[152:153], v16 offset:14528
    s_add_u32 s77, s77, 458752
    v_mfma_f32_16x16x32_bf16 v[164:167], a[132:135], a[100:103], v[164:167]
    ds_read_b64_tr_b16 a[154:155], v16 offset:18112
    v_mfma_f32_16x16x32_bf16 v[168:171], a[132:135], a[104:107], v[168:171]
    buffer_load_dwordx4 a[68:71], v21, s[44:47], s78 offen offset:0 sc1
    v_mfma_f32_16x16x32_bf16 v[172:175], a[132:135], a[108:111], v[172:175]
    s_waitcnt lgkmcnt(8)
    v_mfma_f32_16x16x32_bf16 v[176:179], a[136:139], a[96:99], v[176:179]
    ds_read_b64_tr_b16 a[128:129], v16 offset:7168
    s_add_u32 s75, s75, 28672
    v_mfma_f32_16x16x32_bf16 v[180:183], a[136:139], a[100:103], v[180:183]
    ds_read_b64_tr_b16 a[130:131], v16 offset:10752
    v_mfma_f32_16x16x32_bf16 v[184:187], a[136:139], a[104:107], v[184:187]
    buffer_load_dwordx4 a[72:75], v22, s[44:47], s78 offen offset:0 sc1
    v_mfma_f32_16x16x32_bf16 v[188:191], a[136:139], a[108:111], v[188:191]
    s_waitcnt lgkmcnt(8)
    v_mfma_f32_16x16x32_bf16 v[192:195], a[140:143], a[96:99], v[192:195]
    ds_read_b64_tr_b16 a[132:133], v16 offset:7200
    s_cmp_eq_u32 s75, 143360
    v_mfma_f32_16x16x32_bf16 v[196:199], a[140:143], a[100:103], v[196:199]
    ds_read_b64_tr_b16 a[134:135], v16 offset:10784
    v_mfma_f32_16x16x32_bf16 v[200:203], a[140:143], a[104:107], v[200:203]
    buffer_load_dwordx4 a[76:79], v23, s[44:47], s78 offen offset:0 sc1
    v_mfma_f32_16x16x32_bf16 v[204:207], a[140:143], a[108:111], v[204:207]
    s_waitcnt lgkmcnt(8)
    v_mfma_f32_16x16x32_bf16 v[208:211], a[144:147], a[96:99], v[208:211]
    ds_read_b64_tr_b16 a[136:137], v16 offset:7232
    s_cselect_b32 s75, 0, s75
    v_mfma_f32_16x16x32_bf16 v[212:215], a[144:147], a[100:103], v[212:215]
    ds_read_b64_tr_b16 a[138:139], v16 offset:10816
    v_mfma_f32_16x16x32_bf16 v[216:219], a[144:147], a[104:107], v[216:219]
    buffer_load_dwordx4 a[80:83], v20, s[44:47], s78 offen offset:1024 sc1
    v_mfma_f32_16x16x32_bf16 v[220:223], a[144:147], a[108:111], v[220:223]
    s_waitcnt lgkmcnt(8)
    v_mfma_f32_16x16x32_bf16 v[224:227], a[148:151], a[96:99], v[224:227]
    ds_read_b64_tr_b16 a[140:141], v16 offset:7264
    s_cmp_eq_u32 s92, 0
    v_mfma_f32_16x16x32_bf16 v[228:231], a[148:151], a[100:103], v[228:231]
    ds_read_b64_tr_b16 a[142:143], v16 offset:10848
    v_mfma_f32_16x16x32_bf16 v[232:235], a[148:151], a[104:107], v[232:235]
    buffer_load_dwordx4 a[84:87], v21, s[44:47], s78 offen offset:1024 sc1
    v_mfma_f32_16x16x32_bf16 v[236:239], a[148:151], a[108:111], v[236:239]
    s_waitcnt lgkmcnt(8)
    v_mfma_f32_16x16x32_bf16 v[240:243], a[152:155], a[96:99], v[240:243]
    ds_read_b64_tr_b16 a[144:145], v16 offset:7296
    s_cselect_b32 s50, 7340032, 0
    v_mfma_f32_16x16x32_bf16 v[244:247], a[152:155], a[100:103], v[244:247]
    ds_read_b64_tr_b16 a[146:147], v16 offset:10880
    v_mfma_f32_16x16x32_bf16 v[248:251], a[152:155], a[104:107], v[248:251]
    buffer_load_dwordx4 a[88:91], v22, s[44:47], s78 offen offset:1024 sc1
    v_mfma_f32_16x16x32_bf16 v[252:255], a[152:155], a[108:111], v[252:255]
    s_waitcnt lgkmcnt(8)
    v_mfma_f32_16x16x32_bf16 v[32:35], a[128:131], a[112:115], v[32:35]
    ds_read_b64_tr_b16 a[148:149], v16 offset:7328
    s_cselect_b32 s42, 7340032, 0
    v_mfma_f32_16x16x32_bf16 v[36:39], a[128:131], a[116:119], v[36:39]
    ds_read_b64_tr_b16 a[150:151], v16 offset:10912
    v_mfma_f32_16x16x32_bf16 v[40:43], a[128:131], a[120:123], v[40:43]
    buffer_load_dwordx4 a[92:95], v23, s[44:47], s78 offen offset:1024 sc1
    v_mfma_f32_16x16x32_bf16 v[44:47], a[128:131], a[124:127], v[44:47]
    s_waitcnt lgkmcnt(8)
    v_mfma_f32_16x16x32_bf16 v[48:51], a[132:135], a[112:115], v[48:51]
    ds_read_b64_tr_b16 a[152:153], v16 offset:7360
    v_mfma_f32_16x16x32_bf16 v[52:55], a[132:135], a[116:119], v[52:55]
    ds_read_b64_tr_b16 a[154:155], v16 offset:10944
    v_mfma_f32_16x16x32_bf16 v[56:59], a[132:135], a[120:123], v[56:59]
    buffer_load_dword v7, v30, s[48:51], 0 offen
    v_mfma_f32_16x16x32_bf16 v[60:63], a[132:135], a[124:127], v[60:63]
    s_waitcnt lgkmcnt(8)
    v_mfma_f32_16x16x32_bf16 v[64:67], a[136:139], a[112:115], v[64:67]
    ds_read_b64_tr_b16 a[128:129], v16 offset:21504
    s_add_u32 s78, s78, 2048
    v_mfma_f32_16x16x32_bf16 v[68:71], a[136:139], a[116:119], v[68:71]
    ds_read_b64_tr_b16 a[130:131], v16 offset:25088
    v_mfma_f32_16x16x32_bf16 v[72:75], a[136:139], a[120:123], v[72:75]
    buffer_load_dword v7, v31, s[40:43], 0 offen
    v_mfma_f32_16x16x32_bf16 v[76:79], a[136:139], a[124:127], v[76:79]
    s_waitcnt lgkmcnt(8)
    v_mfma_f32_16x16x32_bf16 v[80:83], a[140:143], a[112:115], v[80:83]
    ds_read_b64_tr_b16 a[132:133], v16 offset:21536
    v_add_u32 v30, -1966080, v30
    v_mfma_f32_16x16x32_bf16 v[84:87], a[140:143], a[116:119], v[84:87]
    ds_read_b64_tr_b16 a[134:135], v16 offset:25120
    v_mfma_f32_16x16x32_bf16 v[88:91], a[140:143], a[120:123], v[88:91]
    v_mfma_f32_16x16x32_bf16 v[92:95], a[140:143], a[124:127], v[92:95]
    s_waitcnt lgkmcnt(8)
    v_mfma_f32_16x16x32_bf16 v[96:99], a[144:147], a[112:115], v[96:99]
    ds_read_b64_tr_b16 a[136:137], v16 offset:21568
    v_add_u32 v31, 917504, v31
    v_mfma_f32_16x16x32_bf16 v[100:103], a[144:147], a[116:119], v[100:103]
    ds_read_b64_tr_b16 a[138:139], v16 offset:25152
    v_mfma_f32_16x16x32_bf16 v[104:107], a[144:147], a[120:123], v[104:107]
    v_mfma_f32_16x16x32_bf16 v[108:111], a[144:147], a[124:127], v[108:111]
    s_waitcnt lgkmcnt(8)
    v_mfma_f32_16x16x32_bf16 v[112:115], a[148:151], a[112:115], v[112:115]
    ds_read_b64_tr_b16 a[140:141], v16 offset:21600
    s_add_u32 s76, s76, 28672
    v_mfma_f32_16x16x32_bf16 v[116:119], a[148:151], a[116:119], v[116:119]
    ds_read_b64_tr_b16 a[142:143], v16 offset:25184
    v_mfma_f32_16x16x32_bf16 v[120:123], a[148:151], a[120:123], v[120:123]
    v_mfma_f32_16x16x32_bf16 v[124:127], a[148:151], a[124:127], v[124:127]
    s_waitcnt lgkmcnt(8)
    v_mfma_f32_16x16x32_bf16 v[128:131], a[152:155], a[112:115], v[128:131]
    ds_read_b64_tr_b16 a[144:145], v16 offset:21632
    s_cmp_eq_u32 s76, 143360
    v_mfma_f32_16x16x32_bf16 v[132:135], a[152:155], a[116:119], v[132:135]
    ds_read_b64_tr_b16 a[146:147], v16 offset:25216
    v_mfma_f32_16x16x32_bf16 v[136:139], a[152:155], a[120:123], v[136:139]
    v_mfma_f32_16x16x32_bf16 v[140:143], a[152:155], a[124:127], v[140:143]
    s_waitcnt lgkmcnt(8)
    v_mfma_f32_16x16x32_bf16 v[144:147], a[128:131], a[112:115], v[144:147]
    ds_read_b64_tr_b16 a[148:149], v16 offset:21664
    s_cselect_b32 s76, 0, s76
    v_mfma_f32_16x16x32_bf16 v[148:151], a[128:131], a[116:119], v[148:151]
    ds_read_b64_tr_b16 a[150:151], v16 offset:25248
    v_mfma_f32_16x16x32_bf16 v[152:155], a[128:131], a[120:123], v[152:155]
    v_mfma_f32_16x16x32_bf16 v[156:159], a[128:131], a[124:127], v[156:159]
    s_waitcnt lgkmcnt(8)
    v_mfma_f32_16x16x32_bf16 v[160:163], a[132:135], a[112:115], v[160:163]
    ds_read_b64_tr_b16 a[152:153], v16 offset:21696
    v_mfma_f32_16x16x32_bf16 v[164:167], a[132:135], a[116:119], v[164:167]
    ds_read_b64_tr_b16 a[154:155], v16 offset:25280
    v_mfma_f32_16x16x32_bf16 v[168:171], a[132:135], a[120:123], v[168:171]
    v_add_u32 v16, s76, v15
    s_waitcnt vmcnt(36)
    v_mfma_f32_16x16x32_bf16 v[172:175], a[132:135], a[124:127], v[172:175]
    s_barrier
    s_waitcnt lgkmcnt(8)
    v_mfma_f32_16x16x32_bf16 v[176:179], a[136:139], a[112:115], v[176:179]
    ds_read_b64_tr_b16 a[128:129], v16 offset:0
    v_mfma_f32_16x16x32_bf16 v[180:183], a[136:139], a[116:119], v[180:183]
    ds_read_b64_tr_b16 a[130:131], v16 offset:3584
    v_mfma_f32_16x16x32_bf16 v[184:187], a[136:139], a[120:123], v[184:187]
    s_sub_u32 s80, s80, 1
    v_mfma_f32_16x16x32_bf16 v[188:191], a[136:139], a[124:127], v[188:191]
    s_waitcnt lgkmcnt(8)
    v_mfma_f32_16x16x32_bf16 v[192:195], a[140:143], a[112:115], v[192:195]
    ds_read_b64_tr_b16 a[132:133], v16 offset:32
    v_mfma_f32_16x16x32_bf16 v[196:199], a[140:143], a[116:119], v[196:199]
    ds_read_b64_tr_b16 a[134:135], v16 offset:3616
    v_mfma_f32_16x16x32_bf16 v[200:203], a[140:143], a[120:123], v[200:203]
    v_mfma_f32_16x16x32_bf16 v[204:207], a[140:143], a[124:127], v[204:207]
    s_waitcnt lgkmcnt(8)
    v_mfma_f32_16x16x32_bf16 v[208:211], a[144:147], a[112:115], v[208:211]
    ds_read_b64_tr_b16 a[136:137], v16 offset:64
    v_mfma_f32_16x16x32_bf16 v[212:215], a[144:147], a[116:119], v[212:215]
    ds_read_b64_tr_b16 a[138:139], v16 offset:3648
    v_mfma_f32_16x16x32_bf16 v[216:219], a[144:147], a[120:123], v[216:219]
    v_mfma_f32_16x16x32_bf16 v[220:223], a[144:147], a[124:127], v[220:223]
    s_waitcnt lgkmcnt(8)
    v_mfma_f32_16x16x32_bf16 v[224:227], a[148:151], a[112:115], v[224:227]
    ds_read_b64_tr_b16 a[140:141], v16 offset:96
    v_mfma_f32_16x16x32_bf16 v[228:231], a[148:151], a[116:119], v[228:231]
    ds_read_b64_tr_b16 a[142:143], v16 offset:3680
    v_mfma_f32_16x16x32_bf16 v[232:235], a[148:151], a[120:123], v[232:235]
    s_cmp_lg_u32 s80, 0
    v_mfma_f32_16x16x32_bf16 v[236:239], a[148:151], a[124:127], v[236:239]
    s_waitcnt lgkmcnt(8)
    v_mfma_f32_16x16x32_bf16 v[240:243], a[152:155], a[112:115], v[240:243]
    ds_read_b64_tr_b16 a[144:145], v16 offset:128
    v_mfma_f32_16x16x32_bf16 v[244:247], a[152:155], a[116:119], v[244:247]
    ds_read_b64_tr_b16 a[146:147], v16 offset:3712
    v_mfma_f32_16x16x32_bf16 v[248:251], a[152:155], a[120:123], v[248:251]
    v_mfma_f32_16x16x32_bf16 v[252:255], a[152:155], a[124:127], v[252:255]
    s_waitcnt lgkmcnt(8)
    s_cbranch_scc1 L_g1_1019
L_g1tail:
    s_mov_b32 s50, 7340032
    v_mfma_f32_16x16x32_bf16 v[32:35], a[128:131], a[0:3], v[32:35]
    ds_read_b64_tr_b16 a[148:149], v16 offset:160
    v_mfma_f32_16x16x32_bf16 v[36:39], a[128:131], a[4:7], v[36:39]
    ds_read_b64_tr_b16 a[150:151], v16 offset:3744
    s_add_u32 m0, s75, s74
    v_mfma_f32_16x16x32_bf16 v[40:43], a[128:131], a[8:11], v[40:43]
    buffer_load_dwordx4 v8, s[32:35], s77 offen offset:0  lds
    v_mfma_f32_16x16x32_bf16 v[44:47], a[128:131], a[12:15], v[44:47]
    s_waitcnt lgkmcnt(8)
    v_mfma_f32_16x16x32_bf16 v[48:51], a[132:135], a[0:3], v[48:51]
    ds_read_b64_tr_b16 a[152:153], v16 offset:192
    v_mfma_f32_16x16x32_bf16 v[52:55], a[132:135], a[4:7], v[52:55]
    ds_read_b64_tr_b16 a[154:155], v16 offset:3776
    v_mfma_f32_16x16x32_bf16 v[56:59], a[132:135], a[8:11], v[56:59]
    buffer_load_dwordx4 v9, s[32:35], s77 offen offset:1024  lds
    v_mfma_f32_16x16x32_bf16 v[60:63], a[132:135], a[12:15], v[60:63]
    s_waitcnt lgkmcnt(8)
    v_mfma_f32_16x16x32_bf16 v[64:67], a[136:139], a[0:3], v[64:67]
    ds_read_b64_tr_b16 a[128:129], v16 offset:14336
    v_mfma_f32_16x16x32_bf16 v[68:71], a[136:139], a[4:7], v[68:71]
    ds_read_b64_tr_b16 a[130:131], v16 offset:17920
    v_mfma_f32_16x16x32_bf16 v[72:75], a[136:139], a[8:11], v[72:75]
    buffer_load_dwordx4 v10, s[32:35], s77 offen offset:2048  lds
    v_mfma_f32_16x16x32_bf16 v[76:79], a[136:139], a[12:15], v[76:79]
    s_waitcnt lgkmcnt(8)
    v_mfma_f32_16x16x32_bf16 v[80:83], a[140:143], a[0:3], v[80:83]
    ds_read_b64_tr_b16 a[132:133], v16 offset:14368
    v_mfma_f32_16x16x32_bf16 v[84:87], a[140:143], a[4:7], v[84:87]
    ds_read_b64_tr_b16 a[134:135], v16 offset:17952
    v_mfma_f32_16x16x32_bf16 v[88:91], a[140:143], a[8:11], v[88:91]
    buffer_load_dwordx4 v11, s[32:35], s77 offen offset:3072  lds
    v_mfma_f32_16x16x32_bf16 v[92:95], a[140:143], a[12:15], v[92:95]
    s_waitcnt lgkmcnt(8)
    v_mfma_f32_16x16x32_bf16 v[96:99], a[144:147], a[0:3], v[96:99]
    ds_read_b64_tr_b16 a[136:137], v16 offset:14400
    s_add_u32 m0, m0, 4096
    v_mfma_f32_16x16x32_bf16 v[100:103], a[144:147], a[4:7], v[100:103]
    ds_read_b64_tr_b16 a[138:139], v16 offset:17984
    v_mfma_f32_16x16x32_bf16 v[104:107], a[144:147], a[8:11], v[104:107]
    buffer_load_dwordx4 v12, s[32:35], s77 offen offset:0  lds
    v_mfma_f32_16x16x32_bf16 v[108:111], a[144:147], a[12:15], v[108:111]
    s_waitcnt lgkmcnt(8)
    v_mfma_f32_16x16x32_bf16 v[112:115], a[148:151], a[0:3], v[112:115]
    ds_read_b64_tr_b16 a[140:141], v16 offset:14432
    v_mfma_f32_16x16x32_bf16 v[116:119], a[148:151], a[4:7], v[116:119]
    ds_read_b64_tr_b16 a[142:143], v16 offset:18016
    v_mfma_f32_16x16x32_bf16 v[120:123], a[148:151], a[8:11], v[120:123]
    buffer_load_dwordx4 v13, s[32:35], s77 offen offset:1024  lds
    v_mfma_f32_16x16x32_bf16 v[124:127], a[148:151], a[12:15], v[124:127]
    s_waitcnt lgkmcnt(8)
    v_mfma_f32_16x16x32_bf16 v[128:131], a[152:155], a[0:3], v[128:131]
    ds_read_b64_tr_b16 a[144:145], v16 offset:14464
    v_mfma_f32_16x16x32_bf16 v[132:135], a[152:155], a[4:7], v[132:135]
    ds_read_b64_tr_b16 a[146:147], v16 offset:18048
    v_mfma_f32_16x16x32_bf16 v[136:139], a[152:155], a[8:11], v[136:139]
    buffer_load_dwordx4 v14, s[32:35], s77 offen offset:2048  lds
    v_mfma_f32_16x16x32_bf16 v[140:143], a[152:155], a[12:15], v[140:143]
    s_waitcnt lgkmcnt(8)
    v_mfma_f32_16x16x32_bf16 v[144:147], a[128:131], a[0:3], v[144:147]
    ds_read_b64_tr_b16 a[148:149], v16 offset:14496
    v_mfma_f32_16x16x32_bf16 v[148:151], a[128:131], a[4:7], v[148:151]
    ds_read_b64_tr_b16 a[150:151], v16 offset:18080
    v_mfma_f32_16x16x32_bf16 v[152:155], a[128:131], a[8:11], v[152:155]
    buffer_load_dwordx4 a[96:99], v20, s[44:47], s78 offen offset:0 sc1
    v_mfma_f32_16x16x32_bf16 v[156:159], a[128:131], a[12:15], v[156:159]
    s_waitcnt lgkmcnt(8)
    v_mfma_f32_16x16x32_bf16 v[160:163], a[132:135], a[0:3], v[160:163]
    ds_read_b64_tr_b16 a[152:153], v16 offset:14528
    s_add_u32 s77, s77, 458752
    v_mfma_f32_16x16x32_bf16 v[164:167], a[132:135], a[4:7], v[164:167]
    ds_read_b64_tr_b16 a[154:155], v16 offset:18112
    v_mfma_f32_16x16x32_bf16 v[168:171], a[132:135], a[8:11], v[168:171]
    buffer_load_dwordx4 a[100:103], v21, s[44:47], s78 offen offset:0 sc1
    v_mfma_f32_16x16x32_bf16 v[172:175], a[132:135], a[12:15], v[172:175]
    s_waitcnt lgkmcnt(8)
    v_mfma_f32_16x16x32_bf16 v[176:179], a[136:139], a[0:3], v[176:179]
    ds_read_b64_tr_b16 a[128:129], v16 offset:7168
    s_add_u32 s75, s75, 28672
    v_mfma_f32_16x16x32_bf16 v[180:183], a[136:139], a[4:7], v[180:183]
    ds_read_b64_tr_b16 a[130:131], v16 offset:10752
    v_mfma_f32_16x16x32_bf16 v[184:187], a[136:139], a[8:11], v[184:187]
    buffer_load_dwordx4 a[104:107], v22, s[44:47], s78 offen offset:0 sc1
    v_mfma_f32_16x16x32_bf16 v[188:191], a[136:139], a[12:15], v[188:191]
    s_waitcnt lgkmcnt(8)
    v_mfma_f32_16x16x32_bf16 v[192:195], a[140:143], a[0:3], v[192:195]
    ds_read_b64_tr_b16 a[132:133], v16 offset:7200
    s_cmp_eq_u32 s75, 143360
    v_mfma_f32_16x16x32_bf16 v[196:199], a[140:143], a[4:7], v[196:199]
    ds_read_b64_tr_b16 a[134:135], v16 offset:10784
    v_mfma_f32_16x16x32_bf16 v[200:203], a[140:143], a[8:11], v[200:203]
    buffer_load_dwordx4 a[108:111], v23, s[44:47], s78 offen offset:0 sc1
    v_mfma_f32_16x16x32_bf16 v[204:207], a[140:143], a[12:15], v[204:207]
    s_waitcnt lgkmcnt(8)
    v_mfma_f32_16x16x32_bf16 v[208:211], a[144:147], a[0:3], v[208:211]
    ds_read_b64_tr_b16 a[136:137], v16 offset:7232
    s_cselect_b32 s75, 0, s75
    v_mfma_f32_16x16x32_bf16 v[212:215], a[144:147], a[4:7], v[212:215]
    ds_read_b64_tr_b16 a[138:139], v16 offset:10816
    v_mfma_f32_16x16x32_bf16 v[216:219], a[144:147], a[8:11], v[216:219]
    buffer_load_dwordx4 a[112:115], v20, s[44:47], s78 offen offset:1024 sc1
    v_mfma_f32_16x16x32_bf16 v[220:223], a[144:147], a[12:15], v[220:223]
    s_waitcnt lgkmcnt(8)
    v_mfma_f32_16x16x32_bf16 v[224:227], a[148:151], a[0:3], v[224:227]
    ds_read_b64_tr_b16 a[140:141], v16 offset:7264
    v_mfma_f32_16x16x32_bf16 v[228:231], a[148:151], a[4:7], v[228:231]
    ds_read_b64_tr_b16 a[142:143], v16 offset:10848
    v_mfma_f32_16x16x32_bf16 v[232:235], a[148:151], a[8:11], v[232:235]
    buffer_load_dwordx4 a[116:119], v21, s[44:47], s78 offen offset:1024 sc1
    v_mfma_f32_16x16x32_bf16 v[236:239], a[148:151], a[12:15], v[236:239]
    s_waitcnt lgkmcnt(8)
    v_mfma_f32_16x16x32_bf16 v[240:243], a[152:155], a[0:3], v[240:243]
    ds_read_b64_tr_b16 a[144:145], v16 offset:7296
    v_mfma_f32_16x16x32_bf16 v[244:247], a[152:155], a[4:7], v[244:247]
    ds_read_b64_tr_b16 a[146:147], v16 offset:10880
    v_mfma_f32_16x16x32_bf16 v[248:251], a[152:155], a[8:11], v[248:251]
    buffer_load_dwordx4 a[120:123], v22, s[44:47], s78 offen offset:1024 sc1
    v_mfma_f32_16x16x32_bf16 v[252:255], a[152:155], a[12:15], v[252:255]
    s_waitcnt lgkmcnt(8)
    v_mfma_f32_16x16x32_bf16 v[32:35], a[128:131], a[16:19], v[32:35]
    ds_read_b64_tr_b16 a[148:149], v16 offset:7328
    v_mfma_f32_16x16x32_bf16 v[36:39], a[128:131], a[20:23], v[36:39]
    ds_read_b64_tr_b16 a[150:151], v16 offset:10912
    v_mfma_f32_16x16x32_bf16 v[40:43], a[128:131], a[24:27], v[40:43]
    buffer_load_dwordx4 a[124:127], v23, s[44:47], s78 offen offset:1024 sc1
    v_mfma_f32_16x16x32_bf16 v[44:47], a[128:131], a[28:31], v[44:47]
    s_waitcnt lgkmcnt(8)
    v_mfma_f32_16x16x32_bf16 v[48:51], a[132:135], a[16:19], v[48:51]
    ds_read_b64_tr_b16 a[152:153], v16 offset:7360
    v_mfma_f32_16x16x32_bf16 v[52:55], a[132:135], a[20:23], v[52:55]
    ds_read_b64_tr_b16 a[154:155], v16 offset:10944
    v_mfma_f32_16x16x32_bf16 v[56:59], a[132:135], a[24:27], v[56:59]
    v_mfma_f32_16x16x32_bf16 v[60:63], a[132:135], a[28:31], v[60:63]
    s_waitcnt lgkmcnt(8)
    v_mfma_f32_16x16x32_bf16 v[64:67], a[136:139], a[16:19], v[64:67]
    ds_read_b64_tr_b16 a[128:129], v16 offset:21504
    s_add_u32 s78, s78, 2048
    v_mfma_f32_16x16x32_bf16 v[68:71], a[136:139], a[20:23], v[68:71]
    ds_read_b64_tr_b16 a[130:131], v16 offset:25088
    v_mfma_f32_16x16x32_bf16 v[72:75], a[136:139], a[24:27], v[72:75]
    v_mfma_f32_16x16x32_bf16 v[76:79], a[136:139], a[28:31], v[76:79]
    s_waitcnt lgkmcnt(8)
    v_mfma_f32_16x16x32_bf16 v[80:83], a[140:143], a[16:19], v[80:83]
    ds_read_b64_tr_b16 a[132:133], v16 offset:21536
    v_mfma_f32_16x16x32_bf16 v[84:87], a[140:143], a[20:23], v[84:87]
    ds_read_b64_tr_b16 a[134:135], v16 offset:25120
    v_mfma_f32_16x16x32_bf16 v[88:91], a[140:143], a[24:27], v[88:91]
    v_mfma_f32_16x16x32_bf16 v[92:95], a[140:143], a[28:31], v[92:95]
    s_waitcnt lgkmcnt(8)
    v_mfma_f32_16x16x32_bf16 v[96:99], a[144:147], a[16:19], v[96:99]
    ds_read_b64_tr_b16 a[136:137], v16 offset:21568
    v_mfma_f32_16x16x32_bf16 v[100:103], a[144:147], a[20:23], v[100:103]
    ds_read_b64_tr_b16 a[138:139], v16 offset:25152
    v_mfma_f32_16x16x32_bf16 v[104:107], a[144:147], a[24:27], v[104:107]
    v_mfma_f32_16x16x32_bf16 v[108:111], a[144:147], a[28:31], v[108:111]
    s_waitcnt lgkmcnt(8)
    v_mfma_f32_16x16x32_bf16 v[112:115], a[148:151], a[16:19], v[112:115]
    ds_read_b64_tr_b16 a[140:141], v16 offset:21600
    s_add_u32 s76, s76, 28672
    v_mfma_f32_16x16x32_bf16 v[116:119], a[148:151], a[20:23], v[116:119]
    ds_read_b64_tr_b16 a[142:143], v16 offset:25184
    v_mfma_f32_16x16x32_bf16 v[120:123], a[148:151], a[24:27], v[120:123]
    v_mfma_f32_16x16x32_bf16 v[124:127], a[148:151], a[28:31], v[124:127]
    s_waitcnt lgkmcnt(8)
    v_mfma_f32_16x16x32_bf16 v[128:131], a[152:155], a[16:19], v[128:131]
    ds_read_b64_tr_b16 a[144:145], v16 offset:21632
    s_cmp_eq_u32 s76, 143360
    v_mfma_f32_16x16x32_bf16 v[132:135], a[152:155], a[20:23], v[132:135]
    ds_read_b64_tr_b16 a[146:147], v16 offset:25216
    v_mfma_f32_16x16x32_bf16 v[136:139], a[152:155], a[24:27], v[136:139]
    v_mfma_f32_16x16x32_bf16 v[140:143], a[152:155], a[28:31], v[140:143]
    s_waitcnt lgkmcnt(8)
    v_mfma_f32_16x16x32_bf16 v[144:147], a[128:131], a[16:19], v[144:147]
    ds_read_b64_tr_b16 a[148:149], v16 offset:21664
    s_cselect_b32 s76, 0, s76
    v_mfma_f32_16x16x32_bf16 v[148:151], a[128:131], a[20:23], v[148:151]
    ds_read_b64_tr_b16 a[150:151], v16 offset:25248
    v_mfma_f32_16x16x32_bf16 v[152:155], a[128:131], a[24:27], v[152:155]
    v_mfma_f32_16x16x32_bf16 v[156:159], a[128:131], a[28:31], v[156:159]
    s_waitcnt lgkmcnt(8)
    v_mfma_f32_16x16x32_bf16 v[160:163], a[132:135], a[16:19], v[160:163]
    ds_read_b64_tr_b16 a[152:153], v16 offset:21696
    v_mfma_f32_16x16x32_bf16 v[164:167], a[132:135], a[20:23], v[164:167]
    ds_read_b64_tr_b16 a[154:155], v16 offset:25280
    v_mfma_f32_16x16x32_bf16 v[168:171], a[132:135], a[24:27], v[168:171]
    v_add_u32 v16, s76, v15
    s_waitcnt vmcnt(17)
    v_mfma_f32_16x16x32_bf16 v[172:175], a[132:135], a[28:31], v[172:175]
    s_barrier
    s_waitcnt lgkmcnt(8)
    v_mfma_f32_16x16x32_bf16 v[176:179], a[136:139], a[16:19], v[176:179]
    ds_read_b64_tr_b16 a[128:129], v16 offset:0
    v_mfma_f32_16x16x32_bf16 v[180:183], a[136:139], a[20:23], v[180:183]
    ds_read_b64_tr_b16 a[130:131], v16 offset:3584
    v_mfma_f32_16x16x32_bf16 v[184:187], a[136:139], a[24:27], v[184:187]
    v_mfma_f32_16x16x32_bf16 v[188:191], a[136:139], a[28:31], v[188:191]
    s_waitcnt lgkmcnt(8)
    v_mfma_f32_16x16x32_bf16 v[192:195], a[140:143], a[16:19], v[192:195]
    ds_read_b64_tr_b16 a[132:133], v16 offset:14336
    v_mfma_f32_16x16x32_bf16 v[196:199], a[140:143], a[20:23], v[196:199]
    ds_read_b64_tr_b16 a[134:135], v16 offset:17920
    v_mfma_f32_16x16x32_bf16 v[200:203], a[140:143], a[24:27], v[200:203]
    v_mfma_f32_16x16x32_bf16 v[204:207], a[140:143], a[28:31], v[204:207]
    s_waitcnt lgkmcnt(8)
    v_mfma_f32_16x16x32_bf16 v[208:211], a[144:147], a[16:19], v[208:211]
    ds_read_b64_tr_b16 a[136:137], v16 offset:7168
    v_mfma_f32_16x16x32_bf16 v[212:215], a[144:147], a[20:23], v[212:215]
    ds_read_b64_tr_b16 a[138:139], v16 offset:10752
    v_mfma_f32_16x16x32_bf16 v[216:219], a[144:147], a[24:27], v[216:219]
    v_mfma_f32_16x16x32_bf16 v[220:223], a[144:147], a[28:31], v[220:223]
    s_waitcnt lgkmcnt(8)
    v_mfma_f32_16x16x32_bf16 v[224:227], a[148:151], a[16:19], v[224:227]
    ds_read_b64_tr_b16 a[140:141], v16 offset:21504
    v_mfma_f32_16x16x32_bf16 v[228:231], a[148:151], a[20:23], v[228:231]
    ds_read_b64_tr_b16 a[142:143], v16 offset:25088
    v_mfma_f32_16x16x32_bf16 v[232:235], a[148:151], a[24:27], v[232:235]
    v_mfma_f32_16x16x32_bf16 v[236:239], a[148:151], a[28:31], v[236:239]
    s_waitcnt lgkmcnt(8)
    v_mfma_f32_16x16x32_bf16 v[240:243], a[152:155], a[16:19], v[240:243]
    ds_read_b64_tr_b16 a[144:145], v16 offset:28672
    v_mfma_f32_16x16x32_bf16 v[244:247], a[152:155], a[20:23], v[244:247]
    ds_read_b64_tr_b16 a[146:147], v16 offset:32256
    v_mfma_f32_16x16x32_bf16 v[248:251], a[152:155], a[24:27], v[248:251]
    v_mfma_f32_16x16x32_bf16 v[252:255], a[152:155], a[28:31], v[252:255]
    s_waitcnt lgkmcnt(8)
    v_mfma_f32_16x16x32_bf16 v[32:35], a[128:131], a[32:35], v[32:35]
    ds_read_b64_tr_b16 a[148:149], v16 offset:43008
    v_add_u32 v8, 0, v25
    v_mfma_f32_16x16x32_bf16 v[36:39], a[128:131], a[36:39], v[36:39]
    ds_read_b64_tr_b16 a[150:151], v16 offset:46592
    v_add_u32 v9, 31744, v25
    v_mfma_f32_16x16x32_bf16 v[40:43], a[128:131], a[40:43], v[40:43]
    v_add_u32 v10, 6144, v25
    v_add_u32 v11, 37888, v25
    v_mfma_f32_16x16x32_bf16 v[44:47], a[128:131], a[44:47], v[44:47]
    s_waitcnt lgkmcnt(8)
    v_mov_b32 v17, v15
    v_mfma_f32_16x16x32_bf16 v[144:147], a[132:135], a[32:35], v[144:147]
    ds_read_b64_tr_b16 a[152:153], v16 offset:35840
    v_accvgpr_read_b32 v4, a186
    v_mfma_f32_16x16x32_bf16 v[148:151], a[132:135], a[36:39], v[148:151]
    ds_read_b64_tr_b16 a[154:155], v16 offset:39424
    s_mul_i32 s58, s73, 114688
    v_mfma_f32_16x16x32_bf16 v[152:155], a[132:135], a[40:43], v[152:155]
    s_mul_i32 s59, s72, 7
    s_add_u32 s60, s59, 1
    v_mfma_f32_16x16x32_bf16 v[156:159], a[132:135], a[44:47], v[156:159]
    s_waitcnt lgkmcnt(8)
    s_lshr_b32 s60, s60, 1
    v_mfma_f32_16x16x32_bf16 v[32:35], a[136:139], a[48:51], v[32:35]
    ds_read_b64_tr_b16 a[128:129], v16 offset:50176
    s_lshl_b32 s60, s60, 10
    v_mfma_f32_16x16x32_bf16 v[36:39], a[136:139], a[52:55], v[36:39]
    ds_read_b64_tr_b16 a[130:131], v16 offset:53760
    s_add_u32 s60, s60, s58
    v_mfma_f32_16x16x32_bf16 v[40:43], a[136:139], a[56:59], v[40:43]
    s_and_b32 s61, s72, 1
    s_mov_b32 s62, 3072
    v_mfma_f32_16x16x32_bf16 v[44:47], a[136:139], a[60:63], v[44:47]
    s_barrier
    s_waitcnt lgkmcnt(8)
    v_mfma_f32_16x16x32_bf16 v[144:147], a[140:143], a[48:51], v[144:147]
    ds_read_b64_tr_b16 a[132:133], v16 offset:32
    s_cmp_eq_u32 s61, 1
    s_cselect_b32 s62, -512, s62
    v_mfma_f32_16x16x32_bf16 v[148:151], a[140:143], a[52:55], v[148:151]
    ds_read_b64_tr_b16 a[134:135], v16 offset:3616
    s_add_u32 m0, s88, 28672
    v_mfma_f32_16x16x32_bf16 v[152:155], a[140:143], a[56:59], v[152:155]
    buffer_load_dwordx4 v8, s[48:51], s89 offen offset:0  lds
    s_add_u32 s62, s62, s60
    v_mfma_f32_16x16x32_bf16 v[156:159], a[140:143], a[60:63], v[156:159]
    s_waitcnt lgkmcnt(8)
    v_accvgpr_read_b32 v20, a192
    v_mfma_f32_16x16x32_bf16 v[32:35], a[144:147], a[64:67], v[32:35]
    ds_read_b64_tr_b16 a[136:137], v16 offset:14368
    v_accvgpr_read_b32 v21, a193
    v_mfma_f32_16x16x32_bf16 v[36:39], a[144:147], a[68:71], v[36:39]
    ds_read_b64_tr_b16 a[138:139], v16 offset:17952
    v_accvgpr_read_b32 v23, a194
    v_mfma_f32_16x16x32_bf16 v[40:43], a[144:147], a[72:75], v[40:43]
    buffer_load_dwordx4 v9, s[48:51], s89 offen offset:1024  lds
    v_accvgpr_read_b32 v25, a195
    v_mfma_f32_16x16x32_bf16 v[44:47], a[144:147], a[76:79], v[44:47]
    s_waitcnt lgkmcnt(8)
    v_accvgpr_read_b32 v5, a196
    v_mfma_f32_16x16x32_bf16 v[144:147], a[148:151], a[64:67], v[144:147]
    ds_read_b64_tr_b16 a[140:141], v16 offset:7200
    v_accvgpr_read_b32 v30, a197
    v_mfma_f32_16x16x32_bf16 v[148:151], a[148:151], a[68:71], v[148:151]
    ds_read_b64_tr_b16 a[142:143], v16 offset:10784
    v_bfe_u32 v22, v2, 3, 1
    v_mfma_f32_16x16x32_bf16 v[152:155], a[148:151], a[72:75], v[152:155]
    buffer_load_dwordx4 v10, s[48:51], s89 offen offset:2048  lds
    v_mul_u32_u24 v22, 0x3fc0, v22
    v_mfma_f32_16x16x32_bf16 v[156:159], a[148:151], a[76:79], v[156:159]
    s_waitcnt lgkmcnt(8)
    v_sub_u32 v22, v23, v22
    v_mfma_f32_16x16x32_bf16 v[32:35], a[152:155], a[80:83], v[32:35]
    ds_read_b64_tr_b16 a[144:145], v16 offset:21536
    v_add_u32 v18, 7168, v20
    v_mfma_f32_16x16x32_bf16 v[36:39], a[152:155], a[84:87], v[36:39]
    ds_read_b64_tr_b16 a[146:147], v16 offset:25120
    v_add_u32 v19, 7168, v21
    v_mfma_f32_16x16x32_bf16 v[40:43], a[152:155], a[88:91], v[40:43]
    buffer_load_dwordx4 v11, s[48:51], s89 offen offset:3072  lds
    v_mov_b32 v6, 1
    v_mfma_f32_16x16x32_bf16 v[44:47], a[152:155], a[92:95], v[44:47]
    s_waitcnt lgkmcnt(8)
    s_mov_b32 s44, s24
    v_mfma_f32_16x16x32_bf16 v[144:147], a[128:131], a[80:83], v[144:147]
    ds_read_b64_tr_b16 a[148:149], v16 offset:28704
    s_and_b32 s45, s25, 0xffff
    v_mfma_f32_16x16x32_bf16 v[148:151], a[128:131], a[84:87], v[148:151]
    ds_read_b64_tr_b16 a[150:151], v16 offset:32288
    s_add_u32 m0, s88, 45056
    v_mfma_f32_16x16x32_bf16 v[152:155], a[128:131], a[88:91], v[152:155]
    buffer_load_dwordx4 v8, s[48:51], s90 offen offset:0  lds
    s_mov_b32 s46, 0x400000
    v_mfma_f32_16x16x32_bf16 v[156:159], a[128:131], a[92:95], v[156:159]
    s_waitcnt lgkmcnt(8)
    s_mov_b32 s47, 0x00020000
    v_mfma_f32_16x16x32_bf16 v[48:51], a[132:135], a[32:35], v[48:51]
    ds_read_b64_tr_b16 a[152:153], v16 offset:43040
    s_add_u32 s32, s28, 0x2100000
    s_addc_u32 s33, s29, 0
    v_mfma_f32_16x16x32_bf16 v[52:55], a[132:135], a[36:39], v[52:55]
    ds_read_b64_tr_b16 a[154:155], v16 offset:46624
    s_and_b32 s33, s33, 0xffff
    v_mfma_f32_16x16x32_bf16 v[56:59], a[132:135], a[40:43], v[56:59]
    buffer_load_dwordx4 v9, s[48:51], s90 offen offset:1024  lds
    s_mov_b32 s34, 0x520000
    v_mfma_f32_16x16x32_bf16 v[60:63], a[132:135], a[44:47], v[60:63]
    s_waitcnt lgkmcnt(8)
    s_mov_b32 s35, 0x00020000
    v_mfma_f32_16x16x32_bf16 v[160:163], a[136:139], a[32:35], v[160:163]
    ds_read_b64_tr_b16 a[128:129], v16 offset:35872
    s_add_u32 s40, s28, 0x800000
    s_addc_u32 s41, s29, 0
    v_mfma_f32_16x16x32_bf16 v[164:167], a[136:139], a[36:39], v[164:167]
    ds_read_b64_tr_b16 a[130:131], v16 offset:39456
    s_and_b32 s41, s41, 0xffff
    v_mfma_f32_16x16x32_bf16 v[168:171], a[136:139], a[40:43], v[168:171]
    buffer_load_dwordx4 v10, s[48:51], s90 offen offset:2048  lds
    s_mov_b32 s42, 0x400000
    v_mfma_f32_16x16x32_bf16 v[172:175], a[136:139], a[44:47], v[172:175]
    s_waitcnt lgkmcnt(8)
    s_mov_b32 s43, 0x00020000
    v_mfma_f32_16x16x32_bf16 v[48:51], a[140:143], a[48:51], v[48:51]
    ds_read_b64_tr_b16 a[132:133], v16 offset:50208
    v_add_u32 v12, 94208, v26
    v_mfma_f32_16x16x32_bf16 v[52:55], a[140:143], a[52:55], v[52:55]
    ds_read_b64_tr_b16 a[134:135], v16 offset:53792
    v_add_u32 v26, 28672, v26
    v_mfma_f32_16x16x32_bf16 v[56:59], a[140:143], a[56:59], v[56:59]
    s_waitcnt vmcnt(7)
    buffer_load_dwordx4 v11, s[48:51], s90 offen offset:3072  lds
    v_mfma_f32_16x16x32_bf16 v[60:63], a[140:143], a[60:63], v[60:63]
    s_barrier
    s_waitcnt lgkmcnt(8)
    v_mfma_f32_16x16x32_bf16 v[160:163], a[144:147], a[48:51], v[160:163]
    ds_read_b64_tr_b16 a[136:137], v17 offset:0
    v_add_u32 v13, 94208, v27
    v_mfma_f32_16x16x32_bf16 v[164:167], a[144:147], a[52:55], v[164:167]
    ds_read_b64_tr_b16 a[138:139], v17 offset:3584
    s_add_u32 m0, s88, 61440
    v_mfma_f32_16x16x32_bf16 v[168:171], a[144:147], a[56:59], v[168:171]
    buffer_load_dwordx4 v8, s[48:51], s91 offen offset:0  lds
    v_add_u32 v27, 28672, v27
    v_mfma_f32_16x16x32_bf16 v[172:175], a[144:147], a[60:63], v[172:175]
    s_waitcnt lgkmcnt(8)
    v_add_u32 v14, 94208, v28
    v_mfma_f32_16x16x32_bf16 v[48:51], a[148:151], a[64:67], v[48:51]
    ds_read_b64_tr_b16 a[140:141], v17 offset:14336
    v_add_u32 v28, 28672, v28
    v_mfma_f32_16x16x32_bf16 v[52:55], a[148:151], a[68:71], v[52:55]
    ds_read_b64_tr_b16 a[142:143], v17 offset:17920
    v_add_u32 v15, 94208, v29
    v_mfma_f32_16x16x32_bf16 v[56:59], a[148:151], a[72:75], v[56:59]
    buffer_load_dwordx4 v9, s[48:51], s91 offen offset:1024  lds
    v_add_u32 v29, 28672, v29
    v_mfma_f32_16x16x32_bf16 v[60:63], a[148:151], a[76:79], v[60:63]
    s_waitcnt lgkmcnt(8)
    v_readlane_b32 s75, v25, 4
    v_mfma_f32_16x16x32_bf16 v[160:163], a[152:155], a[64:67], v[160:163]
    ds_read_b64_tr_b16 a[144:145], v17 offset:7168
    s_mov_b32 s76, 5
    v_mfma_f32_16x16x32_bf16 v[164:167], a[152:155], a[68:71], v[164:167]
    ds_read_b64_tr_b16 a[146:147], v17 offset:10752
    s_mov_b32 s79, 16384
    v_mfma_f32_16x16x32_bf16 v[168:171], a[152:155], a[72:75], v[168:171]
    buffer_load_dwordx4 v10, s[48:51], s91 offen offset:2048  lds
    s_mov_b32 s77, 32768
    v_mfma_f32_16x16x32_bf16 v[172:175], a[152:155], a[76:79], v[172:175]
    s_waitcnt lgkmcnt(8)
    v_mfma_f32_16x16x32_bf16 v[48:51], a[128:131], a[80:83], v[48:51]
    ds_read_b64_tr_b16 a[148:149], v17 offset:21504
    v_mfma_f32_16x16x32_bf16 v[52:55], a[128:131], a[84:87], v[52:55]
    ds_read_b64_tr_b16 a[150:151], v17 offset:25088
    v_mfma_f32_16x16x32_bf16 v[56:59], a[128:131], a[88:91], v[56:59]
    buffer_load_dwordx4 v11, s[48:51], s91 offen offset:3072  lds
    v_mfma_f32_16x16x32_bf16 v[60:63], a[128:131], a[92:95], v[60:63]
    s_waitcnt lgkmcnt(8)
    v_mfma_f32_16x16x32_bf16 v[160:163], a[132:135], a[80:83], v[160:163]
    ds_read_b64_tr_b16 a[152:153], v17 offset:32
    v_mfma_f32_16x16x32_bf16 v[164:167], a[132:135], a[84:87], v[164:167]
    ds_read_b64_tr_b16 a[154:155], v17 offset:3616
    s_add_u32 m0, s88, 143360
    v_mfma_f32_16x16x32_bf16 v[168:171], a[132:135], a[88:91], v[168:171]
    buffer_load_dwordx4 v8, s[48:51], s93 offen offset:0  lds
    v_mfma_f32_16x16x32_bf16 v[172:175], a[132:135], a[92:95], v[172:175]
    s_waitcnt lgkmcnt(8)
    v_mfma_f32_16x16x32_bf16 v[32:35], a[136:139], a[96:99], v[32:35]
    ds_read_b64_tr_b16 a[128:129], v17 offset:14368
    v_mfma_f32_16x16x32_bf16 v[36:39], a[136:139], a[100:103], v[36:39]
    ds_read_b64_tr_b16 a[130:131], v17 offset:17952
    v_mfma_f32_16x16x32_bf16 v[40:43], a[136:139], a[104:107], v[40:43]
    buffer_load_dwordx4 v9, s[48:51], s93 offen offset:1024  lds
    v_mfma_f32_16x16x32_bf16 v[44:47], a[136:139], a[108:111], v[44:47]
    s_waitcnt lgkmcnt(8)
    v_mfma_f32_16x16x32_bf16 v[144:147], a[140:143], a[96:99], v[144:147]
    ds_read_b64_tr_b16 a[132:133], v17 offset:7200
    v_mfma_f32_16x16x32_bf16 v[148:151], a[140:143], a[100:103], v[148:151]
    ds_read_b64_tr_b16 a[134:135], v17 offset:10784
    v_mfma_f32_16x16x32_bf16 v[152:155], a[140:143], a[104:107], v[152:155]
    buffer_load_dwordx4 v10, s[48:51], s93 offen offset:2048  lds
    v_mfma_f32_16x16x32_bf16 v[156:159], a[140:143], a[108:111], v[156:159]
    s_waitcnt lgkmcnt(8)
    v_mfma_f32_16x16x32_bf16 v[32:35], a[144:147], a[112:115], v[32:35]
    ds_read_b64_tr_b16 a[136:137], v17 offset:21536
    v_mfma_f32_16x16x32_bf16 v[36:39], a[144:147], a[116:119], v[36:39]
    ds_read_b64_tr_b16 a[138:139], v17 offset:25120
    v_mfma_f32_16x16x32_bf16 v[40:43], a[144:147], a[120:123], v[40:43]
    buffer_load_dwordx4 v11, s[48:51], s93 offen offset:3072  lds
    v_mfma_f32_16x16x32_bf16 v[44:47], a[144:147], a[124:127], v[44:47]
    s_waitcnt lgkmcnt(8)
    v_mfma_f32_16x16x32_bf16 v[144:147], a[148:151], a[112:115], v[144:147]
    ds_read_b64_tr_b16 a[140:141], v16 offset:64
    v_mfma_f32_16x16x32_bf16 v[148:151], a[148:151], a[116:119], v[148:151]
    ds_read_b64_tr_b16 a[142:143], v16 offset:3648
    v_mfma_f32_16x16x32_bf16 v[152:155], a[148:151], a[120:123], v[152:155]
    v_mfma_f32_16x16x32_bf16 v[156:159], a[148:151], a[124:127], v[156:159]
    s_waitcnt lgkmcnt(8)
    v_mfma_f32_16x16x32_bf16 v[48:51], a[152:155], a[96:99], v[48:51]
    ds_read_b64_tr_b16 a[144:145], v16 offset:14400
    v_mfma_f32_16x16x32_bf16 v[52:55], a[152:155], a[100:103], v[52:55]
    ds_read_b64_tr_b16 a[146:147], v16 offset:17984
    v_mul_f32 v32, v32, v144
    v_mfma_f32_16x16x32_bf16 v[56:59], a[152:155], a[104:107], v[56:59]
    v_mul_f32 v33, v33, v145
    v_mul_f32 v34, v34, v146
    v_mfma_f32_16x16x32_bf16 v[60:63], a[152:155], a[108:111], v[60:63]
    s_waitcnt lgkmcnt(8)
    v_mul_f32 v35, v35, v147
    v_mfma_f32_16x16x32_bf16 v[160:163], a[128:131], a[96:99], v[160:163]
    ds_read_b64_tr_b16 a[148:149], v16 offset:7232
    v_mul_f32 v36, v36, v148
    v_mfma_f32_16x16x32_bf16 v[164:167], a[128:131], a[100:103], v[164:167]
    ds_read_b64_tr_b16 a[150:151], v16 offset:10816
    v_mul_f32 v37, v37, v149
    v_mfma_f32_16x16x32_bf16 v[168:171], a[128:131], a[104:107], v[168:171]
    v_mul_f32 v38, v38, v150
    v_mul_f32 v39, v39, v151
    v_mfma_f32_16x16x32_bf16 v[172:175], a[128:131], a[108:111], v[172:175]
    s_waitcnt lgkmcnt(8)
    v_cvt_pk_bf16_f32 v144, v32, v33
    v_mfma_f32_16x16x32_bf16 v[48:51], a[132:135], a[112:115], v[48:51]
    ds_read_b64_tr_b16 a[152:153], v16 offset:21568
    v_cvt_pk_bf16_f32 v145, v34, v35
    v_mfma_f32_16x16x32_bf16 v[52:55], a[132:135], a[116:119], v[52:55]
    ds_read_b64_tr_b16 a[154:155], v16 offset:25152
    v_cvt_pk_bf16_f32 v146, v36, v37
    v_mfma_f32_16x16x32_bf16 v[56:59], a[132:135], a[120:123], v[56:59]
    v_cvt_pk_bf16_f32 v147, v38, v39
    v_mul_f32 v40, v40, v152
    v_mfma_f32_16x16x32_bf16 v[60:63], a[132:135], a[124:127], v[60:63]
    s_waitcnt lgkmcnt(8)
    v_mul_f32 v41, v41, v153
    v_mfma_f32_16x16x32_bf16 v[160:163], a[136:139], a[112:115], v[160:163]
    ds_read_b64_tr_b16 a[128:129], v16 offset:28736
    v_mul_f32 v42, v42, v154
    v_mfma_f32_16x16x32_bf16 v[164:167], a[136:139], a[116:119], v[164:167]
    ds_read_b64_tr_b16 a[130:131], v16 offset:32320
    v_mul_f32 v43, v43, v155
    v_mfma_f32_16x16x32_bf16 v[168:171], a[136:139], a[120:123], v[168:171]
    v_mul_f32 v44, v44, v156
    v_mul_f32 v45, v45, v157
    v_mfma_f32_16x16x32_bf16 v[172:175], a[136:139], a[124:127], v[172:175]
    s_waitcnt lgkmcnt(8)
    v_mul_f32 v46, v46, v158
    v_mfma_f32_16x16x32_bf16 v[64:67], a[140:143], a[32:35], v[64:67]
    ds_read_b64_tr_b16 a[132:133], v16 offset:43072
    v_mul_f32 v47, v47, v159
    v_mfma_f32_16x16x32_bf16 v[68:71], a[140:143], a[36:39], v[68:71]
    ds_read_b64_tr_b16 a[134:135], v16 offset:46656
    s_add_u32 s63, s60, 0
    v_mfma_f32_16x16x32_bf16 v[72:75], a[140:143], a[40:43], v[72:75]
    v_permlane16_swap_b32 v144, v146
    v_permlane16_swap_b32 v145, v147
    v_mfma_f32_16x16x32_bf16 v[76:79], a[140:143], a[44:47], v[76:79]
    s_waitcnt lgkmcnt(8)
    buffer_store_dwordx4 v[144:147], v4, s[36:39], s63 offen sc1
    v_mfma_f32_16x16x32_bf16 v[176:179], a[144:147], a[32:35], v[176:179]
    ds_read_b64_tr_b16 a[136:137], v16 offset:35904
    v_cvt_pk_bf16_f32 v152, v40, v41
    v_mfma_f32_16x16x32_bf16 v[180:183], a[144:147], a[36:39], v[180:183]
    ds_read_b64_tr_b16 a[138:139], v16 offset:39488
    v_cvt_pk_bf16_f32 v153, v42, v43
    v_mfma_f32_16x16x32_bf16 v[184:187], a[144:147], a[40:43], v[184:187]
    v_cvt_pk_bf16_f32 v154, v44, v45
    v_cvt_pk_bf16_f32 v155, v46, v47
    v_mfma_f32_16x16x32_bf16 v[188:191], a[144:147], a[44:47], v[188:191]
    s_waitcnt lgkmcnt(8)
    s_add_u32 s63, s60, 229376
    v_mfma_f32_16x16x32_bf16 v[64:67], a[148:151], a[48:51], v[64:67]
    ds_read_b64_tr_b16 a[140:141], v16 offset:50240
    v_permlane16_swap_b32 v152, v154
    v_mfma_f32_16x16x32_bf16 v[68:71], a[148:151], a[52:55], v[68:71]
    ds_read_b64_tr_b16 a[142:143], v16 offset:53824
    v_permlane16_swap_b32 v153, v155
    v_mfma_f32_16x16x32_bf16 v[72:75], a[148:151], a[56:59], v[72:75]
    buffer_store_dwordx4 v[152:155], v4, s[36:39], s63 offen sc1
    v_pk_mov_b32 v[32:33], 0, 0
    v_mfma_f32_16x16x32_bf16 v[76:79], a[148:151], a[60:63], v[76:79]
    s_waitcnt lgkmcnt(8)
    v_pk_mov_b32 v[34:35], 0, 0
    v_mfma_f32_16x16x32_bf16 v[176:179], a[152:155], a[48:51], v[176:179]
    ds_read_b64_tr_b16 a[144:145], v17 offset:64
    v_pk_mov_b32 v[36:37], 0, 0
    v_mfma_f32_16x16x32_bf16 v[180:183], a[152:155], a[52:55], v[180:183]
    ds_read_b64_tr_b16 a[146:147], v17 offset:3648
    v_pk_mov_b32 v[38:39], 0, 0
    v_mfma_f32_16x16x32_bf16 v[184:187], a[152:155], a[56:59], v[184:187]
    v_pk_mov_b32 v[40:41], 0, 0
    v_pk_mov_b32 v[42:43], 0, 0
    v_mfma_f32_16x16x32_bf16 v[188:191], a[152:155], a[60:63], v[188:191]
    s_waitcnt lgkmcnt(8)
    v_pk_mov_b32 v[44:45], 0, 0
    v_mfma_f32_16x16x32_bf16 v[64:67], a[128:131], a[64:67], v[64:67]
    ds_read_b64_tr_b16 a[148:149], v17 offset:14400
    v_pk_mov_b32 v[46:47], 0, 0
    v_mfma_f32_16x16x32_bf16 v[68:71], a[128:131], a[68:71], v[68:71]
    ds_read_b64_tr_b16 a[150:151], v17 offset:17984
    v_mul_f32 v48, v48, v160
    v_mfma_f32_16x16x32_bf16 v[72:75], a[128:131], a[72:75], v[72:75]
    v_mul_f32 v49, v49, v161
    v_mul_f32 v50, v50, v162
    v_mfma_f32_16x16x32_bf16 v[76:79], a[128:131], a[76:79], v[76:79]
    s_waitcnt lgkmcnt(8)
    v_mul_f32 v51, v51, v163
    v_mfma_f32_16x16x32_bf16 v[176:179], a[132:135], a[64:67], v[176:179]
    ds_read_b64_tr_b16 a[152:153], v17 offset:7232
    v_mul_f32 v52, v52, v164
    v_mfma_f32_16x16x32_bf16 v[180:183], a[132:135], a[68:71], v[180:183]
    ds_read_b64_tr_b16 a[154:155], v17 offset:10816
    v_mul_f32 v53, v53, v165
    v_mfma_f32_16x16x32_bf16 v[184:187], a[132:135], a[72:75], v[184:187]
    v_mul_f32 v54, v54, v166
    v_mul_f32 v55, v55, v167
    v_mfma_f32_16x16x32_bf16 v[188:191], a[132:135], a[76:79], v[188:191]
    s_waitcnt lgkmcnt(8)
    v_cvt_pk_bf16_f32 v160, v48, v49
    v_mfma_f32_16x16x32_bf16 v[64:67], a[136:139], a[80:83], v[64:67]
    ds_read_b64_tr_b16 a[128:129], v17 offset:21568
    v_cvt_pk_bf16_f32 v161, v50, v51
    v_mfma_f32_16x16x32_bf16 v[68:71], a[136:139], a[84:87], v[68:71]
    ds_read_b64_tr_b16 a[130:131], v17 offset:25152
    v_cvt_pk_bf16_f32 v162, v52, v53
    v_mfma_f32_16x16x32_bf16 v[72:75], a[136:139], a[88:91], v[72:75]
    v_cvt_pk_bf16_f32 v163, v54, v55
    v_mul_f32 v56, v56, v168
    v_mfma_f32_16x16x32_bf16 v[76:79], a[136:139], a[92:95], v[76:79]
    s_waitcnt lgkmcnt(8)
    v_mul_f32 v57, v57, v169
    v_mfma_f32_16x16x32_bf16 v[176:179], a[140:143], a[80:83], v[176:179]
    ds_read_b64_tr_b16 a[132:133], v16 offset:96
    v_mul_f32 v58, v58, v170
    v_mfma_f32_16x16x32_bf16 v[180:183], a[140:143], a[84:87], v[180:183]
    ds_read_b64_tr_b16 a[134:135], v16 offset:3680
    v_mul_f32 v59, v59, v171
    v_mfma_f32_16x16x32_bf16 v[184:187], a[140:143], a[88:91], v[184:187]
    v_mul_f32 v60, v60, v172
    v_mul_f32 v61, v61, v173
    v_mfma_f32_16x16x32_bf16 v[188:191], a[140:143], a[92:95], v[188:191]
    s_waitcnt lgkmcnt(8)
    v_mul_f32 v62, v62, v174
    v_mfma_f32_16x16x32_bf16 v[64:67], a[144:147], a[96:99], v[64:67]
    ds_read_b64_tr_b16 a[136:137], v16 offset:14432
    v_mul_f32 v63, v63, v175
    v_mfma_f32_16x16x32_bf16 v[68:71], a[144:147], a[100:103], v[68:71]
    ds_read_b64_tr_b16 a[138:139], v16 offset:18016
    s_add_u32 s63, s60, 512
    v_mfma_f32_16x16x32_bf16 v[72:75], a[144:147], a[104:107], v[72:75]
    v_permlane16_swap_b32 v160, v162
    v_permlane16_swap_b32 v161, v163
    v_mfma_f32_16x16x32_bf16 v[76:79], a[144:147], a[108:111], v[76:79]
    s_waitcnt lgkmcnt(8)
    buffer_store_dwordx4 v[160:163], v4, s[36:39], s63 offen sc1
    v_mfma_f32_16x16x32_bf16 v[176:179], a[148:151], a[96:99], v[176:179]
    ds_read_b64_tr_b16 a[140:141], v16 offset:7264
    v_cvt_pk_bf16_f32 v168, v56, v57
    v_mfma_f32_16x16x32_bf16 v[180:183], a[148:151], a[100:103], v[180:183]
    ds_read_b64_tr_b16 a[142:143], v16 offset:10848
    v_cvt_pk_bf16_f32 v169, v58, v59
    v_mfma_f32_16x16x32_bf16 v[184:187], a[148:151], a[104:107], v[184:187]
    v_cvt_pk_bf16_f32 v170, v60, v61
    v_cvt_pk_bf16_f32 v171, v62, v63
    v_mfma_f32_16x16x32_bf16 v[188:191], a[148:151], a[108:111], v[188:191]
    s_waitcnt lgkmcnt(8)
    s_add_u32 s63, s60, 229888
    v_mfma_f32_16x16x32_bf16 v[64:67], a[152:155], a[112:115], v[64:67]
    ds_read_b64_tr_b16 a[144:145], v16 offset:21600
    v_permlane16_swap_b32 v168, v170
    v_mfma_f32_16x16x32_bf16 v[68:71], a[152:155], a[116:119], v[68:71]
    ds_read_b64_tr_b16 a[146:147], v16 offset:25184
    v_permlane16_swap_b32 v169, v171
    v_mfma_f32_16x16x32_bf16 v[72:75], a[152:155], a[120:123], v[72:75]
    buffer_store_dwordx4 v[168:171], v4, s[36:39], s63 offen sc1
    v_pk_mov_b32 v[48:49], 0, 0
    v_mfma_f32_16x16x32_bf16 v[76:79], a[152:155], a[124:127], v[76:79]
    s_waitcnt lgkmcnt(8)
    v_pk_mov_b32 v[50:51], 0, 0
    v_mfma_f32_16x16x32_bf16 v[176:179], a[128:131], a[112:115], v[176:179]
    ds_read_b64_tr_b16 a[148:149], v16 offset:28768
    v_pk_mov_b32 v[52:53], 0, 0
    v_mfma_f32_16x16x32_bf16 v[180:183], a[128:131], a[116:119], v[180:183]
    ds_read_b64_tr_b16 a[150:151], v16 offset:32352
    v_pk_mov_b32 v[54:55], 0, 0
    v_mfma_f32_16x16x32_bf16 v[184:187], a[128:131], a[120:123], v[184:187]
    v_pk_mov_b32 v[56:57], 0, 0
    v_pk_mov_b32 v[58:59], 0, 0
    v_mfma_f32_16x16x32_bf16 v[188:191], a[128:131], a[124:127], v[188:191]
    s_waitcnt lgkmcnt(8)
    v_pk_mov_b32 v[60:61], 0, 0
    v_mfma_f32_16x16x32_bf16 v[80:83], a[132:135], a[32:35], v[80:83]
    ds_read_b64_tr_b16 a[152:153], v16 offset:43104
    v_pk_mov_b32 v[62:63], 0, 0
    v_mfma_f32_16x16x32_bf16 v[84:87], a[132:135], a[36:39], v[84:87]
    ds_read_b64_tr_b16 a[154:155], v16 offset:46688
    v_mul_f32 v64, v64, v176
    v_mfma_f32_16x16x32_bf16 v[88:91], a[132:135], a[40:43], v[88:91]
    v_mul_f32 v65, v65, v177
    v_mul_f32 v66, v66, v178
    v_mfma_f32_16x16x32_bf16 v[92:95], a[132:135], a[44:47], v[92:95]
    s_waitcnt lgkmcnt(8)
    v_mul_f32 v67, v67, v179
    v_mfma_f32_16x16x32_bf16 v[192:195], a[136:139], a[32:35], v[192:195]
    ds_read_b64_tr_b16 a[128:129], v16 offset:35936
    v_mul_f32 v68, v68, v180
    v_mfma_f32_16x16x32_bf16 v[196:199], a[136:139], a[36:39], v[196:199]
    ds_read_b64_tr_b16 a[130:131], v16 offset:39520
    v_mul_f32 v69, v69, v181
    v_mfma_f32_16x16x32_bf16 v[200:203], a[136:139], a[40:43], v[200:203]
    v_mul_f32 v70, v70, v182
    v_mul_f32 v71, v71, v183
    v_mfma_f32_16x16x32_bf16 v[204:207], a[136:139], a[44:47], v[204:207]
    s_waitcnt lgkmcnt(8)
    v_cvt_pk_bf16_f32 v176, v64, v65
    v_mfma_f32_16x16x32_bf16 v[80:83], a[140:143], a[48:51], v[80:83]
    ds_read_b64_tr_b16 a[132:133], v16 offset:50272
    v_cvt_pk_bf16_f32 v177, v66, v67
    v_mfma_f32_16x16x32_bf16 v[84:87], a[140:143], a[52:55], v[84:87]
    ds_read_b64_tr_b16 a[134:135], v16 offset:53856
    v_cvt_pk_bf16_f32 v178, v68, v69
    v_mfma_f32_16x16x32_bf16 v[88:91], a[140:143], a[56:59], v[88:91]
    v_cvt_pk_bf16_f32 v179, v70, v71
    v_mul_f32 v72, v72, v184
    v_mfma_f32_16x16x32_bf16 v[92:95], a[140:143], a[60:63], v[92:95]
    s_waitcnt lgkmcnt(8)
    v_mul_f32 v73, v73, v185
    v_mfma_f32_16x16x32_bf16 v[192:195], a[144:147], a[48:51], v[192:195]
    ds_read_b64_tr_b16 a[136:137], v17 offset:96
    v_mul_f32 v74, v74, v186
    v_mfma_f32_16x16x32_bf16 v[196:199], a[144:147], a[52:55], v[196:199]
    ds_read_b64_tr_b16 a[138:139], v17 offset:3680
    v_mul_f32 v75, v75, v187
    v_mfma_f32_16x16x32_bf16 v[200:203], a[144:147], a[56:59], v[200:203]
    v_mul_f32 v76, v76, v188
    v_mul_f32 v77, v77, v189
    v_mfma_f32_16x16x32_bf16 v[204:207], a[144:147], a[60:63], v[204:207]
    s_waitcnt lgkmcnt(8)
    v_mul_f32 v78, v78, v190
    v_mfma_f32_16x16x32_bf16 v[80:83], a[148:151], a[64:67], v[80:83]
    ds_read_b64_tr_b16 a[140:141], v17 offset:14432
    v_mul_f32 v79, v79, v191
    v_mfma_f32_16x16x32_bf16 v[84:87], a[148:151], a[68:71], v[84:87]
    ds_read_b64_tr_b16 a[142:143], v17 offset:18016
    s_add_u32 s63, s60, 1024
    v_mfma_f32_16x16x32_bf16 v[88:91], a[148:151], a[72:75], v[88:91]
    v_permlane16_swap_b32 v176, v178
    v_permlane16_swap_b32 v177, v179
    v_mfma_f32_16x16x32_bf16 v[92:95], a[148:151], a[76:79], v[92:95]
    s_waitcnt lgkmcnt(8)
    buffer_store_dwordx4 v[176:179], v4, s[36:39], s63 offen sc1
    v_mfma_f32_16x16x32_bf16 v[192:195], a[152:155], a[64:67], v[192:195]
    ds_read_b64_tr_b16 a[144:145], v17 offset:7264
    v_cvt_pk_bf16_f32 v184, v72, v73
    v_mfma_f32_16x16x32_bf16 v[196:199], a[152:155], a[68:71], v[196:199]
    ds_read_b64_tr_b16 a[146:147], v17 offset:10848
    v_cvt_pk_bf16_f32 v185, v74, v75
    v_mfma_f32_16x16x32_bf16 v[200:203], a[152:155], a[72:75], v[200:203]
    v_cvt_pk_bf16_f32 v186, v76, v77
    v_cvt_pk_bf16_f32 v187, v78, v79
    v_mfma_f32_16x16x32_bf16 v[204:207], a[152:155], a[76:79], v[204:207]
    s_waitcnt lgkmcnt(8)
    s_add_u32 s63, s60, 230400
    v_mfma_f32_16x16x32_bf16 v[80:83], a[128:131], a[80:83], v[80:83]
    ds_read_b64_tr_b16 a[148:149], v17 offset:21600
    v_permlane16_swap_b32 v184, v186
    v_mfma_f32_16x16x32_bf16 v[84:87], a[128:131], a[84:87], v[84:87]
    ds_read_b64_tr_b16 a[150:151], v17 offset:25184
    v_permlane16_swap_b32 v185, v187
    v_mfma_f32_16x16x32_bf16 v[88:91], a[128:131], a[88:91], v[88:91]
    buffer_store_dwordx4 v[184:187], v4, s[36:39], s63 offen sc1
    v_pk_mov_b32 v[64:65], 0, 0
    v_mfma_f32_16x16x32_bf16 v[92:95], a[128:131], a[92:95], v[92:95]
    s_waitcnt lgkmcnt(8)
    v_pk_mov_b32 v[66:67], 0, 0
    v_mfma_f32_16x16x32_bf16 v[192:195], a[132:135], a[80:83], v[192:195]
    ds_read_b64_tr_b16 a[152:153], v16 offset:128
    v_pk_mov_b32 v[68:69], 0, 0
    v_mfma_f32_16x16x32_bf16 v[196:199], a[132:135], a[84:87], v[196:199]
    ds_read_b64_tr_b16 a[154:155], v16 offset:3712
    v_pk_mov_b32 v[70:71], 0, 0
    v_mfma_f32_16x16x32_bf16 v[200:203], a[132:135], a[88:91], v[200:203]
    v_pk_mov_b32 v[72:73], 0, 0
    v_pk_mov_b32 v[74:75], 0, 0
    v_mfma_f32_16x16x32_bf16 v[204:207], a[132:135], a[92:95], v[204:207]
    s_waitcnt lgkmcnt(8)
    v_pk_mov_b32 v[76:77], 0, 0
    v_mfma_f32_16x16x32_bf16 v[80:83], a[136:139], a[96:99], v[80:83]
    ds_read_b64_tr_b16 a[128:129], v16 offset:14464
    v_pk_mov_b32 v[78:79], 0, 0
    v_mfma_f32_16x16x32_bf16 v[84:87], a[136:139], a[100:103], v[84:87]
    ds_read_b64_tr_b16 a[130:131], v16 offset:18048
    v_mfma_f32_16x16x32_bf16 v[88:91], a[136:139], a[104:107], v[88:91]
    v_mfma_f32_16x16x32_bf16 v[92:95], a[136:139], a[108:111], v[92:95]
    s_waitcnt lgkmcnt(8)
    v_mfma_f32_16x16x32_bf16 v[192:195], a[140:143], a[96:99], v[192:195]
    ds_read_b64_tr_b16 a[132:133], v16 offset:7296
    v_mfma_f32_16x16x32_bf16 v[196:199], a[140:143], a[100:103], v[196:199]
    ds_read_b64_tr_b16 a[134:135], v16 offset:10880
    v_mfma_f32_16x16x32_bf16 v[200:203], a[140:143], a[104:107], v[200:203]
    v_mfma_f32_16x16x32_bf16 v[204:207], a[140:143], a[108:111], v[204:207]
    s_waitcnt lgkmcnt(8)
    v_mfma_f32_16x16x32_bf16 v[80:83], a[144:147], a[112:115], v[80:83]
    ds_read_b64_tr_b16 a[136:137], v16 offset:21632
    v_mfma_f32_16x16x32_bf16 v[84:87], a[144:147], a[116:119], v[84:87]
    ds_read_b64_tr_b16 a[138:139], v16 offset:25216
    v_mfma_f32_16x16x32_bf16 v[88:91], a[144:147], a[120:123], v[88:91]
    s_waitcnt vmcnt(2)
    buffer_atomic_add v6, v5, s[52:55], 0 offen
    v_mfma_f32_16x16x32_bf16 v[92:95], a[144:147], a[124:127], v[92:95]
    s_waitcnt lgkmcnt(8)
    v_mfma_f32_16x16x32_bf16 v[192:195], a[148:151], a[112:115], v[192:195]
    ds_read_b64_tr_b16 a[140:141], v16 offset:28800
    v_mfma_f32_16x16x32_bf16 v[196:199], a[148:151], a[116:119], v[196:199]
    ds_read_b64_tr_b16 a[142:143], v16 offset:32384
    v_mfma_f32_16x16x32_bf16 v[200:203], a[148:151], a[120:123], v[200:203]
    v_mfma_f32_16x16x32_bf16 v[204:207], a[148:151], a[124:127], v[204:207]
    s_waitcnt lgkmcnt(8)
    v_mfma_f32_16x16x32_bf16 v[96:99], a[152:155], a[32:35], v[96:99]
    ds_read_b64_tr_b16 a[144:145], v16 offset:43136
    v_mfma_f32_16x16x32_bf16 v[100:103], a[152:155], a[36:39], v[100:103]
    ds_read_b64_tr_b16 a[146:147], v16 offset:46720
    v_mul_f32 v80, v80, v192
    v_mfma_f32_16x16x32_bf16 v[104:107], a[152:155], a[40:43], v[104:107]
    v_mul_f32 v81, v81, v193
    v_mul_f32 v82, v82, v194
    v_mfma_f32_16x16x32_bf16 v[108:111], a[152:155], a[44:47], v[108:111]
    s_waitcnt lgkmcnt(8)
    v_mul_f32 v83, v83, v195
    v_mfma_f32_16x16x32_bf16 v[208:211], a[128:131], a[32:35], v[208:211]
    ds_read_b64_tr_b16 a[148:149], v16 offset:35968
    v_mul_f32 v84, v84, v196
    v_mfma_f32_16x16x32_bf16 v[212:215], a[128:131], a[36:39], v[212:215]
    ds_read_b64_tr_b16 a[150:151], v16 offset:39552
    v_mul_f32 v85, v85, v197
    v_mfma_f32_16x16x32_bf16 v[216:219], a[128:131], a[40:43], v[216:219]
    v_mul_f32 v86, v86, v198
    v_mul_f32 v87, v87, v199
    v_mfma_f32_16x16x32_bf16 v[220:223], a[128:131], a[44:47], v[220:223]
    s_waitcnt lgkmcnt(8)
    v_cvt_pk_bf16_f32 v192, v80, v81
    v_mfma_f32_16x16x32_bf16 v[96:99], a[132:135], a[48:51], v[96:99]
    ds_read_b64_tr_b16 a[152:153], v16 offset:50304
    v_cvt_pk_bf16_f32 v193, v82, v83
    v_mfma_f32_16x16x32_bf16 v[100:103], a[132:135], a[52:55], v[100:103]
    ds_read_b64_tr_b16 a[154:155], v16 offset:53888
    v_cvt_pk_bf16_f32 v194, v84, v85
    v_mfma_f32_16x16x32_bf16 v[104:107], a[132:135], a[56:59], v[104:107]
    v_cvt_pk_bf16_f32 v195, v86, v87
    v_mul_f32 v88, v88, v200
    v_mfma_f32_16x16x32_bf16 v[108:111], a[132:135], a[60:63], v[108:111]
    s_waitcnt lgkmcnt(8)
    v_mul_f32 v89, v89, v201
    v_mfma_f32_16x16x32_bf16 v[208:211], a[136:139], a[48:51], v[208:211]
    ds_read_b64_tr_b16 a[128:129], v17 offset:128
    v_mul_f32 v90, v90, v202
    v_mfma_f32_16x16x32_bf16 v[212:215], a[136:139], a[52:55], v[212:215]
    ds_read_b64_tr_b16 a[130:131], v17 offset:3712
    v_mul_f32 v91, v91, v203
    v_mfma_f32_16x16x32_bf16 v[216:219], a[136:139], a[56:59], v[216:219]
    v_mul_f32 v92, v92, v204
    v_mul_f32 v93, v93, v205
    v_mfma_f32_16x16x32_bf16 v[220:223], a[136:139], a[60:63], v[220:223]
    s_waitcnt lgkmcnt(8)
    v_mul_f32 v94, v94, v206
    v_mfma_f32_16x16x32_bf16 v[96:99], a[140:143], a[64:67], v[96:99]
    ds_read_b64_tr_b16 a[132:133], v17 offset:14464
    v_mul_f32 v95, v95, v207
    v_mfma_f32_16x16x32_bf16 v[100:103], a[140:143], a[68:71], v[100:103]
    ds_read_b64_tr_b16 a[134:135], v17 offset:18048
    s_add_u32 s63, s60, 1536
    v_mfma_f32_16x16x32_bf16 v[104:107], a[140:143], a[72:75], v[104:107]
    v_permlane16_swap_b32 v192, v194
    v_permlane16_swap_b32 v193, v195
    v_mfma_f32_16x16x32_bf16 v[108:111], a[140:143], a[76:79], v[108:111]
    s_waitcnt lgkmcnt(8)
    buffer_store_dwordx4 v[192:195], v4, s[36:39], s63 offen sc1
    v_mfma_f32_16x16x32_bf16 v[208:211], a[144:147], a[64:67], v[208:211]
    ds_read_b64_tr_b16 a[136:137], v17 offset:7296
    v_cvt_pk_bf16_f32 v200, v88, v89
    v_mfma_f32_16x16x32_bf16 v[212:215], a[144:147], a[68:71], v[212:215]
    ds_read_b64_tr_b16 a[138:139], v17 offset:10880
    v_cvt_pk_bf16_f32 v201, v90, v91
    v_mfma_f32_16x16x32_bf16 v[216:219], a[144:147], a[72:75], v[216:219]
    v_cvt_pk_bf16_f32 v202, v92, v93
    v_cvt_pk_bf16_f32 v203, v94, v95
    v_mfma_f32_16x16x32_bf16 v[220:223], a[144:147], a[76:79], v[220:223]
    s_waitcnt lgkmcnt(8)
    s_add_u32 s63, s60, 230912
    v_mfma_f32_16x16x32_bf16 v[96:99], a[148:151], a[80:83], v[96:99]
    ds_read_b64_tr_b16 a[140:141], v17 offset:21632
    v_permlane16_swap_b32 v200, v202
    v_mfma_f32_16x16x32_bf16 v[100:103], a[148:151], a[84:87], v[100:103]
    ds_read_b64_tr_b16 a[142:143], v17 offset:25216
    v_permlane16_swap_b32 v201, v203
    v_mfma_f32_16x16x32_bf16 v[104:107], a[148:151], a[88:91], v[104:107]
    buffer_store_dwordx4 v[200:203], v4, s[36:39], s63 offen sc1
    v_pk_mov_b32 v[80:81], 0, 0
    v_mfma_f32_16x16x32_bf16 v[108:111], a[148:151], a[92:95], v[108:111]
    s_waitcnt lgkmcnt(8)
    v_pk_mov_b32 v[82:83], 0, 0
    v_mfma_f32_16x16x32_bf16 v[208:211], a[152:155], a[80:83], v[208:211]
    ds_read_b64_tr_b16 a[144:145], v16 offset:160
    v_pk_mov_b32 v[84:85], 0, 0
    v_mfma_f32_16x16x32_bf16 v[212:215], a[152:155], a[84:87], v[212:215]
    ds_read_b64_tr_b16 a[146:147], v16 offset:3744
    v_pk_mov_b32 v[86:87], 0, 0
    v_mfma_f32_16x16x32_bf16 v[216:219], a[152:155], a[88:91], v[216:219]
    v_pk_mov_b32 v[88:89], 0, 0
    v_pk_mov_b32 v[90:91], 0, 0
    v_mfma_f32_16x16x32_bf16 v[220:223], a[152:155], a[92:95], v[220:223]
    s_waitcnt lgkmcnt(8)
    v_pk_mov_b32 v[92:93], 0, 0
    v_mfma_f32_16x16x32_bf16 v[96:99], a[128:131], a[96:99], v[96:99]
    ds_read_b64_tr_b16 a[148:149], v16 offset:14496
    v_pk_mov_b32 v[94:95], 0, 0
    v_mfma_f32_16x16x32_bf16 v[100:103], a[128:131], a[100:103], v[100:103]
    ds_read_b64_tr_b16 a[150:151], v16 offset:18080
    v_mfma_f32_16x16x32_bf16 v[104:107], a[128:131], a[104:107], v[104:107]
    v_mfma_f32_16x16x32_bf16 v[108:111], a[128:131], a[108:111], v[108:111]
    s_waitcnt lgkmcnt(8)
    v_mfma_f32_16x16x32_bf16 v[208:211], a[132:135], a[96:99], v[208:211]
    ds_read_b64_tr_b16 a[152:153], v16 offset:7328
    v_mfma_f32_16x16x32_bf16 v[212:215], a[132:135], a[100:103], v[212:215]
    ds_read_b64_tr_b16 a[154:155], v16 offset:10912
    v_mfma_f32_16x16x32_bf16 v[216:219], a[132:135], a[104:107], v[216:219]
    v_mfma_f32_16x16x32_bf16 v[220:223], a[132:135], a[108:111], v[220:223]
    s_waitcnt lgkmcnt(8)
    v_mfma_f32_16x16x32_bf16 v[96:99], a[136:139], a[112:115], v[96:99]
    ds_read_b64_tr_b16 a[128:129], v16 offset:21664
    v_mfma_f32_16x16x32_bf16 v[100:103], a[136:139], a[116:119], v[100:103]
    ds_read_b64_tr_b16 a[130:131], v16 offset:25248
    v_mfma_f32_16x16x32_bf16 v[104:107], a[136:139], a[120:123], v[104:107]
    v_mfma_f32_16x16x32_bf16 v[108:111], a[136:139], a[124:127], v[108:111]
    s_waitcnt lgkmcnt(8)
    v_mfma_f32_16x16x32_bf16 v[208:211], a[140:143], a[112:115], v[208:211]
    ds_read_b64_tr_b16 a[132:133], v16 offset:28832
    v_mfma_f32_16x16x32_bf16 v[212:215], a[140:143], a[116:119], v[212:215]
    ds_read_b64_tr_b16 a[134:135], v16 offset:32416
    v_mfma_f32_16x16x32_bf16 v[216:219], a[140:143], a[120:123], v[216:219]
    v_mfma_f32_16x16x32_bf16 v[220:223], a[140:143], a[124:127], v[220:223]
    s_waitcnt lgkmcnt(8)
    v_mfma_f32_16x16x32_bf16 v[112:115], a[144:147], a[32:35], v[112:115]
    ds_read_b64_tr_b16 a[136:137], v16 offset:43168
    v_mfma_f32_16x16x32_bf16 v[116:119], a[144:147], a[36:39], v[116:119]
    ds_read_b64_tr_b16 a[138:139], v16 offset:46752
    v_mul_f32 v96, v96, v208
    v_mfma_f32_16x16x32_bf16 v[120:123], a[144:147], a[40:43], v[120:123]
    v_mul_f32 v97, v97, v209
    v_mul_f32 v98, v98, v210
    v_mfma_f32_16x16x32_bf16 v[124:127], a[144:147], a[44:47], v[124:127]
    s_waitcnt lgkmcnt(8)
    v_mul_f32 v99, v99, v211
    v_mfma_f32_16x16x32_bf16 v[224:227], a[148:151], a[32:35], v[224:227]
    ds_read_b64_tr_b16 a[140:141], v16 offset:36000
    v_mul_f32 v100, v100, v212
    v_mfma_f32_16x16x32_bf16 v[228:231], a[148:151], a[36:39], v[228:231]
    ds_read_b64_tr_b16 a[142:143], v16 offset:39584
    v_mul_f32 v101, v101, v213
    v_mfma_f32_16x16x32_bf16 v[232:235], a[148:151], a[40:43], v[232:235]
    v_mul_f32 v102, v102, v214
    v_mul_f32 v103, v103, v215
    v_mfma_f32_16x16x32_bf16 v[236:239], a[148:151], a[44:47], v[236:239]
    s_waitcnt lgkmcnt(8)
    v_cvt_pk_bf16_f32 v208, v96, v97
    v_mfma_f32_16x16x32_bf16 v[112:115], a[152:155], a[48:51], v[112:115]
    ds_read_b64_tr_b16 a[144:145], v16 offset:50336
    v_cvt_pk_bf16_f32 v209, v98, v99
    v_mfma_f32_16x16x32_bf16 v[116:119], a[152:155], a[52:55], v[116:119]
    ds_read_b64_tr_b16 a[146:147], v16 offset:53920
    v_cvt_pk_bf16_f32 v210, v100, v101
    v_mfma_f32_16x16x32_bf16 v[120:123], a[152:155], a[56:59], v[120:123]
    buffer_load_dword v31, v30, s[52:55], 0 offen sc1
    v_cvt_pk_bf16_f32 v211, v102, v103
    v_mfma_f32_16x16x32_bf16 v[124:127], a[152:155], a[60:63], v[124:127]
    s_waitcnt lgkmcnt(8)
    v_mul_f32 v104, v104, v216
    v_mfma_f32_16x16x32_bf16 v[224:227], a[128:131], a[48:51], v[224:227]
    ds_read_b64_tr_b16 a[148:149], v17 offset:160
    v_mul_f32 v105, v105, v217
    v_mfma_f32_16x16x32_bf16 v[228:231], a[128:131], a[52:55], v[228:231]
    ds_read_b64_tr_b16 a[150:151], v17 offset:3744
    v_mul_f32 v106, v106, v218
    v_mfma_f32_16x16x32_bf16 v[232:235], a[128:131], a[56:59], v[232:235]
    v_mul_f32 v107, v107, v219
    v_mul_f32 v108, v108, v220
    v_mfma_f32_16x16x32_bf16 v[236:239], a[128:131], a[60:63], v[236:239]
    s_waitcnt lgkmcnt(8)
    v_mul_f32 v109, v109, v221
    v_mfma_f32_16x16x32_bf16 v[112:115], a[132:135], a[64:67], v[112:115]
    ds_read_b64_tr_b16 a[152:153], v17 offset:14496
    v_mul_f32 v110, v110, v222
    v_mfma_f32_16x16x32_bf16 v[116:119], a[132:135], a[68:71], v[116:119]
    ds_read_b64_tr_b16 a[154:155], v17 offset:18080
    v_mul_f32 v111, v111, v223
    v_mfma_f32_16x16x32_bf16 v[120:123], a[132:135], a[72:75], v[120:123]
    s_add_u32 s63, s60, 2048
    v_permlane16_swap_b32 v208, v210
    v_mfma_f32_16x16x32_bf16 v[124:127], a[132:135], a[76:79], v[124:127]
    s_waitcnt lgkmcnt(8)
    v_permlane16_swap_b32 v209, v211
    v_mfma_f32_16x16x32_bf16 v[224:227], a[136:139], a[64:67], v[224:227]
    ds_read_b64_tr_b16 a[128:129], v17 offset:7328
    buffer_store_dwordx4 v[208:211], v4, s[36:39], s63 offen sc1
    v_mfma_f32_16x16x32_bf16 v[228:231], a[136:139], a[68:71], v[228:231]
    ds_read_b64_tr_b16 a[130:131], v17 offset:10912
    v_cvt_pk_bf16_f32 v216, v104, v105
    v_mfma_f32_16x16x32_bf16 v[232:235], a[136:139], a[72:75], v[232:235]
    v_cvt_pk_bf16_f32 v217, v106, v107
    v_cvt_pk_bf16_f32 v218, v108, v109
    v_mfma_f32_16x16x32_bf16 v[236:239], a[136:139], a[76:79], v[236:239]
    s_waitcnt lgkmcnt(8)
    v_cvt_pk_bf16_f32 v219, v110, v111
    v_mfma_f32_16x16x32_bf16 v[112:115], a[140:143], a[80:83], v[112:115]
    ds_read_b64_tr_b16 a[132:133], v17 offset:21664
    s_add_u32 s63, s60, 231424
    v_mfma_f32_16x16x32_bf16 v[116:119], a[140:143], a[84:87], v[116:119]
    ds_read_b64_tr_b16 a[134:135], v17 offset:25248
    v_permlane16_swap_b32 v216, v218
    v_mfma_f32_16x16x32_bf16 v[120:123], a[140:143], a[88:91], v[120:123]
    v_permlane16_swap_b32 v217, v219
    buffer_store_dwordx4 v[216:219], v4, s[36:39], s63 offen sc1
    v_mfma_f32_16x16x32_bf16 v[124:127], a[140:143], a[92:95], v[124:127]
    s_waitcnt lgkmcnt(8)
    v_mfma_f32_16x16x32_bf16 v[224:227], a[144:147], a[80:83], v[224:227]
    ds_read_b64_tr_b16 a[136:137], v16 offset:192
    v_mfma_f32_16x16x32_bf16 v[228:231], a[144:147], a[84:87], v[228:231]
    ds_read_b64_tr_b16 a[138:139], v16 offset:3776
    v_mfma_f32_16x16x32_bf16 v[232:235], a[144:147], a[88:91], v[232:235]
    v_mfma_f32_16x16x32_bf16 v[236:239], a[144:147], a[92:95], v[236:239]
    s_waitcnt lgkmcnt(8)
    v_mfma_f32_16x16x32_bf16 v[112:115], a[148:151], a[96:99], v[112:115]
    ds_read_b64_tr_b16 a[140:141], v16 offset:14528
    v_mfma_f32_16x16x32_bf16 v[116:119], a[148:151], a[100:103], v[116:119]
    ds_read_b64_tr_b16 a[142:143], v16 offset:18112
    v_mfma_f32_16x16x32_bf16 v[120:123], a[148:151], a[104:107], v[120:123]
    v_mfma_f32_16x16x32_bf16 v[124:127], a[148:151], a[108:111], v[124:127]
    s_waitcnt lgkmcnt(8)
    v_mfma_f32_16x16x32_bf16 v[224:227], a[152:155], a[96:99], v[224:227]
    ds_read_b64_tr_b16 a[144:145], v16 offset:7360
    v_mfma_f32_16x16x32_bf16 v[228:231], a[152:155], a[100:103], v[228:231]
    ds_read_b64_tr_b16 a[146:147], v16 offset:10944
    v_mfma_f32_16x16x32_bf16 v[232:235], a[152:155], a[104:107], v[232:235]
    v_mfma_f32_16x16x32_bf16 v[236:239], a[152:155], a[108:111], v[236:239]
    s_waitcnt lgkmcnt(8)
    v_mfma_f32_16x16x32_bf16 v[112:115], a[128:131], a[112:115], v[112:115]
    ds_read_b64_tr_b16 a[148:149], v16 offset:21696
    v_mfma_f32_16x16x32_bf16 v[116:119], a[128:131], a[116:119], v[116:119]
    ds_read_b64_tr_b16 a[150:151], v16 offset:25280
    s_waitcnt vmcnt(2)
    v_mfma_f32_16x16x32_bf16 v[120:123], a[128:131], a[120:123], v[120:123]
    v_cmp_gt_u32 vcc, 16, v31
    s_cbranch_vccnz L_c4s_1022
L_c4b_1023:
    v_mfma_f32_16x16x32_bf16 v[124:127], a[128:131], a[124:127], v[124:127]
    s_waitcnt lgkmcnt(8)
    v_mfma_f32_16x16x32_bf16 v[224:227], a[132:135], a[112:115], v[224:227]
    ds_read_b64_tr_b16 a[152:153], v16 offset:28864
    s_lshr_b32 s78, s89, 6
    v_mfma_f32_16x16x32_bf16 v[228:231], a[132:135], a[116:119], v[228:231]
    ds_read_b64_tr_b16 a[154:155], v16 offset:32448
    buffer_load_dwordx4 a[0:3], v20, s[36:39], s78 offen sc1
    v_mfma_f32_16x16x32_bf16 v[232:235], a[132:135], a[120:123], v[232:235]
    buffer_load_dwordx4 a[4:7], v21, s[36:39], s78 offen sc1
    v_mfma_f32_16x16x32_bf16 v[236:239], a[132:135], a[124:127], v[236:239]
    s_waitcnt lgkmcnt(8)
    buffer_load_dwordx4 a[8:11], v18, s[36:39], s78 offen sc1
    v_mfma_f32_16x16x32_bf16 v[128:131], a[136:139], a[32:35], v[128:131]
    ds_read_b64_tr_b16 a[128:129], v16 offset:43200
    buffer_load_dwordx4 a[12:15], v19, s[36:39], s78 offen sc1
    v_mfma_f32_16x16x32_bf16 v[132:135], a[136:139], a[36:39], v[132:135]
    ds_read_b64_tr_b16 a[130:131], v16 offset:46784
    s_lshr_b32 s78, s90, 6
    v_mfma_f32_16x16x32_bf16 v[136:139], a[136:139], a[40:43], v[136:139]
    buffer_load_dwordx4 a[16:19], v20, s[36:39], s78 offen sc1
    v_mul_f32 v112, v112, v224
    v_mfma_f32_16x16x32_bf16 v[140:143], a[136:139], a[44:47], v[140:143]
    s_waitcnt lgkmcnt(8)
    buffer_load_dwordx4 a[20:23], v21, s[36:39], s78 offen sc1
    v_mfma_f32_16x16x32_bf16 v[240:243], a[140:143], a[32:35], v[240:243]
    ds_read_b64_tr_b16 a[132:133], v16 offset:36032
    buffer_load_dwordx4 a[24:27], v18, s[36:39], s78 offen sc1
    v_mfma_f32_16x16x32_bf16 v[244:247], a[140:143], a[36:39], v[244:247]
    ds_read_b64_tr_b16 a[134:135], v16 offset:39616
    buffer_load_dwordx4 a[28:31], v19, s[36:39], s78 offen sc1
    v_mfma_f32_16x16x32_bf16 v[248:251], a[140:143], a[40:43], v[248:251]
    s_lshr_b32 s78, s91, 6
    v_mul_f32 v113, v113, v225
    v_mfma_f32_16x16x32_bf16 v[252:255], a[140:143], a[44:47], v[252:255]
    s_waitcnt lgkmcnt(8)
    buffer_load_dwordx4 a[160:163], v20, s[36:39], s78 offen sc1
    v_mfma_f32_16x16x32_bf16 v[128:131], a[144:147], a[48:51], v[128:131]
    ds_read_b64_tr_b16 a[136:137], v16 offset:50368
    buffer_load_dwordx4 a[164:167], v21, s[36:39], s78 offen sc1
    v_mfma_f32_16x16x32_bf16 v[132:135], a[144:147], a[52:55], v[132:135]
    ds_read_b64_tr_b16 a[138:139], v16 offset:53952
    buffer_load_dwordx4 a[168:171], v18, s[36:39], s78 offen sc1
    v_mfma_f32_16x16x32_bf16 v[136:139], a[144:147], a[56:59], v[136:139]
    buffer_load_dwordx4 a[172:175], v19, s[36:39], s78 offen sc1
    v_mul_f32 v114, v114, v226
    v_mfma_f32_16x16x32_bf16 v[140:143], a[144:147], a[60:63], v[140:143]
    s_waitcnt lgkmcnt(8)
    s_lshr_b32 s78, s93, 6
    v_mfma_f32_16x16x32_bf16 v[240:243], a[148:151], a[48:51], v[240:243]
    ds_read_b64_tr_b16 a[140:141], v17 offset:192
    buffer_load_dwordx4 a[176:179], v20, s[36:39], s78 offen sc1
    v_mfma_f32_16x16x32_bf16 v[244:247], a[148:151], a[52:55], v[244:247]
    ds_read_b64_tr_b16 a[142:143], v17 offset:3776
    buffer_load_dwordx4 a[180:183], v21, s[36:39], s78 offen sc1
    v_mfma_f32_16x16x32_bf16 v[248:251], a[148:151], a[56:59], v[248:251]
    buffer_load_dwordx4 a[184:187], v18, s[36:39], s78 offen sc1
    v_mul_f32 v115, v115, v227
    v_mfma_f32_16x16x32_bf16 v[252:255], a[148:151], a[60:63], v[252:255]
    s_waitcnt lgkmcnt(8)
    buffer_load_dwordx4 a[188:191], v19, s[36:39], s78 offen sc1
    v_mfma_f32_16x16x32_bf16 v[128:131], a[152:155], a[64:67], v[128:131]
    ds_read_b64_tr_b16 a[144:145], v17 offset:14528
    v_mul_f32 v116, v116, v228
    v_mfma_f32_16x16x32_bf16 v[132:135], a[152:155], a[68:71], v[132:135]
    ds_read_b64_tr_b16 a[146:147], v17 offset:18112
    v_mul_f32 v117, v117, v229
    v_mfma_f32_16x16x32_bf16 v[136:139], a[152:155], a[72:75], v[136:139]
    s_waitcnt vmcnt(19)
    buffer_atomic_add v6, v5, s[52:55], s79 offen
    v_mfma_f32_16x16x32_bf16 v[140:143], a[152:155], a[76:79], v[140:143]
    s_waitcnt lgkmcnt(8)
    v_mul_f32 v118, v118, v230
    v_mfma_f32_16x16x32_bf16 v[240:243], a[128:131], a[64:67], v[240:243]
    ds_read_b64_tr_b16 a[148:149], v17 offset:7360
    v_mul_f32 v119, v119, v231
    v_mfma_f32_16x16x32_bf16 v[244:247], a[128:131], a[68:71], v[244:247]
    ds_read_b64_tr_b16 a[150:151], v17 offset:10944
    v_cvt_pk_bf16_f32 v224, v112, v113
    v_mfma_f32_16x16x32_bf16 v[248:251], a[128:131], a[72:75], v[248:251]
    v_cvt_pk_bf16_f32 v225, v114, v115
    v_cvt_pk_bf16_f32 v226, v116, v117
    v_mfma_f32_16x16x32_bf16 v[252:255], a[128:131], a[76:79], v[252:255]
    s_waitcnt lgkmcnt(8)
    v_cvt_pk_bf16_f32 v227, v118, v119
    v_mfma_f32_16x16x32_bf16 v[128:131], a[132:135], a[80:83], v[128:131]
    ds_read_b64_tr_b16 a[152:153], v17 offset:21696
    v_mul_f32 v120, v120, v232
    v_mfma_f32_16x16x32_bf16 v[132:135], a[132:135], a[84:87], v[132:135]
    ds_read_b64_tr_b16 a[154:155], v17 offset:25280
    v_mul_f32 v121, v121, v233
    v_mfma_f32_16x16x32_bf16 v[136:139], a[132:135], a[88:91], v[136:139]
    v_mul_f32 v122, v122, v234
    v_mul_f32 v123, v123, v235
    v_mfma_f32_16x16x32_bf16 v[140:143], a[132:135], a[92:95], v[140:143]
    s_waitcnt lgkmcnt(8)
    v_mul_f32 v124, v124, v236
    v_mfma_f32_16x16x32_bf16 v[240:243], a[136:139], a[80:83], v[240:243]
    v_mul_f32 v125, v125, v237
    v_mul_f32 v126, v126, v238
    v_mfma_f32_16x16x32_bf16 v[244:247], a[136:139], a[84:87], v[244:247]
    v_mul_f32 v127, v127, v239
    s_add_u32 s63, s60, 2560
    v_mfma_f32_16x16x32_bf16 v[248:251], a[136:139], a[88:91], v[248:251]
    v_permlane16_swap_b32 v224, v226
    v_permlane16_swap_b32 v225, v227
    v_mfma_f32_16x16x32_bf16 v[252:255], a[136:139], a[92:95], v[252:255]
    s_waitcnt lgkmcnt(6)
    buffer_store_dwordx4 v[224:227], v4, s[36:39], s63 offen sc1
    v_mfma_f32_16x16x32_bf16 v[128:131], a[140:143], a[96:99], v[128:131]
    v_cvt_pk_bf16_f32 v232, v120, v121
    v_cvt_pk_bf16_f32 v233, v122, v123
    v_mfma_f32_16x16x32_bf16 v[132:135], a[140:143], a[100:103], v[132:135]
    v_cvt_pk_bf16_f32 v234, v124, v125
    v_cvt_pk_bf16_f32 v235, v126, v127
    v_mfma_f32_16x16x32_bf16 v[136:139], a[140:143], a[104:107], v[136:139]
    s_add_u32 s63, s60, 231936
    v_permlane16_swap_b32 v232, v234
    v_mfma_f32_16x16x32_bf16 v[140:143], a[140:143], a[108:111], v[140:143]
    s_waitcnt lgkmcnt(4)
    v_permlane16_swap_b32 v233, v235
    v_mfma_f32_16x16x32_bf16 v[240:243], a[144:147], a[96:99], v[240:243]
    buffer_store_dwordx4 v[232:235], v4, s[36:39], s63 offen sc1
    v_mfma_f32_16x16x32_bf16 v[244:247], a[144:147], a[100:103], v[244:247]
    v_mfma_f32_16x16x32_bf16 v[248:251], a[144:147], a[104:107], v[248:251]
    v_mfma_f32_16x16x32_bf16 v[252:255], a[144:147], a[108:111], v[252:255]
    s_waitcnt lgkmcnt(2)
    v_mfma_f32_16x16x32_bf16 v[128:131], a[148:151], a[112:115], v[128:131]
    v_mfma_f32_16x16x32_bf16 v[132:135], a[148:151], a[116:119], v[132:135]
    v_mfma_f32_16x16x32_bf16 v[136:139], a[148:151], a[120:123], v[136:139]
    v_mfma_f32_16x16x32_bf16 v[140:143], a[148:151], a[124:127], v[140:143]
    s_waitcnt lgkmcnt(0)
    v_mfma_f32_16x16x32_bf16 v[240:243], a[152:155], a[112:115], v[240:243]
    v_mfma_f32_16x16x32_bf16 v[244:247], a[152:155], a[116:119], v[244:247]
    v_mfma_f32_16x16x32_bf16 v[248:251], a[152:155], a[120:123], v[248:251]
    v_mfma_f32_16x16x32_bf16 v[252:255], a[152:155], a[124:127], v[252:255]
    v_mul_f32 v128, v128, v240
    v_mul_f32 v129, v129, v241
    v_mul_f32 v130, v130, v242
    v_mul_f32 v131, v131, v243
    v_mul_f32 v132, v132, v244
    v_mul_f32 v133, v133, v245
    v_mul_f32 v134, v134, v246
    v_mul_f32 v135, v135, v247
    v_cvt_pk_bf16_f32 v240, v128, v129
    v_cvt_pk_bf16_f32 v241, v130, v131
    v_cvt_pk_bf16_f32 v242, v132, v133
    v_cvt_pk_bf16_f32 v243, v134, v135
    v_mul_f32 v136, v136, v248
    v_mul_f32 v137, v137, v249
    v_mul_f32 v138, v138, v250
    v_mul_f32 v139, v139, v251
    v_mul_f32 v140, v140, v252
    v_mul_f32 v141, v141, v253
    v_mul_f32 v142, v142, v254
    v_mul_f32 v143, v143, v255
    s_add_u32 s63, s62, 0
    v_permlane16_swap_b32 v240, v242
    v_permlane16_swap_b32 v241, v243
    buffer_store_dwordx4 v[240:243], v4, s[36:39], s63 offen sc1
    v_cvt_pk_bf16_f32 v248, v136, v137
    v_cvt_pk_bf16_f32 v249, v138, v139
    v_cvt_pk_bf16_f32 v250, v140, v141
    v_cvt_pk_bf16_f32 v251, v142, v143
    s_add_u32 s63, s62, 229376
    v_permlane16_swap_b32 v248, v250
    v_permlane16_swap_b32 v249, v251
    buffer_store_dwordx4 v[248:251], v4, s[36:39], s63 offen sc1
L_g2code:
    s_barrier
    ds_read_b64_tr_b16 a[204:205], v26 offset:4096
    ds_read_b64_tr_b16 a[206:207], v26 offset:6144
    ds_read_b64_tr_b16 a[208:209], v27 offset:4096
    ds_read_b64_tr_b16 a[210:211], v27 offset:6144
    ds_read_b64_tr_b16 a[212:213], v28 offset:4096
    ds_read_b64_tr_b16 a[214:215], v28 offset:6144
    ds_read_b64_tr_b16 a[216:217], v29 offset:4096
    ds_read_b64_tr_b16 a[218:219], v29 offset:6144
    ds_read_b64_tr_b16 a[220:221], v26 offset:12288
    ds_read_b64_tr_b16 a[222:223], v26 offset:14336
    ds_read_b64_tr_b16 a[224:225], v27 offset:12288
    ds_read_b64_tr_b16 a[226:227], v27 offset:14336
    ds_read_b64_tr_b16 a[228:229], v28 offset:12288
    ds_read_b64_tr_b16 a[230:231], v28 offset:14336
    s_add_u32 m0, s88, 77824
    s_waitcnt vmcnt(13) lgkmcnt(10)
    v_mfma_f32_16x16x32_bf16 v[64:67], a[204:207], a[0:3], v[64:67]
    ds_read_b64_tr_b16 a[232:233], v29 offset:12288
    buffer_load_dwordx4 v8, s[48:51], s75 offen offset:0  lds
    v_mfma_f32_16x16x32_bf16 v[68:71], a[204:207], a[4:7], v[68:71]
    ds_read_b64_tr_b16 a[234:235], v29 offset:14336
    s_lshr_b32 s78, s75, 6
    v_mfma_f32_16x16x32_bf16 v[72:75], a[208:211], a[0:3], v[72:75]
    ds_read_b64_tr_b16 a[204:205], v26 offset:0
    buffer_load_dwordx4 v9, s[48:51], s75 offen offset:1024  lds
    v_mfma_f32_16x16x32_bf16 v[76:79], a[208:211], a[4:7], v[76:79]
    ds_read_b64_tr_b16 a[206:207], v26 offset:2048
    s_waitcnt lgkmcnt(10)
    v_mfma_f32_16x16x32_bf16 v[80:83], a[212:215], a[0:3], v[80:83]
    ds_read_b64_tr_b16 a[208:209], v27 offset:0
    buffer_load_dwordx4 v10, s[48:51], s75 offen offset:2048  lds
    v_mfma_f32_16x16x32_bf16 v[84:87], a[212:215], a[4:7], v[84:87]
    ds_read_b64_tr_b16 a[210:211], v27 offset:2048
    v_mfma_f32_16x16x32_bf16 v[88:91], a[216:219], a[0:3], v[88:91]
    ds_read_b64_tr_b16 a[212:213], v28 offset:0
    buffer_load_dwordx4 v11, s[48:51], s75 offen offset:3072  lds
    v_mfma_f32_16x16x32_bf16 v[92:95], a[216:219], a[4:7], v[92:95]
    ds_read_b64_tr_b16 a[214:215], v28 offset:2048
    s_waitcnt lgkmcnt(10)
    v_mfma_f32_16x16x32_bf16 v[64:67], a[220:223], a[8:11], v[64:67]
    ds_read_b64_tr_b16 a[216:217], v29 offset:0
    buffer_load_dwordx4 a[32:35], v20, s[36:39], s78 offen sc1
    v_mfma_f32_16x16x32_bf16 v[68:71], a[220:223], a[12:15], v[68:71]
    ds_read_b64_tr_b16 a[218:219], v29 offset:2048
    v_readlane_b32 s75, v25, s76
    v_mfma_f32_16x16x32_bf16 v[72:75], a[224:227], a[8:11], v[72:75]
    ds_read_b64_tr_b16 a[220:221], v26 offset:8192
    buffer_load_dwordx4 a[36:39], v21, s[36:39], s78 offen sc1
    v_mfma_f32_16x16x32_bf16 v[76:79], a[224:227], a[12:15], v[76:79]
    ds_read_b64_tr_b16 a[222:223], v26 offset:10240
    s_waitcnt lgkmcnt(10)
    v_mfma_f32_16x16x32_bf16 v[80:83], a[228:231], a[8:11], v[80:83]
    ds_read_b64_tr_b16 a[224:225], v27 offset:8192
    buffer_load_dwordx4 a[40:43], v18, s[36:39], s78 offen sc1
    v_mfma_f32_16x16x32_bf16 v[84:87], a[228:231], a[12:15], v[84:87]
    ds_read_b64_tr_b16 a[226:227], v27 offset:10240
    s_add_u32 s76, s76, 1
    v_mfma_f32_16x16x32_bf16 v[88:91], a[232:235], a[8:11], v[88:91]
    ds_read_b64_tr_b16 a[228:229], v28 offset:8192
    buffer_load_dwordx4 a[44:47], v19, s[36:39], s78 offen sc1
    v_mfma_f32_16x16x32_bf16 v[92:95], a[232:235], a[12:15], v[92:95]
    ds_read_b64_tr_b16 a[230:231], v28 offset:10240
    s_waitcnt lgkmcnt(10)
    v_mfma_f32_16x16x32_bf16 v[32:35], a[204:207], a[0:3], v[32:35]
    ds_read_b64_tr_b16 a[232:233], v29 offset:8192
    s_waitcnt vmcnt(21)
    v_mfma_f32_16x16x32_bf16 v[36:39], a[204:207], a[4:7], v[36:39]
    ds_read_b64_tr_b16 a[234:235], v29 offset:10240
    s_barrier
    v_mfma_f32_16x16x32_bf16 v[40:43], a[208:211], a[0:3], v[40:43]
    ds_read_b64_tr_b16 a[204:205], v26 offset:20480
    v_mfma_f32_16x16x32_bf16 v[44:47], a[208:211], a[4:7], v[44:47]
    ds_read_b64_tr_b16 a[206:207], v26 offset:22528
    s_waitcnt lgkmcnt(10)
    v_mfma_f32_16x16x32_bf16 v[48:51], a[212:215], a[0:3], v[48:51]
    ds_read_b64_tr_b16 a[208:209], v27 offset:20480
    v_mfma_f32_16x16x32_bf16 v[52:55], a[212:215], a[4:7], v[52:55]
    ds_read_b64_tr_b16 a[210:211], v27 offset:22528
    v_mfma_f32_16x16x32_bf16 v[56:59], a[216:219], a[0:3], v[56:59]
    ds_read_b64_tr_b16 a[212:213], v28 offset:20480
    v_mfma_f32_16x16x32_bf16 v[60:63], a[216:219], a[4:7], v[60:63]
    ds_read_b64_tr_b16 a[214:215], v28 offset:22528
    s_waitcnt lgkmcnt(10)
    v_mfma_f32_16x16x32_bf16 v[32:35], a[220:223], a[8:11], v[32:35]
    ds_read_b64_tr_b16 a[216:217], v29 offset:20480
    v_mfma_f32_16x16x32_bf16 v[36:39], a[220:223], a[12:15], v[36:39]
    ds_read_b64_tr_b16 a[218:219], v29 offset:22528
    v_mfma_f32_16x16x32_bf16 v[40:43], a[224:227], a[8:11], v[40:43]
    ds_read_b64_tr_b16 a[220:221], v26 offset:28672
    v_mfma_f32_16x16x32_bf16 v[44:47], a[224:227], a[12:15], v[44:47]
    ds_read_b64_tr_b16 a[222:223], v26 offset:30720
    s_waitcnt lgkmcnt(10)
    v_mfma_f32_16x16x32_bf16 v[48:51], a[228:231], a[8:11], v[48:51]
    ds_read_b64_tr_b16 a[224:225], v27 offset:28672
    v_mfma_f32_16x16x32_bf16 v[52:55], a[228:231], a[12:15], v[52:55]
    ds_read_b64_tr_b16 a[226:227], v27 offset:30720
    s_add_u32 m0, s88, 94208
    v_mfma_f32_16x16x32_bf16 v[56:59], a[232:235], a[8:11], v[56:59]
    ds_read_b64_tr_b16 a[228:229], v28 offset:28672
    v_mfma_f32_16x16x32_bf16 v[60:63], a[232:235], a[12:15], v[60:63]
    ds_read_b64_tr_b16 a[230:231], v28 offset:30720
    s_waitcnt lgkmcnt(10)
    v_mfma_f32_16x16x32_bf16 v[64:67], a[204:207], a[16:19], v[64:67]
    ds_read_b64_tr_b16 a[232:233], v29 offset:28672
    buffer_load_dwordx4 v8, s[48:51], s75 offen offset:0  lds
    v_mfma_f32_16x16x32_bf16 v[68:71], a[204:207], a[20:23], v[68:71]
    ds_read_b64_tr_b16 a[234:235], v29 offset:30720
    s_lshr_b32 s78, s75, 6
    v_mfma_f32_16x16x32_bf16 v[72:75], a[208:211], a[16:19], v[72:75]
    ds_read_b64_tr_b16 a[204:205], v26 offset:16384
    buffer_load_dwordx4 v9, s[48:51], s75 offen offset:1024  lds
    v_mfma_f32_16x16x32_bf16 v[76:79], a[208:211], a[20:23], v[76:79]
    ds_read_b64_tr_b16 a[206:207], v26 offset:18432
    s_waitcnt lgkmcnt(10)
    v_mfma_f32_16x16x32_bf16 v[80:83], a[212:215], a[16:19], v[80:83]
    ds_read_b64_tr_b16 a[208:209], v27 offset:16384
    buffer_load_dwordx4 v10, s[48:51], s75 offen offset:2048  lds
    v_mfma_f32_16x16x32_bf16 v[84:87], a[212:215], a[20:23], v[84:87]
    ds_read_b64_tr_b16 a[210:211], v27 offset:18432
    v_mfma_f32_16x16x32_bf16 v[88:91], a[216:219], a[16:19], v[88:91]
    ds_read_b64_tr_b16 a[212:213], v28 offset:16384
    buffer_load_dwordx4 v11, s[48:51], s75 offen offset:3072  lds
    v_mfma_f32_16x16x32_bf16 v[92:95], a[216:219], a[20:23], v[92:95]
    ds_read_b64_tr_b16 a[214:215], v28 offset:18432
    s_waitcnt lgkmcnt(10)
    v_mfma_f32_16x16x32_bf16 v[64:67], a[220:223], a[24:27], v[64:67]
    ds_read_b64_tr_b16 a[216:217], v29 offset:16384
    buffer_load_dwordx4 a[48:51], v20, s[36:39], s78 offen sc1
    v_mfma_f32_16x16x32_bf16 v[68:71], a[220:223], a[28:31], v[68:71]
    ds_read_b64_tr_b16 a[218:219], v29 offset:18432
    v_readlane_b32 s75, v25, s76
    v_mfma_f32_16x16x32_bf16 v[72:75], a[224:227], a[24:27], v[72:75]
    ds_read_b64_tr_b16 a[220:221], v26 offset:24576
    buffer_load_dwordx4 a[52:55], v21, s[36:39], s78 offen sc1
    v_mfma_f32_16x16x32_bf16 v[76:79], a[224:227], a[28:31], v[76:79]
    ds_read_b64_tr_b16 a[222:223], v26 offset:26624
    s_waitcnt lgkmcnt(10)
    v_mfma_f32_16x16x32_bf16 v[80:83], a[228:231], a[24:27], v[80:83]
    ds_read_b64_tr_b16 a[224:225], v27 offset:24576
    buffer_load_dwordx4 a[56:59], v18, s[36:39], s78 offen sc1
    v_mfma_f32_16x16x32_bf16 v[84:87], a[228:231], a[28:31], v[84:87]
    ds_read_b64_tr_b16 a[226:227], v27 offset:26624
    s_add_u32 s76, s76, 1
    v_mfma_f32_16x16x32_bf16 v[88:91], a[232:235], a[24:27], v[88:91]
    ds_read_b64_tr_b16 a[228:229], v28 offset:24576
    buffer_load_dwordx4 a[60:63], v19, s[36:39], s78 offen sc1
    v_mfma_f32_16x16x32_bf16 v[92:95], a[232:235], a[28:31], v[92:95]
    ds_read_b64_tr_b16 a[230:231], v28 offset:26624
    s_waitcnt lgkmcnt(10)
    buffer_load_dword v31, v30, s[52:55], s79 offen sc1
    v_mfma_f32_16x16x32_bf16 v[32:35], a[204:207], a[16:19], v[32:35]
    ds_read_b64_tr_b16 a[232:233], v29 offset:24576
    s_waitcnt vmcnt(26)
    v_mfma_f32_16x16x32_bf16 v[36:39], a[204:207], a[20:23], v[36:39]
    ds_read_b64_tr_b16 a[234:235], v29 offset:26624
    s_barrier
    v_mfma_f32_16x16x32_bf16 v[40:43], a[208:211], a[16:19], v[40:43]
    ds_read_b64_tr_b16 a[204:205], v26 offset:36864
    v_mfma_f32_16x16x32_bf16 v[44:47], a[208:211], a[20:23], v[44:47]
    ds_read_b64_tr_b16 a[206:207], v26 offset:38912
    s_waitcnt lgkmcnt(10)
    v_mfma_f32_16x16x32_bf16 v[48:51], a[212:215], a[16:19], v[48:51]
    ds_read_b64_tr_b16 a[208:209], v27 offset:36864
    v_mfma_f32_16x16x32_bf16 v[52:55], a[212:215], a[20:23], v[52:55]
    ds_read_b64_tr_b16 a[210:211], v27 offset:38912
    v_mfma_f32_16x16x32_bf16 v[56:59], a[216:219], a[16:19], v[56:59]
    ds_read_b64_tr_b16 a[212:213], v28 offset:36864
    v_mfma_f32_16x16x32_bf16 v[60:63], a[216:219], a[20:23], v[60:63]
    ds_read_b64_tr_b16 a[214:215], v28 offset:38912
    s_waitcnt lgkmcnt(10)
    v_mfma_f32_16x16x32_bf16 v[32:35], a[220:223], a[24:27], v[32:35]
    ds_read_b64_tr_b16 a[216:217], v29 offset:36864
    v_mfma_f32_16x16x32_bf16 v[36:39], a[220:223], a[28:31], v[36:39]
    ds_read_b64_tr_b16 a[218:219], v29 offset:38912
    v_mfma_f32_16x16x32_bf16 v[40:43], a[224:227], a[24:27], v[40:43]
    ds_read_b64_tr_b16 a[220:221], v26 offset:45056
    v_mfma_f32_16x16x32_bf16 v[44:47], a[224:227], a[28:31], v[44:47]
    ds_read_b64_tr_b16 a[222:223], v26 offset:47104
    s_waitcnt lgkmcnt(10)
    v_mfma_f32_16x16x32_bf16 v[48:51], a[228:231], a[24:27], v[48:51]
    ds_read_b64_tr_b16 a[224:225], v27 offset:45056
    v_mfma_f32_16x16x32_bf16 v[52:55], a[228:231], a[28:31], v[52:55]
    ds_read_b64_tr_b16 a[226:227], v27 offset:47104
    s_add_u32 m0, s88, 28672
    v_mfma_f32_16x16x32_bf16 v[56:59], a[232:235], a[24:27], v[56:59]
    ds_read_b64_tr_b16 a[228:229], v28 offset:45056
    v_mfma_f32_16x16x32_bf16 v[60:63], a[232:235], a[28:31], v[60:63]
    ds_read_b64_tr_b16 a[230:231], v28 offset:47104
    s_waitcnt lgkmcnt(10)
    v_mfma_f32_16x16x32_bf16 v[64:67], a[204:207], a[160:163], v[64:67]
    ds_read_b64_tr_b16 a[232:233], v29 offset:45056
    buffer_load_dwordx4 v8, s[48:51], s75 offen offset:0  lds
    v_mfma_f32_16x16x32_bf16 v[68:71], a[204:207], a[164:167], v[68:71]
    ds_read_b64_tr_b16 a[234:235], v29 offset:47104
    s_lshr_b32 s78, s75, 6
    v_mfma_f32_16x16x32_bf16 v[72:75], a[208:211], a[160:163], v[72:75]
    ds_read_b64_tr_b16 a[204:205], v26 offset:32768
    buffer_load_dwordx4 v9, s[48:51], s75 offen offset:1024  lds
    v_mfma_f32_16x16x32_bf16 v[76:79], a[208:211], a[164:167], v[76:79]
    ds_read_b64_tr_b16 a[206:207], v26 offset:34816
    s_waitcnt lgkmcnt(10)
    v_mfma_f32_16x16x32_bf16 v[80:83], a[212:215], a[160:163], v[80:83]
    ds_read_b64_tr_b16 a[208:209], v27 offset:32768
    buffer_load_dwordx4 v10, s[48:51], s75 offen offset:2048  lds
    v_mfma_f32_16x16x32_bf16 v[84:87], a[212:215], a[164:167], v[84:87]
    ds_read_b64_tr_b16 a[210:211], v27 offset:34816
    v_mfma_f32_16x16x32_bf16 v[88:91], a[216:219], a[160:163], v[88:91]
    ds_read_b64_tr_b16 a[212:213], v28 offset:32768
    buffer_load_dwordx4 v11, s[48:51], s75 offen offset:3072  lds
    v_mfma_f32_16x16x32_bf16 v[92:95], a[216:219], a[164:167], v[92:95]
    ds_read_b64_tr_b16 a[214:215], v28 offset:34816
    s_waitcnt lgkmcnt(10)
    v_mfma_f32_16x16x32_bf16 v[64:67], a[220:223], a[168:171], v[64:67]
    ds_read_b64_tr_b16 a[216:217], v29 offset:32768
    buffer_load_dwordx4 a[0:3], v20, s[36:39], s78 offen sc1
    v_mfma_f32_16x16x32_bf16 v[68:71], a[220:223], a[172:175], v[68:71]
    ds_read_b64_tr_b16 a[218:219], v29 offset:34816
    v_readlane_b32 s75, v25, s76
    v_mfma_f32_16x16x32_bf16 v[72:75], a[224:227], a[168:171], v[72:75]
    ds_read_b64_tr_b16 a[220:221], v26 offset:40960
    buffer_load_dwordx4 a[4:7], v21, s[36:39], s78 offen sc1
    v_mfma_f32_16x16x32_bf16 v[76:79], a[224:227], a[172:175], v[76:79]
    ds_read_b64_tr_b16 a[222:223], v26 offset:43008
    s_waitcnt lgkmcnt(10)
    v_mfma_f32_16x16x32_bf16 v[80:83], a[228:231], a[168:171], v[80:83]
    ds_read_b64_tr_b16 a[224:225], v27 offset:40960
    buffer_load_dwordx4 a[8:11], v18, s[36:39], s78 offen sc1
    v_mfma_f32_16x16x32_bf16 v[84:87], a[228:231], a[172:175], v[84:87]
    ds_read_b64_tr_b16 a[226:227], v27 offset:43008
    s_add_u32 s76, s76, 1
    v_mfma_f32_16x16x32_bf16 v[88:91], a[232:235], a[168:171], v[88:91]
    ds_read_b64_tr_b16 a[228:229], v28 offset:40960
    buffer_load_dwordx4 a[12:15], v19, s[36:39], s78 offen sc1
    v_mfma_f32_16x16x32_bf16 v[92:95], a[232:235], a[172:175], v[92:95]
    ds_read_b64_tr_b16 a[230:231], v28 offset:43008
    s_waitcnt lgkmcnt(10)
    v_mfma_f32_16x16x32_bf16 v[32:35], a[204:207], a[160:163], v[32:35]
    ds_read_b64_tr_b16 a[232:233], v29 offset:40960
    s_waitcnt vmcnt(30)
    v_mfma_f32_16x16x32_bf16 v[36:39], a[204:207], a[164:167], v[36:39]
    ds_read_b64_tr_b16 a[234:235], v29 offset:43008
    s_barrier
    v_mfma_f32_16x16x32_bf16 v[40:43], a[208:211], a[160:163], v[40:43]
    ds_read_b64_tr_b16 a[204:205], v12 offset:53248
    s_waitcnt vmcnt(25)
    v_mfma_f32_16x16x32_bf16 v[44:47], a[208:211], a[164:167], v[44:47]
    ds_read_b64_tr_b16 a[206:207], v12 offset:55296
    s_waitcnt lgkmcnt(10)
    v_mfma_f32_16x16x32_bf16 v[48:51], a[212:215], a[160:163], v[48:51]
    ds_read_b64_tr_b16 a[208:209], v13 offset:53248
    buffer_atomic_add v6, v5, s[52:55], s77 offen
    v_mfma_f32_16x16x32_bf16 v[52:55], a[212:215], a[164:167], v[52:55]
    ds_read_b64_tr_b16 a[210:211], v13 offset:55296
    v_mfma_f32_16x16x32_bf16 v[56:59], a[216:219], a[160:163], v[56:59]
    ds_read_b64_tr_b16 a[212:213], v14 offset:53248
    v_mfma_f32_16x16x32_bf16 v[60:63], a[216:219], a[164:167], v[60:63]
    ds_read_b64_tr_b16 a[214:215], v14 offset:55296
    s_waitcnt lgkmcnt(10)
    v_mfma_f32_16x16x32_bf16 v[32:35], a[220:223], a[168:171], v[32:35]
    ds_read_b64_tr_b16 a[216:217], v15 offset:53248
    v_mfma_f32_16x16x32_bf16 v[36:39], a[220:223], a[172:175], v[36:39]
    ds_read_b64_tr_b16 a[218:219], v15 offset:55296
    v_mfma_f32_16x16x32_bf16 v[40:43], a[224:227], a[168:171], v[40:43]
    ds_read_b64_tr_b16 a[220:221], v12 offset:61440
    v_mfma_f32_16x16x32_bf16 v[44:47], a[224:227], a[172:175], v[44:47]
    ds_read_b64_tr_b16 a[222:223], v12 offset:63488
    s_waitcnt lgkmcnt(10)
    v_mfma_f32_16x16x32_bf16 v[48:51], a[228:231], a[168:171], v[48:51]
    ds_read_b64_tr_b16 a[224:225], v13 offset:61440
    v_mfma_f32_16x16x32_bf16 v[52:55], a[228:231], a[172:175], v[52:55]
    ds_read_b64_tr_b16 a[226:227], v13 offset:63488
    s_add_u32 m0, s88, 45056
    v_mfma_f32_16x16x32_bf16 v[56:59], a[232:235], a[168:171], v[56:59]
    ds_read_b64_tr_b16 a[228:229], v14 offset:61440
    v_mfma_f32_16x16x32_bf16 v[60:63], a[232:235], a[172:175], v[60:63]
    ds_read_b64_tr_b16 a[230:231], v14 offset:63488
    s_waitcnt lgkmcnt(10)
    v_mfma_f32_16x16x32_bf16 v[64:67], a[204:207], a[176:179], v[64:67]
    ds_read_b64_tr_b16 a[232:233], v15 offset:61440
    buffer_load_dwordx4 v8, s[48:51], s75 offen offset:0  lds
    v_mfma_f32_16x16x32_bf16 v[68:71], a[204:207], a[180:183], v[68:71]
    ds_read_b64_tr_b16 a[234:235], v15 offset:63488
    s_lshr_b32 s78, s75, 6
    v_mfma_f32_16x16x32_bf16 v[72:75], a[208:211], a[176:179], v[72:75]
    ds_read_b64_tr_b16 a[204:205], v12 offset:49152
    buffer_load_dwordx4 v9, s[48:51], s75 offen offset:1024  lds
    v_mfma_f32_16x16x32_bf16 v[76:79], a[208:211], a[180:183], v[76:79]
    ds_read_b64_tr_b16 a[206:207], v12 offset:51200
    s_waitcnt lgkmcnt(10)
    v_mfma_f32_16x16x32_bf16 v[80:83], a[212:215], a[176:179], v[80:83]
    ds_read_b64_tr_b16 a[208:209], v13 offset:49152
    buffer_load_dwordx4 v10, s[48:51], s75 offen offset:2048  lds
    v_mfma_f32_16x16x32_bf16 v[84:87], a[212:215], a[180:183], v[84:87]
    ds_read_b64_tr_b16 a[210:211], v13 offset:51200
    v_mfma_f32_16x16x32_bf16 v[88:91], a[216:219], a[176:179], v[88:91]
    ds_read_b64_tr_b16 a[212:213], v14 offset:49152
    buffer_load_dwordx4 v11, s[48:51], s75 offen offset:3072  lds
    v_mfma_f32_16x16x32_bf16 v[92:95], a[216:219], a[180:183], v[92:95]
    ds_read_b64_tr_b16 a[214:215], v14 offset:51200
    s_waitcnt lgkmcnt(10)
    v_mfma_f32_16x16x32_bf16 v[64:67], a[220:223], a[184:187], v[64:67]
    ds_read_b64_tr_b16 a[216:217], v15 offset:49152
    buffer_load_dwordx4 a[16:19], v20, s[36:39], s78 offen sc1
    v_mfma_f32_16x16x32_bf16 v[68:71], a[220:223], a[188:191], v[68:71]
    ds_read_b64_tr_b16 a[218:219], v15 offset:51200
    v_readlane_b32 s75, v25, s76
    v_mfma_f32_16x16x32_bf16 v[72:75], a[224:227], a[184:187], v[72:75]
    ds_read_b64_tr_b16 a[220:221], v12 offset:57344
    buffer_load_dwordx4 a[20:23], v21, s[36:39], s78 offen sc1
    v_mfma_f32_16x16x32_bf16 v[76:79], a[224:227], a[188:191], v[76:79]
    ds_read_b64_tr_b16 a[222:223], v12 offset:59392
    s_waitcnt lgkmcnt(10)
    v_mfma_f32_16x16x32_bf16 v[80:83], a[228:231], a[184:187], v[80:83]
    ds_read_b64_tr_b16 a[224:225], v13 offset:57344
    buffer_load_dwordx4 a[24:27], v18, s[36:39], s78 offen sc1
    v_mfma_f32_16x16x32_bf16 v[84:87], a[228:231], a[188:191], v[84:87]
    ds_read_b64_tr_b16 a[226:227], v13 offset:59392
    s_add_u32 s76, s76, 1
    v_mfma_f32_16x16x32_bf16 v[88:91], a[232:235], a[184:187], v[88:91]
    ds_read_b64_tr_b16 a[228:229], v14 offset:57344
    buffer_load_dwordx4 a[28:31], v19, s[36:39], s78 offen sc1
    v_mfma_f32_16x16x32_bf16 v[92:95], a[232:235], a[188:191], v[92:95]
    ds_read_b64_tr_b16 a[230:231], v14 offset:59392
    s_waitcnt lgkmcnt(10)
    v_mfma_f32_16x16x32_bf16 v[32:35], a[204:207], a[176:179], v[32:35]
    ds_read_b64_tr_b16 a[232:233], v15 offset:57344
    s_waitcnt vmcnt(26)
    v_mfma_f32_16x16x32_bf16 v[36:39], a[204:207], a[180:183], v[36:39]
    ds_read_b64_tr_b16 a[234:235], v15 offset:59392
    s_barrier
    v_mfma_f32_16x16x32_bf16 v[40:43], a[208:211], a[176:179], v[40:43]
    ds_read_b64_tr_b16 a[204:205], v26 offset:53248
    v_mfma_f32_16x16x32_bf16 v[44:47], a[208:211], a[180:183], v[44:47]
    ds_read_b64_tr_b16 a[206:207], v26 offset:55296
    s_waitcnt lgkmcnt(10)
    v_mfma_f32_16x16x32_bf16 v[48:51], a[212:215], a[176:179], v[48:51]
    ds_read_b64_tr_b16 a[208:209], v27 offset:53248
    v_mfma_f32_16x16x32_bf16 v[52:55], a[212:215], a[180:183], v[52:55]
    ds_read_b64_tr_b16 a[210:211], v27 offset:55296
    v_mfma_f32_16x16x32_bf16 v[56:59], a[216:219], a[176:179], v[56:59]
    ds_read_b64_tr_b16 a[212:213], v28 offset:53248
    v_mfma_f32_16x16x32_bf16 v[60:63], a[216:219], a[180:183], v[60:63]
    ds_read_b64_tr_b16 a[214:215], v28 offset:55296
    s_waitcnt lgkmcnt(10)
    v_mfma_f32_16x16x32_bf16 v[32:35], a[220:223], a[184:187], v[32:35]
    ds_read_b64_tr_b16 a[216:217], v29 offset:53248
    v_mfma_f32_16x16x32_bf16 v[36:39], a[220:223], a[188:191], v[36:39]
    ds_read_b64_tr_b16 a[218:219], v29 offset:55296
    v_mfma_f32_16x16x32_bf16 v[40:43], a[224:227], a[184:187], v[40:43]
    ds_read_b64_tr_b16 a[220:221], v26 offset:61440
    v_mfma_f32_16x16x32_bf16 v[44:47], a[224:227], a[188:191], v[44:47]
    ds_read_b64_tr_b16 a[222:223], v26 offset:63488
    s_waitcnt lgkmcnt(10)
    v_mfma_f32_16x16x32_bf16 v[48:51], a[228:231], a[184:187], v[48:51]
    ds_read_b64_tr_b16 a[224:225], v27 offset:61440
    v_mfma_f32_16x16x32_bf16 v[52:55], a[228:231], a[188:191], v[52:55]
    ds_read_b64_tr_b16 a[226:227], v27 offset:63488
    s_add_u32 m0, s88, 61440
    v_mfma_f32_16x16x32_bf16 v[56:59], a[232:235], a[184:187], v[56:59]
    ds_read_b64_tr_b16 a[228:229], v28 offset:61440
    v_mfma_f32_16x16x32_bf16 v[60:63], a[232:235], a[188:191], v[60:63]
    ds_read_b64_tr_b16 a[230:231], v28 offset:63488
    s_waitcnt lgkmcnt(10)
    v_mfma_f32_16x16x32_bf16 v[64:67], a[204:207], a[32:35], v[64:67]
    ds_read_b64_tr_b16 a[232:233], v29 offset:61440
    buffer_load_dwordx4 v8, s[48:51], s75 offen offset:0  lds
    v_mfma_f32_16x16x32_bf16 v[68:71], a[204:207], a[36:39], v[68:71]
    ds_read_b64_tr_b16 a[234:235], v29 offset:63488
    s_lshr_b32 s78, s75, 6
    v_mfma_f32_16x16x32_bf16 v[72:75], a[208:211], a[32:35], v[72:75]
    ds_read_b64_tr_b16 a[204:205], v26 offset:49152
    buffer_load_dwordx4 v9, s[48:51], s75 offen offset:1024  lds
    v_mfma_f32_16x16x32_bf16 v[76:79], a[208:211], a[36:39], v[76:79]
    ds_read_b64_tr_b16 a[206:207], v26 offset:51200
    s_waitcnt lgkmcnt(10)
    v_mfma_f32_16x16x32_bf16 v[80:83], a[212:215], a[32:35], v[80:83]
    ds_read_b64_tr_b16 a[208:209], v27 offset:49152
    buffer_load_dwordx4 v10, s[48:51], s75 offen offset:2048  lds
    v_mfma_f32_16x16x32_bf16 v[84:87], a[212:215], a[36:39], v[84:87]
    ds_read_b64_tr_b16 a[210:211], v27 offset:51200
    s_waitcnt vmcnt(20)
    v_mfma_f32_16x16x32_bf16 v[88:91], a[216:219], a[32:35], v[88:91]
    ds_read_b64_tr_b16 a[212:213], v28 offset:49152
    v_cmp_gt_u32 vcc, 16, v31
    buffer_load_dwordx4 v11, s[48:51], s75 offen offset:3072  lds
    v_mfma_f32_16x16x32_bf16 v[92:95], a[216:219], a[36:39], v[92:95]
    ds_read_b64_tr_b16 a[214:215], v28 offset:51200
    s_waitcnt lgkmcnt(10)
    s_cbranch_vccnz L_c4t_1024
L_c4u_1025:
    v_mfma_f32_16x16x32_bf16 v[64:67], a[220:223], a[40:43], v[64:67]
    ds_read_b64_tr_b16 a[216:217], v29 offset:49152
    buffer_load_dwordx4 a[160:163], v20, s[36:39], s78 offen sc1
    v_mfma_f32_16x16x32_bf16 v[68:71], a[220:223], a[44:47], v[68:71]
    ds_read_b64_tr_b16 a[218:219], v29 offset:51200
    v_readlane_b32 s75, v25, s76
    v_mfma_f32_16x16x32_bf16 v[72:75], a[224:227], a[40:43], v[72:75]
    ds_read_b64_tr_b16 a[220:221], v26 offset:57344
    buffer_load_dwordx4 a[164:167], v21, s[36:39], s78 offen sc1
    v_mfma_f32_16x16x32_bf16 v[76:79], a[224:227], a[44:47], v[76:79]
    ds_read_b64_tr_b16 a[222:223], v26 offset:59392
    s_waitcnt lgkmcnt(10)
    v_mfma_f32_16x16x32_bf16 v[80:83], a[228:231], a[40:43], v[80:83]
    ds_read_b64_tr_b16 a[224:225], v27 offset:57344
    buffer_load_dwordx4 a[168:171], v18, s[36:39], s78 offen sc1
    v_mfma_f32_16x16x32_bf16 v[84:87], a[228:231], a[44:47], v[84:87]
    ds_read_b64_tr_b16 a[226:227], v27 offset:59392
    s_add_u32 s76, s76, 1
    v_mfma_f32_16x16x32_bf16 v[88:91], a[232:235], a[40:43], v[88:91]
    ds_read_b64_tr_b16 a[228:229], v28 offset:57344
    buffer_load_dwordx4 a[172:175], v19, s[36:39], s78 offen sc1
    v_mfma_f32_16x16x32_bf16 v[92:95], a[232:235], a[44:47], v[92:95]
    ds_read_b64_tr_b16 a[230:231], v28 offset:59392
    s_waitcnt lgkmcnt(10)
    v_mfma_f32_16x16x32_bf16 v[32:35], a[204:207], a[32:35], v[32:35]
    ds_read_b64_tr_b16 a[232:233], v29 offset:57344
    s_waitcnt vmcnt(26)
    v_mfma_f32_16x16x32_bf16 v[36:39], a[204:207], a[36:39], v[36:39]
    ds_read_b64_tr_b16 a[234:235], v29 offset:59392
    s_barrier
    v_mfma_f32_16x16x32_bf16 v[40:43], a[208:211], a[32:35], v[40:43]
    ds_read_b64_tr_b16 a[204:205], v12 offset:4096
    v_mfma_f32_16x16x32_bf16 v[44:47], a[208:211], a[36:39], v[44:47]
    ds_read_b64_tr_b16 a[206:207], v12 offset:6144
    s_waitcnt lgkmcnt(10)
    v_mfma_f32_16x16x32_bf16 v[48:51], a[212:215], a[32:35], v[48:51]
    ds_read_b64_tr_b16 a[208:209], v13 offset:4096
    v_mfma_f32_16x16x32_bf16 v[52:55], a[212:215], a[36:39], v[52:55]
    ds_read_b64_tr_b16 a[210:211], v13 offset:6144
    v_mfma_f32_16x16x32_bf16 v[56:59], a[216:219], a[32:35], v[56:59]
    ds_read_b64_tr_b16 a[212:213], v14 offset:4096
    v_mfma_f32_16x16x32_bf16 v[60:63], a[216:219], a[36:39], v[60:63]
    ds_read_b64_tr_b16 a[214:215], v14 offset:6144
    s_waitcnt lgkmcnt(10)
    v_mfma_f32_16x16x32_bf16 v[32:35], a[220:223], a[40:43], v[32:35]
    ds_read_b64_tr_b16 a[216:217], v15 offset:4096
    v_mfma_f32_16x16x32_bf16 v[36:39], a[220:223], a[44:47], v[36:39]
    ds_read_b64_tr_b16 a[218:219], v15 offset:6144
    v_mfma_f32_16x16x32_bf16 v[40:43], a[224:227], a[40:43], v[40:43]
    ds_read_b64_tr_b16 a[220:221], v12 offset:12288
    v_mfma_f32_16x16x32_bf16 v[44:47], a[224:227], a[44:47], v[44:47]
    ds_read_b64_tr_b16 a[222:223], v12 offset:14336
    s_waitcnt lgkmcnt(10)
    v_mfma_f32_16x16x32_bf16 v[48:51], a[228:231], a[40:43], v[48:51]
    ds_read_b64_tr_b16 a[224:225], v13 offset:12288
    v_mfma_f32_16x16x32_bf16 v[52:55], a[228:231], a[44:47], v[52:55]
    ds_read_b64_tr_b16 a[226:227], v13 offset:14336
    s_add_u32 m0, s88, 143360
    v_mfma_f32_16x16x32_bf16 v[56:59], a[232:235], a[40:43], v[56:59]
    ds_read_b64_tr_b16 a[228:229], v14 offset:12288
    v_mfma_f32_16x16x32_bf16 v[60:63], a[232:235], a[44:47], v[60:63]
    ds_read_b64_tr_b16 a[230:231], v14 offset:14336
    s_waitcnt lgkmcnt(10)
    v_mfma_f32_16x16x32_bf16 v[64:67], a[204:207], a[48:51], v[64:67]
    ds_read_b64_tr_b16 a[232:233], v15 offset:12288
    buffer_load_dwordx4 v8, s[48:51], s75 offen offset:0  lds
    v_mfma_f32_16x16x32_bf16 v[68:71], a[204:207], a[52:55], v[68:71]
    ds_read_b64_tr_b16 a[234:235], v15 offset:14336
    s_lshr_b32 s78, s75, 6
    v_mfma_f32_16x16x32_bf16 v[72:75], a[208:211], a[48:51], v[72:75]
    ds_read_b64_tr_b16 a[204:205], v12 offset:0
    buffer_load_dwordx4 v9, s[48:51], s75 offen offset:1024  lds
    v_mfma_f32_16x16x32_bf16 v[76:79], a[208:211], a[52:55], v[76:79]
    ds_read_b64_tr_b16 a[206:207], v12 offset:2048
    s_waitcnt lgkmcnt(10)
    v_mfma_f32_16x16x32_bf16 v[80:83], a[212:215], a[48:51], v[80:83]
    ds_read_b64_tr_b16 a[208:209], v13 offset:0
    buffer_load_dwordx4 v10, s[48:51], s75 offen offset:2048  lds
    v_mfma_f32_16x16x32_bf16 v[84:87], a[212:215], a[52:55], v[84:87]
    ds_read_b64_tr_b16 a[210:211], v13 offset:2048
    v_mfma_f32_16x16x32_bf16 v[88:91], a[216:219], a[48:51], v[88:91]
    ds_read_b64_tr_b16 a[212:213], v14 offset:0
    buffer_load_dwordx4 v11, s[48:51], s75 offen offset:3072  lds
    v_mfma_f32_16x16x32_bf16 v[92:95], a[216:219], a[52:55], v[92:95]
    ds_read_b64_tr_b16 a[214:215], v14 offset:2048
    s_waitcnt lgkmcnt(10)
    v_mfma_f32_16x16x32_bf16 v[64:67], a[220:223], a[56:59], v[64:67]
    ds_read_b64_tr_b16 a[216:217], v15 offset:0
    buffer_load_dwordx4 a[176:179], v20, s[36:39], s78 offen sc1
    v_mfma_f32_16x16x32_bf16 v[68:71], a[220:223], a[60:63], v[68:71]
    ds_read_b64_tr_b16 a[218:219], v15 offset:2048
    v_readlane_b32 s75, v25, s76
    v_mfma_f32_16x16x32_bf16 v[72:75], a[224:227], a[56:59], v[72:75]
    ds_read_b64_tr_b16 a[220:221], v12 offset:8192
    buffer_load_dwordx4 a[180:183], v21, s[36:39], s78 offen sc1
    v_mfma_f32_16x16x32_bf16 v[76:79], a[224:227], a[60:63], v[76:79]
    ds_read_b64_tr_b16 a[222:223], v12 offset:10240
    s_waitcnt lgkmcnt(10)
    v_mfma_f32_16x16x32_bf16 v[80:83], a[228:231], a[56:59], v[80:83]
    ds_read_b64_tr_b16 a[224:225], v13 offset:8192
    buffer_load_dwordx4 a[184:187], v18, s[36:39], s78 offen sc1
    v_mfma_f32_16x16x32_bf16 v[84:87], a[228:231], a[60:63], v[84:87]
    ds_read_b64_tr_b16 a[226:227], v13 offset:10240
    s_add_u32 s76, s76, 1
    v_mfma_f32_16x16x32_bf16 v[88:91], a[232:235], a[56:59], v[88:91]
    ds_read_b64_tr_b16 a[228:229], v14 offset:8192
    buffer_load_dwordx4 a[188:191], v19, s[36:39], s78 offen sc1
    v_mfma_f32_16x16x32_bf16 v[92:95], a[232:235], a[60:63], v[92:95]
    ds_read_b64_tr_b16 a[230:231], v14 offset:10240
    s_waitcnt lgkmcnt(10)
    v_mfma_f32_16x16x32_bf16 v[32:35], a[204:207], a[48:51], v[32:35]
    ds_read_b64_tr_b16 a[232:233], v15 offset:8192
    s_waitcnt vmcnt(25)
    v_mfma_f32_16x16x32_bf16 v[36:39], a[204:207], a[52:55], v[36:39]
    ds_read_b64_tr_b16 a[234:235], v15 offset:10240
    s_barrier
    v_mfma_f32_16x16x32_bf16 v[40:43], a[208:211], a[48:51], v[40:43]
    ds_read_b64_tr_b16 a[204:205], v26 offset:4096
    v_mfma_f32_16x16x32_bf16 v[44:47], a[208:211], a[52:55], v[44:47]
    ds_read_b64_tr_b16 a[206:207], v26 offset:6144
    s_waitcnt lgkmcnt(10)
    v_mfma_f32_16x16x32_bf16 v[48:51], a[212:215], a[48:51], v[48:51]
    ds_read_b64_tr_b16 a[208:209], v27 offset:4096
    v_mfma_f32_16x16x32_bf16 v[52:55], a[212:215], a[52:55], v[52:55]
    ds_read_b64_tr_b16 a[210:211], v27 offset:6144
    v_mfma_f32_16x16x32_bf16 v[56:59], a[216:219], a[48:51], v[56:59]
    ds_read_b64_tr_b16 a[212:213], v28 offset:4096
    v_mfma_f32_16x16x32_bf16 v[60:63], a[216:219], a[52:55], v[60:63]
    ds_read_b64_tr_b16 a[214:215], v28 offset:6144
    s_waitcnt lgkmcnt(10)
    v_mfma_f32_16x16x32_bf16 v[32:35], a[220:223], a[56:59], v[32:35]
    ds_read_b64_tr_b16 a[216:217], v29 offset:4096
    v_mfma_f32_16x16x32_bf16 v[36:39], a[220:223], a[60:63], v[36:39]
    ds_read_b64_tr_b16 a[218:219], v29 offset:6144
    v_mfma_f32_16x16x32_bf16 v[40:43], a[224:227], a[56:59], v[40:43]
    ds_read_b64_tr_b16 a[220:221], v26 offset:12288
    v_mfma_f32_16x16x32_bf16 v[44:47], a[224:227], a[60:63], v[44:47]
    ds_read_b64_tr_b16 a[222:223], v26 offset:14336
    s_waitcnt lgkmcnt(10)
    v_mfma_f32_16x16x32_bf16 v[48:51], a[228:231], a[56:59], v[48:51]
    ds_read_b64_tr_b16 a[224:225], v27 offset:12288
    v_mfma_f32_16x16x32_bf16 v[52:55], a[228:231], a[60:63], v[52:55]
    ds_read_b64_tr_b16 a[226:227], v27 offset:14336
    s_add_u32 m0, s88, 77824
    v_mfma_f32_16x16x32_bf16 v[56:59], a[232:235], a[56:59], v[56:59]
    ds_read_b64_tr_b16 a[228:229], v28 offset:12288
    v_mfma_f32_16x16x32_bf16 v[60:63], a[232:235], a[60:63], v[60:63]
    ds_read_b64_tr_b16 a[230:231], v28 offset:14336
    s_waitcnt lgkmcnt(10)
    s_mov_b32 s81, 3
L_g2_1026:
    v_mfma_f32_16x16x32_bf16 v[64:67], a[204:207], a[0:3], v[64:67]
    ds_read_b64_tr_b16 a[232:233], v29 offset:12288
    buffer_load_dwordx4 v8, s[48:51], s75 offen offset:0  lds
    v_mfma_f32_16x16x32_bf16 v[68:71], a[204:207], a[4:7], v[68:71]
    ds_read_b64_tr_b16 a[234:235], v29 offset:14336
    s_lshr_b32 s78, s75, 6
    v_mfma_f32_16x16x32_bf16 v[72:75], a[208:211], a[0:3], v[72:75]
    ds_read_b64_tr_b16 a[204:205], v26 offset:0
    buffer_load_dwordx4 v9, s[48:51], s75 offen offset:1024  lds
    v_mfma_f32_16x16x32_bf16 v[76:79], a[208:211], a[4:7], v[76:79]
    ds_read_b64_tr_b16 a[206:207], v26 offset:2048
    s_waitcnt lgkmcnt(10)
    v_mfma_f32_16x16x32_bf16 v[80:83], a[212:215], a[0:3], v[80:83]
    ds_read_b64_tr_b16 a[208:209], v27 offset:0
    buffer_load_dwordx4 v10, s[48:51], s75 offen offset:2048  lds
    v_mfma_f32_16x16x32_bf16 v[84:87], a[212:215], a[4:7], v[84:87]
    ds_read_b64_tr_b16 a[210:211], v27 offset:2048
    s_waitcnt vmcnt(19)
    v_mfma_f32_16x16x32_bf16 v[88:91], a[216:219], a[0:3], v[88:91]
    ds_read_b64_tr_b16 a[212:213], v28 offset:0
    v_cmp_gt_u32 vcc, 16, v31
    buffer_load_dwordx4 v11, s[48:51], s75 offen offset:3072  lds
    v_mfma_f32_16x16x32_bf16 v[92:95], a[216:219], a[4:7], v[92:95]
    ds_read_b64_tr_b16 a[214:215], v28 offset:2048
    s_waitcnt lgkmcnt(10)
    s_cbranch_vccnz L_c4t_1027
L_c4u_1028:
    v_mfma_f32_16x16x32_bf16 v[64:67], a[220:223], a[8:11], v[64:67]
    ds_read_b64_tr_b16 a[216:217], v29 offset:0
    buffer_load_dwordx4 a[32:35], v20, s[36:39], s78 offen sc1
    v_mfma_f32_16x16x32_bf16 v[68:71], a[220:223], a[12:15], v[68:71]
    ds_read_b64_tr_b16 a[218:219], v29 offset:2048
    v_readlane_b32 s75, v25, s76
    v_mfma_f32_16x16x32_bf16 v[72:75], a[224:227], a[8:11], v[72:75]
    ds_read_b64_tr_b16 a[220:221], v26 offset:8192
    buffer_load_dwordx4 a[36:39], v21, s[36:39], s78 offen sc1
    v_mfma_f32_16x16x32_bf16 v[76:79], a[224:227], a[12:15], v[76:79]
    ds_read_b64_tr_b16 a[222:223], v26 offset:10240
    s_waitcnt lgkmcnt(10)
    v_mfma_f32_16x16x32_bf16 v[80:83], a[228:231], a[8:11], v[80:83]
    ds_read_b64_tr_b16 a[224:225], v27 offset:8192
    buffer_load_dwordx4 a[40:43], v18, s[36:39], s78 offen sc1
    v_mfma_f32_16x16x32_bf16 v[84:87], a[228:231], a[12:15], v[84:87]
    ds_read_b64_tr_b16 a[226:227], v27 offset:10240
    s_add_u32 s76, s76, 1
    v_mfma_f32_16x16x32_bf16 v[88:91], a[232:235], a[8:11], v[88:91]
    ds_read_b64_tr_b16 a[228:229], v28 offset:8192
    buffer_load_dwordx4 a[44:47], v19, s[36:39], s78 offen sc1
    v_mfma_f32_16x16x32_bf16 v[92:95], a[232:235], a[12:15], v[92:95]
    ds_read_b64_tr_b16 a[230:231], v28 offset:10240
    s_waitcnt lgkmcnt(10)
    v_mfma_f32_16x16x32_bf16 v[32:35], a[204:207], a[0:3], v[32:35]
    ds_read_b64_tr_b16 a[232:233], v29 offset:8192
    s_waitcnt vmcnt(25)
    v_mfma_f32_16x16x32_bf16 v[36:39], a[204:207], a[4:7], v[36:39]
    ds_read_b64_tr_b16 a[234:235], v29 offset:10240
    s_barrier
    v_mfma_f32_16x16x32_bf16 v[40:43], a[208:211], a[0:3], v[40:43]
    ds_read_b64_tr_b16 a[204:205], v26 offset:20480
    v_mfma_f32_16x16x32_bf16 v[44:47], a[208:211], a[4:7], v[44:47]
    ds_read_b64_tr_b16 a[206:207], v26 offset:22528
    s_waitcnt lgkmcnt(10)
    v_mfma_f32_16x16x32_bf16 v[48:51], a[212:215], a[0:3], v[48:51]
    ds_read_b64_tr_b16 a[208:209], v27 offset:20480
    v_mfma_f32_16x16x32_bf16 v[52:55], a[212:215], a[4:7], v[52:55]
    ds_read_b64_tr_b16 a[210:211], v27 offset:22528
    v_mfma_f32_16x16x32_bf16 v[56:59], a[216:219], a[0:3], v[56:59]
    ds_read_b64_tr_b16 a[212:213], v28 offset:20480
    v_mfma_f32_16x16x32_bf16 v[60:63], a[216:219], a[4:7], v[60:63]
    ds_read_b64_tr_b16 a[214:215], v28 offset:22528
    s_waitcnt lgkmcnt(10)
    v_mfma_f32_16x16x32_bf16 v[32:35], a[220:223], a[8:11], v[32:35]
    ds_read_b64_tr_b16 a[216:217], v29 offset:20480
    v_mfma_f32_16x16x32_bf16 v[36:39], a[220:223], a[12:15], v[36:39]
    ds_read_b64_tr_b16 a[218:219], v29 offset:22528
    v_mfma_f32_16x16x32_bf16 v[40:43], a[224:227], a[8:11], v[40:43]
    ds_read_b64_tr_b16 a[220:221], v26 offset:28672
    v_mfma_f32_16x16x32_bf16 v[44:47], a[224:227], a[12:15], v[44:47]
    ds_read_b64_tr_b16 a[222:223], v26 offset:30720
    s_waitcnt lgkmcnt(10)
    v_mfma_f32_16x16x32_bf16 v[48:51], a[228:231], a[8:11], v[48:51]
    ds_read_b64_tr_b16 a[224:225], v27 offset:28672
    v_mfma_f32_16x16x32_bf16 v[52:55], a[228:231], a[12:15], v[52:55]
    ds_read_b64_tr_b16 a[226:227], v27 offset:30720
    s_add_u32 m0, s88, 94208
    v_mfma_f32_16x16x32_bf16 v[56:59], a[232:235], a[8:11], v[56:59]
    ds_read_b64_tr_b16 a[228:229], v28 offset:28672
    v_mfma_f32_16x16x32_bf16 v[60:63], a[232:235], a[12:15], v[60:63]
    ds_read_b64_tr_b16 a[230:231], v28 offset:30720
    s_waitcnt lgkmcnt(10)
    v_mfma_f32_16x16x32_bf16 v[64:67], a[204:207], a[16:19], v[64:67]
    ds_read_b64_tr_b16 a[232:233], v29 offset:28672
    buffer_load_dwordx4 v8, s[48:51], s75 offen offset:0  lds
    v_mfma_f32_16x16x32_bf16 v[68:71], a[204:207], a[20:23], v[68:71]
    ds_read_b64_tr_b16 a[234:235], v29 offset:30720
    s_lshr_b32 s78, s75, 6
    v_mfma_f32_16x16x32_bf16 v[72:75], a[208:211], a[16:19], v[72:75]
    ds_read_b64_tr_b16 a[204:205], v26 offset:16384
    buffer_load_dwordx4 v9, s[48:51], s75 offen offset:1024  lds
    v_mfma_f32_16x16x32_bf16 v[76:79], a[208:211], a[20:23], v[76:79]
    ds_read_b64_tr_b16 a[206:207], v26 offset:18432
    s_waitcnt lgkmcnt(10)
    v_mfma_f32_16x16x32_bf16 v[80:83], a[212:215], a[16:19], v[80:83]
    ds_read_b64_tr_b16 a[208:209], v27 offset:16384
    buffer_load_dwordx4 v10, s[48:51], s75 offen offset:2048  lds
    v_mfma_f32_16x16x32_bf16 v[84:87], a[212:215], a[20:23], v[84:87]
    ds_read_b64_tr_b16 a[210:211], v27 offset:18432
    v_mfma_f32_16x16x32_bf16 v[88:91], a[216:219], a[16:19], v[88:91]
    ds_read_b64_tr_b16 a[212:213], v28 offset:16384
    buffer_load_dwordx4 v11, s[48:51], s75 offen offset:3072  lds
    v_mfma_f32_16x16x32_bf16 v[92:95], a[216:219], a[20:23], v[92:95]
    ds_read_b64_tr_b16 a[214:215], v28 offset:18432
    s_waitcnt lgkmcnt(10)
    v_mfma_f32_16x16x32_bf16 v[64:67], a[220:223], a[24:27], v[64:67]
    ds_read_b64_tr_b16 a[216:217], v29 offset:16384
    buffer_load_dwordx4 a[48:51], v20, s[36:39], s78 offen sc1
    v_mfma_f32_16x16x32_bf16 v[68:71], a[220:223], a[28:31], v[68:71]
    ds_read_b64_tr_b16 a[218:219], v29 offset:18432
    v_readlane_b32 s75, v25, s76
    v_mfma_f32_16x16x32_bf16 v[72:75], a[224:227], a[24:27], v[72:75]
    ds_read_b64_tr_b16 a[220:221], v26 offset:24576
    buffer_load_dwordx4 a[52:55], v21, s[36:39], s78 offen sc1
    v_mfma_f32_16x16x32_bf16 v[76:79], a[224:227], a[28:31], v[76:79]
    ds_read_b64_tr_b16 a[222:223], v26 offset:26624
    s_waitcnt lgkmcnt(10)
    v_mfma_f32_16x16x32_bf16 v[80:83], a[228:231], a[24:27], v[80:83]
    ds_read_b64_tr_b16 a[224:225], v27 offset:24576
    buffer_load_dwordx4 a[56:59], v18, s[36:39], s78 offen sc1
    v_mfma_f32_16x16x32_bf16 v[84:87], a[228:231], a[28:31], v[84:87]
    ds_read_b64_tr_b16 a[226:227], v27 offset:26624
    s_add_u32 s76, s76, 1
    v_mfma_f32_16x16x32_bf16 v[88:91], a[232:235], a[24:27], v[88:91]
    ds_read_b64_tr_b16 a[228:229], v28 offset:24576
    buffer_load_dwordx4 a[60:63], v19, s[36:39], s78 offen sc1
    v_mfma_f32_16x16x32_bf16 v[92:95], a[232:235], a[28:31], v[92:95]
    ds_read_b64_tr_b16 a[230:231], v28 offset:26624
    s_waitcnt lgkmcnt(10)
    v_mfma_f32_16x16x32_bf16 v[32:35], a[204:207], a[16:19], v[32:35]
    ds_read_b64_tr_b16 a[232:233], v29 offset:24576
    s_waitcnt vmcnt(24)
    v_mfma_f32_16x16x32_bf16 v[36:39], a[204:207], a[20:23], v[36:39]
    ds_read_b64_tr_b16 a[234:235], v29 offset:26624
    s_barrier
    v_mfma_f32_16x16x32_bf16 v[40:43], a[208:211], a[16:19], v[40:43]
    ds_read_b64_tr_b16 a[204:205], v26 offset:36864
    v_mfma_f32_16x16x32_bf16 v[44:47], a[208:211], a[20:23], v[44:47]
    ds_read_b64_tr_b16 a[206:207], v26 offset:38912
    s_waitcnt lgkmcnt(10)
    v_mfma_f32_16x16x32_bf16 v[48:51], a[212:215], a[16:19], v[48:51]
    ds_read_b64_tr_b16 a[208:209], v27 offset:36864
    v_mfma_f32_16x16x32_bf16 v[52:55], a[212:215], a[20:23], v[52:55]
    ds_read_b64_tr_b16 a[210:211], v27 offset:38912
    v_mfma_f32_16x16x32_bf16 v[56:59], a[216:219], a[16:19], v[56:59]
    ds_read_b64_tr_b16 a[212:213], v28 offset:36864
    v_mfma_f32_16x16x32_bf16 v[60:63], a[216:219], a[20:23], v[60:63]
    ds_read_b64_tr_b16 a[214:215], v28 offset:38912
    s_waitcnt lgkmcnt(10)
    v_mfma_f32_16x16x32_bf16 v[32:35], a[220:223], a[24:27], v[32:35]
    ds_read_b64_tr_b16 a[216:217], v29 offset:36864
    v_mfma_f32_16x16x32_bf16 v[36:39], a[220:223], a[28:31], v[36:39]
    ds_read_b64_tr_b16 a[218:219], v29 offset:38912
    v_mfma_f32_16x16x32_bf16 v[40:43], a[224:227], a[24:27], v[40:43]
    ds_read_b64_tr_b16 a[220:221], v26 offset:45056
    v_mfma_f32_16x16x32_bf16 v[44:47], a[224:227], a[28:31], v[44:47]
    ds_read_b64_tr_b16 a[222:223], v26 offset:47104
    s_waitcnt lgkmcnt(10)
    v_mfma_f32_16x16x32_bf16 v[48:51], a[228:231], a[24:27], v[48:51]
    ds_read_b64_tr_b16 a[224:225], v27 offset:45056
    v_mfma_f32_16x16x32_bf16 v[52:55], a[228:231], a[28:31], v[52:55]
    ds_read_b64_tr_b16 a[226:227], v27 offset:47104
    s_add_u32 m0, s88, 28672
    v_mfma_f32_16x16x32_bf16 v[56:59], a[232:235], a[24:27], v[56:59]
    ds_read_b64_tr_b16 a[228:229], v28 offset:45056
    v_mfma_f32_16x16x32_bf16 v[60:63], a[232:235], a[28:31], v[60:63]
    ds_read_b64_tr_b16 a[230:231], v28 offset:47104
    s_waitcnt lgkmcnt(10)
    v_mfma_f32_16x16x32_bf16 v[64:67], a[204:207], a[160:163], v[64:67]
    ds_read_b64_tr_b16 a[232:233], v29 offset:45056
    buffer_load_dwordx4 v8, s[48:51], s75 offen offset:0  lds
    v_mfma_f32_16x16x32_bf16 v[68:71], a[204:207], a[164:167], v[68:71]
    ds_read_b64_tr_b16 a[234:235], v29 offset:47104
    s_lshr_b32 s78, s75, 6
    v_mfma_f32_16x16x32_bf16 v[72:75], a[208:211], a[160:163], v[72:75]
    ds_read_b64_tr_b16 a[204:205], v26 offset:32768
    buffer_load_dwordx4 v9, s[48:51], s75 offen offset:1024  lds
    v_mfma_f32_16x16x32_bf16 v[76:79], a[208:211], a[164:167], v[76:79]
    ds_read_b64_tr_b16 a[206:207], v26 offset:34816
    s_waitcnt lgkmcnt(10)
    v_mfma_f32_16x16x32_bf16 v[80:83], a[212:215], a[160:163], v[80:83]
    ds_read_b64_tr_b16 a[208:209], v27 offset:32768
    buffer_load_dwordx4 v10, s[48:51], s75 offen offset:2048  lds
    v_mfma_f32_16x16x32_bf16 v[84:87], a[212:215], a[164:167], v[84:87]
    ds_read_b64_tr_b16 a[210:211], v27 offset:34816
    v_mfma_f32_16x16x32_bf16 v[88:91], a[216:219], a[160:163], v[88:91]
    ds_read_b64_tr_b16 a[212:213], v28 offset:32768
    buffer_load_dwordx4 v11, s[48:51], s75 offen offset:3072  lds
    v_mfma_f32_16x16x32_bf16 v[92:95], a[216:219], a[164:167], v[92:95]
    ds_read_b64_tr_b16 a[214:215], v28 offset:34816
    s_waitcnt lgkmcnt(10)
    v_mfma_f32_16x16x32_bf16 v[64:67], a[220:223], a[168:171], v[64:67]
    ds_read_b64_tr_b16 a[216:217], v29 offset:32768
    buffer_load_dwordx4 a[0:3], v20, s[36:39], s78 offen sc1
    v_mfma_f32_16x16x32_bf16 v[68:71], a[220:223], a[172:175], v[68:71]
    ds_read_b64_tr_b16 a[218:219], v29 offset:34816
    v_readlane_b32 s75, v25, s76
    v_mfma_f32_16x16x32_bf16 v[72:75], a[224:227], a[168:171], v[72:75]
    ds_read_b64_tr_b16 a[220:221], v26 offset:40960
    buffer_load_dwordx4 a[4:7], v21, s[36:39], s78 offen sc1
    v_mfma_f32_16x16x32_bf16 v[76:79], a[224:227], a[172:175], v[76:79]
    ds_read_b64_tr_b16 a[222:223], v26 offset:43008
    s_waitcnt lgkmcnt(10)
    v_mfma_f32_16x16x32_bf16 v[80:83], a[228:231], a[168:171], v[80:83]
    ds_read_b64_tr_b16 a[224:225], v27 offset:40960
    buffer_load_dwordx4 a[8:11], v18, s[36:39], s78 offen sc1
    v_mfma_f32_16x16x32_bf16 v[84:87], a[228:231], a[172:175], v[84:87]
    ds_read_b64_tr_b16 a[226:227], v27 offset:43008
    s_add_u32 s76, s76, 1
    v_mfma_f32_16x16x32_bf16 v[88:91], a[232:235], a[168:171], v[88:91]
    ds_read_b64_tr_b16 a[228:229], v28 offset:40960
    buffer_load_dwordx4 a[12:15], v19, s[36:39], s78 offen sc1
    v_mfma_f32_16x16x32_bf16 v[92:95], a[232:235], a[172:175], v[92:95]
    ds_read_b64_tr_b16 a[230:231], v28 offset:43008
    s_waitcnt lgkmcnt(10)
    v_mfma_f32_16x16x32_bf16 v[32:35], a[204:207], a[160:163], v[32:35]
    ds_read_b64_tr_b16 a[232:233], v29 offset:40960
    s_waitcnt vmcnt(24)
    v_mfma_f32_16x16x32_bf16 v[36:39], a[204:207], a[164:167], v[36:39]
    ds_read_b64_tr_b16 a[234:235], v29 offset:43008
    s_barrier
    v_mfma_f32_16x16x32_bf16 v[40:43], a[208:211], a[160:163], v[40:43]
    ds_read_b64_tr_b16 a[204:205], v12 offset:53248
    v_mfma_f32_16x16x32_bf16 v[44:47], a[208:211], a[164:167], v[44:47]
    ds_read_b64_tr_b16 a[206:207], v12 offset:55296
    s_waitcnt lgkmcnt(10)
    v_mfma_f32_16x16x32_bf16 v[48:51], a[212:215], a[160:163], v[48:51]
    ds_read_b64_tr_b16 a[208:209], v13 offset:53248
    v_mfma_f32_16x16x32_bf16 v[52:55], a[212:215], a[164:167], v[52:55]
    ds_read_b64_tr_b16 a[210:211], v13 offset:55296
    v_mfma_f32_16x16x32_bf16 v[56:59], a[216:219], a[160:163], v[56:59]
    ds_read_b64_tr_b16 a[212:213], v14 offset:53248
    v_mfma_f32_16x16x32_bf16 v[60:63], a[216:219], a[164:167], v[60:63]
    ds_read_b64_tr_b16 a[214:215], v14 offset:55296
    s_waitcnt lgkmcnt(10)
    v_mfma_f32_16x16x32_bf16 v[32:35], a[220:223], a[168:171], v[32:35]
    ds_read_b64_tr_b16 a[216:217], v15 offset:53248
    v_mfma_f32_16x16x32_bf16 v[36:39], a[220:223], a[172:175], v[36:39]
    ds_read_b64_tr_b16 a[218:219], v15 offset:55296
    v_mfma_f32_16x16x32_bf16 v[40:43], a[224:227], a[168:171], v[40:43]
    ds_read_b64_tr_b16 a[220:221], v12 offset:61440
    v_mfma_f32_16x16x32_bf16 v[44:47], a[224:227], a[172:175], v[44:47]
    ds_read_b64_tr_b16 a[222:223], v12 offset:63488
    s_waitcnt lgkmcnt(10)
    v_mfma_f32_16x16x32_bf16 v[48:51], a[228:231], a[168:171], v[48:51]
    ds_read_b64_tr_b16 a[224:225], v13 offset:61440
    v_mfma_f32_16x16x32_bf16 v[52:55], a[228:231], a[172:175], v[52:55]
    ds_read_b64_tr_b16 a[226:227], v13 offset:63488
    s_add_u32 m0, s88, 45056
    v_mfma_f32_16x16x32_bf16 v[56:59], a[232:235], a[168:171], v[56:59]
    ds_read_b64_tr_b16 a[228:229], v14 offset:61440
    v_mfma_f32_16x16x32_bf16 v[60:63], a[232:235], a[172:175], v[60:63]
    ds_read_b64_tr_b16 a[230:231], v14 offset:63488
    s_waitcnt lgkmcnt(10)
    v_mfma_f32_16x16x32_bf16 v[64:67], a[204:207], a[176:179], v[64:67]
    ds_read_b64_tr_b16 a[232:233], v15 offset:61440
    buffer_load_dwordx4 v8, s[48:51], s75 offen offset:0  lds
    v_mfma_f32_16x16x32_bf16 v[68:71], a[204:207], a[180:183], v[68:71]
    ds_read_b64_tr_b16 a[234:235], v15 offset:63488
    s_lshr_b32 s78, s75, 6
    v_mfma_f32_16x16x32_bf16 v[72:75], a[208:211], a[176:179], v[72:75]
    ds_read_b64_tr_b16 a[204:205], v12 offset:49152
    buffer_load_dwordx4 v9, s[48:51], s75 offen offset:1024  lds
    v_mfma_f32_16x16x32_bf16 v[76:79], a[208:211], a[180:183], v[76:79]
    ds_read_b64_tr_b16 a[206:207], v12 offset:51200
    s_waitcnt lgkmcnt(10)
    v_mfma_f32_16x16x32_bf16 v[80:83], a[212:215], a[176:179], v[80:83]
    ds_read_b64_tr_b16 a[208:209], v13 offset:49152
    buffer_load_dwordx4 v10, s[48:51], s75 offen offset:2048  lds
    v_mfma_f32_16x16x32_bf16 v[84:87], a[212:215], a[180:183], v[84:87]
    ds_read_b64_tr_b16 a[210:211], v13 offset:51200
    v_mfma_f32_16x16x32_bf16 v[88:91], a[216:219], a[176:179], v[88:91]
    ds_read_b64_tr_b16 a[212:213], v14 offset:49152
    buffer_load_dwordx4 v11, s[48:51], s75 offen offset:3072  lds
    v_mfma_f32_16x16x32_bf16 v[92:95], a[216:219], a[180:183], v[92:95]
    ds_read_b64_tr_b16 a[214:215], v14 offset:51200
    s_waitcnt lgkmcnt(10)
    v_mfma_f32_16x16x32_bf16 v[64:67], a[220:223], a[184:187], v[64:67]
    ds_read_b64_tr_b16 a[216:217], v15 offset:49152
    buffer_load_dwordx4 a[16:19], v20, s[36:39], s78 offen sc1
    v_mfma_f32_16x16x32_bf16 v[68:71], a[220:223], a[188:191], v[68:71]
    ds_read_b64_tr_b16 a[218:219], v15 offset:51200
    v_readlane_b32 s75, v25, s76
    v_mfma_f32_16x16x32_bf16 v[72:75], a[224:227], a[184:187], v[72:75]
    ds_read_b64_tr_b16 a[220:221], v12 offset:57344
    buffer_load_dwordx4 a[20:23], v21, s[36:39], s78 offen sc1
    v_mfma_f32_16x16x32_bf16 v[76:79], a[224:227], a[188:191], v[76:79]
    ds_read_b64_tr_b16 a[222:223], v12 offset:59392
    s_waitcnt lgkmcnt(10)
    v_mfma_f32_16x16x32_bf16 v[80:83], a[228:231], a[184:187], v[80:83]
    ds_read_b64_tr_b16 a[224:225], v13 offset:57344
    buffer_load_dwordx4 a[24:27], v18, s[36:39], s78 offen sc1
    v_mfma_f32_16x16x32_bf16 v[84:87], a[228:231], a[188:191], v[84:87]
    ds_read_b64_tr_b16 a[226:227], v13 offset:59392
    s_add_u32 s76, s76, 1
    v_mfma_f32_16x16x32_bf16 v[88:91], a[232:235], a[184:187], v[88:91]
    ds_read_b64_tr_b16 a[228:229], v14 offset:57344
    buffer_load_dwordx4 a[28:31], v19, s[36:39], s78 offen sc1
    v_mfma_f32_16x16x32_bf16 v[92:95], a[232:235], a[188:191], v[92:95]
    ds_read_b64_tr_b16 a[230:231], v14 offset:59392
    s_waitcnt lgkmcnt(10)
    buffer_load_dword v31, v30, s[52:55], s77 offen sc1
    v_mfma_f32_16x16x32_bf16 v[32:35], a[204:207], a[176:179], v[32:35]
    ds_read_b64_tr_b16 a[232:233], v15 offset:57344
    s_waitcnt vmcnt(25)
    v_mfma_f32_16x16x32_bf16 v[36:39], a[204:207], a[180:183], v[36:39]
    ds_read_b64_tr_b16 a[234:235], v15 offset:59392
    s_barrier
    v_mfma_f32_16x16x32_bf16 v[40:43], a[208:211], a[176:179], v[40:43]
    ds_read_b64_tr_b16 a[204:205], v26 offset:53248
    v_mfma_f32_16x16x32_bf16 v[44:47], a[208:211], a[180:183], v[44:47]
    ds_read_b64_tr_b16 a[206:207], v26 offset:55296
    s_waitcnt lgkmcnt(10)
    v_mfma_f32_16x16x32_bf16 v[48:51], a[212:215], a[176:179], v[48:51]
    ds_read_b64_tr_b16 a[208:209], v27 offset:53248
    v_mfma_f32_16x16x32_bf16 v[52:55], a[212:215], a[180:183], v[52:55]
    ds_read_b64_tr_b16 a[210:211], v27 offset:55296
    v_mfma_f32_16x16x32_bf16 v[56:59], a[216:219], a[176:179], v[56:59]
    ds_read_b64_tr_b16 a[212:213], v28 offset:53248
    v_mfma_f32_16x16x32_bf16 v[60:63], a[216:219], a[180:183], v[60:63]
    ds_read_b64_tr_b16 a[214:215], v28 offset:55296
    s_waitcnt lgkmcnt(10)
    v_mfma_f32_16x16x32_bf16 v[32:35], a[220:223], a[184:187], v[32:35]
    ds_read_b64_tr_b16 a[216:217], v29 offset:53248
    v_mfma_f32_16x16x32_bf16 v[36:39], a[220:223], a[188:191], v[36:39]
    ds_read_b64_tr_b16 a[218:219], v29 offset:55296
    v_mfma_f32_16x16x32_bf16 v[40:43], a[224:227], a[184:187], v[40:43]
    ds_read_b64_tr_b16 a[220:221], v26 offset:61440
    v_mfma_f32_16x16x32_bf16 v[44:47], a[224:227], a[188:191], v[44:47]
    ds_read_b64_tr_b16 a[222:223], v26 offset:63488
    s_waitcnt lgkmcnt(10)
    v_mfma_f32_16x16x32_bf16 v[48:51], a[228:231], a[184:187], v[48:51]
    ds_read_b64_tr_b16 a[224:225], v27 offset:61440
    v_mfma_f32_16x16x32_bf16 v[52:55], a[228:231], a[188:191], v[52:55]
    ds_read_b64_tr_b16 a[226:227], v27 offset:63488
    s_add_u32 m0, s88, 61440
    v_mfma_f32_16x16x32_bf16 v[56:59], a[232:235], a[184:187], v[56:59]
    ds_read_b64_tr_b16 a[228:229], v28 offset:61440
    v_mfma_f32_16x16x32_bf16 v[60:63], a[232:235], a[188:191], v[60:63]
    ds_read_b64_tr_b16 a[230:231], v28 offset:63488
    s_waitcnt lgkmcnt(10)
    v_mfma_f32_16x16x32_bf16 v[64:67], a[204:207], a[32:35], v[64:67]
    ds_read_b64_tr_b16 a[232:233], v29 offset:61440
    buffer_load_dwordx4 v8, s[48:51], s75 offen offset:0  lds
    v_mfma_f32_16x16x32_bf16 v[68:71], a[204:207], a[36:39], v[68:71]
    ds_read_b64_tr_b16 a[234:235], v29 offset:63488
    s_lshr_b32 s78, s75, 6
    v_mfma_f32_16x16x32_bf16 v[72:75], a[208:211], a[32:35], v[72:75]
    ds_read_b64_tr_b16 a[204:205], v26 offset:49152
    buffer_load_dwordx4 v9, s[48:51], s75 offen offset:1024  lds
    v_mfma_f32_16x16x32_bf16 v[76:79], a[208:211], a[36:39], v[76:79]
    ds_read_b64_tr_b16 a[206:207], v26 offset:51200
    s_waitcnt lgkmcnt(10)
    v_mfma_f32_16x16x32_bf16 v[80:83], a[212:215], a[32:35], v[80:83]
    ds_read_b64_tr_b16 a[208:209], v27 offset:49152
    buffer_load_dwordx4 v10, s[48:51], s75 offen offset:2048  lds
    v_mfma_f32_16x16x32_bf16 v[84:87], a[212:215], a[36:39], v[84:87]
    ds_read_b64_tr_b16 a[210:211], v27 offset:51200
    v_mfma_f32_16x16x32_bf16 v[88:91], a[216:219], a[32:35], v[88:91]
    ds_read_b64_tr_b16 a[212:213], v28 offset:49152
    buffer_load_dwordx4 v11, s[48:51], s75 offen offset:3072  lds
    v_mfma_f32_16x16x32_bf16 v[92:95], a[216:219], a[36:39], v[92:95]
    ds_read_b64_tr_b16 a[214:215], v28 offset:51200
    s_waitcnt lgkmcnt(10)
    v_mfma_f32_16x16x32_bf16 v[64:67], a[220:223], a[40:43], v[64:67]
    ds_read_b64_tr_b16 a[216:217], v29 offset:49152
    buffer_load_dwordx4 a[160:163], v20, s[36:39], s78 offen sc1
    v_mfma_f32_16x16x32_bf16 v[68:71], a[220:223], a[44:47], v[68:71]
    ds_read_b64_tr_b16 a[218:219], v29 offset:51200
    v_readlane_b32 s75, v25, s76
    v_mfma_f32_16x16x32_bf16 v[72:75], a[224:227], a[40:43], v[72:75]
    ds_read_b64_tr_b16 a[220:221], v26 offset:57344
    buffer_load_dwordx4 a[164:167], v21, s[36:39], s78 offen sc1
    v_mfma_f32_16x16x32_bf16 v[76:79], a[224:227], a[44:47], v[76:79]
    ds_read_b64_tr_b16 a[222:223], v26 offset:59392
    s_waitcnt lgkmcnt(10)
    v_mfma_f32_16x16x32_bf16 v[80:83], a[228:231], a[40:43], v[80:83]
    ds_read_b64_tr_b16 a[224:225], v27 offset:57344
    buffer_load_dwordx4 a[168:171], v18, s[36:39], s78 offen sc1
    v_mfma_f32_16x16x32_bf16 v[84:87], a[228:231], a[44:47], v[84:87]
    ds_read_b64_tr_b16 a[226:227], v27 offset:59392
    s_add_u32 s76, s76, 1
    v_mfma_f32_16x16x32_bf16 v[88:91], a[232:235], a[40:43], v[88:91]
    ds_read_b64_tr_b16 a[228:229], v28 offset:57344
    buffer_load_dwordx4 a[172:175], v19, s[36:39], s78 offen sc1
    v_mfma_f32_16x16x32_bf16 v[92:95], a[232:235], a[44:47], v[92:95]
    ds_read_b64_tr_b16 a[230:231], v28 offset:59392
    s_waitcnt lgkmcnt(10)
    v_mfma_f32_16x16x32_bf16 v[32:35], a[204:207], a[32:35], v[32:35]
    ds_read_b64_tr_b16 a[232:233], v29 offset:57344
    s_waitcnt vmcnt(25)
    v_mfma_f32_16x16x32_bf16 v[36:39], a[204:207], a[36:39], v[36:39]
    ds_read_b64_tr_b16 a[234:235], v29 offset:59392
    s_barrier
    v_mfma_f32_16x16x32_bf16 v[40:43], a[208:211], a[32:35], v[40:43]
    ds_read_b64_tr_b16 a[204:205], v12 offset:4096
    v_mfma_f32_16x16x32_bf16 v[44:47], a[208:211], a[36:39], v[44:47]
    ds_read_b64_tr_b16 a[206:207], v12 offset:6144
    s_waitcnt lgkmcnt(10)
    v_mfma_f32_16x16x32_bf16 v[48:51], a[212:215], a[32:35], v[48:51]
    ds_read_b64_tr_b16 a[208:209], v13 offset:4096
    v_mfma_f32_16x16x32_bf16 v[52:55], a[212:215], a[36:39], v[52:55]
    ds_read_b64_tr_b16 a[210:211], v13 offset:6144
    v_mfma_f32_16x16x32_bf16 v[56:59], a[216:219], a[32:35], v[56:59]
    ds_read_b64_tr_b16 a[212:213], v14 offset:4096
    v_mfma_f32_16x16x32_bf16 v[60:63], a[216:219], a[36:39], v[60:63]
    ds_read_b64_tr_b16 a[214:215], v14 offset:6144
    s_waitcnt lgkmcnt(10)
    v_mfma_f32_16x16x32_bf16 v[32:35], a[220:223], a[40:43], v[32:35]
    ds_read_b64_tr_b16 a[216:217], v15 offset:4096
    v_mfma_f32_16x16x32_bf16 v[36:39], a[220:223], a[44:47], v[36:39]
    ds_read_b64_tr_b16 a[218:219], v15 offset:6144
    v_mfma_f32_16x16x32_bf16 v[40:43], a[224:227], a[40:43], v[40:43]
    ds_read_b64_tr_b16 a[220:221], v12 offset:12288
    v_mfma_f32_16x16x32_bf16 v[44:47], a[224:227], a[44:47], v[44:47]
    ds_read_b64_tr_b16 a[222:223], v12 offset:14336
    s_waitcnt lgkmcnt(10)
    v_mfma_f32_16x16x32_bf16 v[48:51], a[228:231], a[40:43], v[48:51]
    ds_read_b64_tr_b16 a[224:225], v13 offset:12288
    v_mfma_f32_16x16x32_bf16 v[52:55], a[228:231], a[44:47], v[52:55]
    ds_read_b64_tr_b16 a[226:227], v13 offset:14336
    s_add_u32 m0, s88, 143360
    v_mfma_f32_16x16x32_bf16 v[56:59], a[232:235], a[40:43], v[56:59]
    ds_read_b64_tr_b16 a[228:229], v14 offset:12288
    v_mfma_f32_16x16x32_bf16 v[60:63], a[232:235], a[44:47], v[60:63]
    ds_read_b64_tr_b16 a[230:231], v14 offset:14336
    s_waitcnt lgkmcnt(10)
    v_mfma_f32_16x16x32_bf16 v[64:67], a[204:207], a[48:51], v[64:67]
    ds_read_b64_tr_b16 a[232:233], v15 offset:12288
    buffer_load_dwordx4 v8, s[48:51], s75 offen offset:0  lds
    v_mfma_f32_16x16x32_bf16 v[68:71], a[204:207], a[52:55], v[68:71]
    ds_read_b64_tr_b16 a[234:235], v15 offset:14336
    s_lshr_b32 s78, s75, 6
    v_mfma_f32_16x16x32_bf16 v[72:75], a[208:211], a[48:51], v[72:75]
    ds_read_b64_tr_b16 a[204:205], v12 offset:0
    buffer_load_dwordx4 v9, s[48:51], s75 offen offset:1024  lds
    v_mfma_f32_16x16x32_bf16 v[76:79], a[208:211], a[52:55], v[76:79]
    ds_read_b64_tr_b16 a[206:207], v12 offset:2048
    s_waitcnt lgkmcnt(10)
    v_mfma_f32_16x16x32_bf16 v[80:83], a[212:215], a[48:51], v[80:83]
    ds_read_b64_tr_b16 a[208:209], v13 offset:0
    buffer_load_dwordx4 v10, s[48:51], s75 offen offset:2048  lds
    v_mfma_f32_16x16x32_bf16 v[84:87], a[212:215], a[52:55], v[84:87]
    ds_read_b64_tr_b16 a[210:211], v13 offset:2048
    v_mfma_f32_16x16x32_bf16 v[88:91], a[216:219], a[48:51], v[88:91]
    ds_read_b64_tr_b16 a[212:213], v14 offset:0
    buffer_load_dwordx4 v11, s[48:51], s75 offen offset:3072  lds
    v_mfma_f32_16x16x32_bf16 v[92:95], a[216:219], a[52:55], v[92:95]
    ds_read_b64_tr_b16 a[214:215], v14 offset:2048
    s_waitcnt lgkmcnt(10)
    v_mfma_f32_16x16x32_bf16 v[64:67], a[220:223], a[56:59], v[64:67]
    ds_read_b64_tr_b16 a[216:217], v15 offset:0
    buffer_load_dwordx4 a[176:179], v20, s[36:39], s78 offen sc1
    v_mfma_f32_16x16x32_bf16 v[68:71], a[220:223], a[60:63], v[68:71]
    ds_read_b64_tr_b16 a[218:219], v15 offset:2048
    v_readlane_b32 s75, v25, s76
    v_mfma_f32_16x16x32_bf16 v[72:75], a[224:227], a[56:59], v[72:75]
    ds_read_b64_tr_b16 a[220:221], v12 offset:8192
    buffer_load_dwordx4 a[180:183], v21, s[36:39], s78 offen sc1
    v_mfma_f32_16x16x32_bf16 v[76:79], a[224:227], a[60:63], v[76:79]
    ds_read_b64_tr_b16 a[222:223], v12 offset:10240
    s_waitcnt lgkmcnt(10)
    v_mfma_f32_16x16x32_bf16 v[80:83], a[228:231], a[56:59], v[80:83]
    ds_read_b64_tr_b16 a[224:225], v13 offset:8192
    buffer_load_dwordx4 a[184:187], v18, s[36:39], s78 offen sc1
    v_mfma_f32_16x16x32_bf16 v[84:87], a[228:231], a[60:63], v[84:87]
    ds_read_b64_tr_b16 a[226:227], v13 offset:10240
    s_add_u32 s76, s76, 1
    v_mfma_f32_16x16x32_bf16 v[88:91], a[232:235], a[56:59], v[88:91]
    ds_read_b64_tr_b16 a[228:229], v14 offset:8192
    buffer_load_dwordx4 a[188:191], v19, s[36:39], s78 offen sc1
    v_mfma_f32_16x16x32_bf16 v[92:95], a[232:235], a[60:63], v[92:95]
    ds_read_b64_tr_b16 a[230:231], v14 offset:10240
    s_waitcnt lgkmcnt(10)
    v_mfma_f32_16x16x32_bf16 v[32:35], a[204:207], a[48:51], v[32:35]
    ds_read_b64_tr_b16 a[232:233], v15 offset:8192
    s_waitcnt vmcnt(25)
    v_mfma_f32_16x16x32_bf16 v[36:39], a[204:207], a[52:55], v[36:39]
    ds_read_b64_tr_b16 a[234:235], v15 offset:10240
    s_barrier
    v_mfma_f32_16x16x32_bf16 v[40:43], a[208:211], a[48:51], v[40:43]
    ds_read_b64_tr_b16 a[204:205], v26 offset:4096
    v_mfma_f32_16x16x32_bf16 v[44:47], a[208:211], a[52:55], v[44:47]
    ds_read_b64_tr_b16 a[206:207], v26 offset:6144
    s_waitcnt lgkmcnt(10)
    v_mfma_f32_16x16x32_bf16 v[48:51], a[212:215], a[48:51], v[48:51]
    ds_read_b64_tr_b16 a[208:209], v27 offset:4096
    v_mfma_f32_16x16x32_bf16 v[52:55], a[212:215], a[52:55], v[52:55]
    ds_read_b64_tr_b16 a[210:211], v27 offset:6144
    v_mfma_f32_16x16x32_bf16 v[56:59], a[216:219], a[48:51], v[56:59]
    ds_read_b64_tr_b16 a[212:213], v28 offset:4096
    s_sub_u32 s81, s81, 1
    v_mfma_f32_16x16x32_bf16 v[60:63], a[216:219], a[52:55], v[60:63]
    ds_read_b64_tr_b16 a[214:215], v28 offset:6144
    s_waitcnt lgkmcnt(10)
    v_mfma_f32_16x16x32_bf16 v[32:35], a[220:223], a[56:59], v[32:35]
    ds_read_b64_tr_b16 a[216:217], v29 offset:4096
    v_mfma_f32_16x16x32_bf16 v[36:39], a[220:223], a[60:63], v[36:39]
    ds_read_b64_tr_b16 a[218:219], v29 offset:6144
    v_mfma_f32_16x16x32_bf16 v[40:43], a[224:227], a[56:59], v[40:43]
    ds_read_b64_tr_b16 a[220:221], v26 offset:12288
    v_mfma_f32_16x16x32_bf16 v[44:47], a[224:227], a[60:63], v[44:47]
    ds_read_b64_tr_b16 a[222:223], v26 offset:14336
    s_waitcnt lgkmcnt(10)
    v_mfma_f32_16x16x32_bf16 v[48:51], a[228:231], a[56:59], v[48:51]
    ds_read_b64_tr_b16 a[224:225], v27 offset:12288
    v_mfma_f32_16x16x32_bf16 v[52:55], a[228:231], a[60:63], v[52:55]
    ds_read_b64_tr_b16 a[226:227], v27 offset:14336
    s_add_u32 m0, s88, 77824
    v_mfma_f32_16x16x32_bf16 v[56:59], a[232:235], a[56:59], v[56:59]
    ds_read_b64_tr_b16 a[228:229], v28 offset:12288
    s_cmp_lg_u32 s81, 0
    v_mfma_f32_16x16x32_bf16 v[60:63], a[232:235], a[60:63], v[60:63]
    ds_read_b64_tr_b16 a[230:231], v28 offset:14336
    s_waitcnt lgkmcnt(10)
    s_cbranch_scc1 L_g2_1026
    s_mov_b32 s60, 32768
    v_mfma_f32_16x16x32_bf16 v[64:67], a[204:207], a[0:3], v[64:67]
    ds_read_b64_tr_b16 a[232:233], v29 offset:12288
    s_waitcnt vmcnt(16)
    v_mfma_f32_16x16x32_bf16 v[68:71], a[204:207], a[4:7], v[68:71]
    s_barrier
    ds_read_b64_tr_b16 a[234:235], v29 offset:14336
    v_mfma_f32_16x16x32_bf16 v[72:75], a[208:211], a[0:3], v[72:75]
    ds_read_b64_tr_b16 a[204:205], v26 offset:20480
    buffer_load_dwordx4 v[96:99], v23, s[40:43], 0 offen offset:0 sc1
    v_mfma_f32_16x16x32_bf16 v[76:79], a[208:211], a[4:7], v[76:79]
    ds_read_b64_tr_b16 a[206:207], v26 offset:22528
    s_waitcnt lgkmcnt(10)
    v_mfma_f32_16x16x32_bf16 v[80:83], a[212:215], a[0:3], v[80:83]
    ds_read_b64_tr_b16 a[208:209], v27 offset:20480
    buffer_load_dwordx4 v[100:103], v23, s[40:43], 0 offen offset:64 sc1
    v_mfma_f32_16x16x32_bf16 v[84:87], a[212:215], a[4:7], v[84:87]
    ds_read_b64_tr_b16 a[210:211], v27 offset:22528
    v_mfma_f32_16x16x32_bf16 v[88:91], a[216:219], a[0:3], v[88:91]
    ds_read_b64_tr_b16 a[212:213], v28 offset:20480
    buffer_load_dwordx4 v[104:107], v23, s[40:43], s60 offen offset:0 sc1
    v_mfma_f32_16x16x32_bf16 v[92:95], a[216:219], a[4:7], v[92:95]
    ds_read_b64_tr_b16 a[214:215], v28 offset:22528
    s_waitcnt lgkmcnt(10)
    v_mfma_f32_16x16x32_bf16 v[64:67], a[220:223], a[8:11], v[64:67]
    ds_read_b64_tr_b16 a[216:217], v29 offset:20480
    buffer_load_dwordx4 v[108:111], v23, s[40:43], s60 offen offset:64 sc1
    v_mfma_f32_16x16x32_bf16 v[68:71], a[220:223], a[12:15], v[68:71]
    ds_read_b64_tr_b16 a[218:219], v29 offset:22528
    v_mfma_f32_16x16x32_bf16 v[72:75], a[224:227], a[8:11], v[72:75]
    ds_read_b64_tr_b16 a[220:221], v26 offset:28672
    v_mfma_f32_16x16x32_bf16 v[76:79], a[224:227], a[12:15], v[76:79]
    ds_read_b64_tr_b16 a[222:223], v26 offset:30720
    s_waitcnt lgkmcnt(10)
    v_mfma_f32_16x16x32_bf16 v[80:83], a[228:231], a[8:11], v[80:83]
    ds_read_b64_tr_b16 a[224:225], v27 offset:28672
    v_mfma_f32_16x16x32_bf16 v[84:87], a[228:231], a[12:15], v[84:87]
    ds_read_b64_tr_b16 a[226:227], v27 offset:30720
    v_mfma_f32_16x16x32_bf16 v[88:91], a[232:235], a[8:11], v[88:91]
    ds_read_b64_tr_b16 a[228:229], v28 offset:28672
    v_mfma_f32_16x16x32_bf16 v[92:95], a[232:235], a[12:15], v[92:95]
    ds_read_b64_tr_b16 a[230:231], v28 offset:30720
    s_waitcnt lgkmcnt(10)
    v_mfma_f32_16x16x32_bf16 v[64:67], a[204:207], a[16:19], v[64:67]
    ds_read_b64_tr_b16 a[232:233], v29 offset:28672
    v_mfma_f32_16x16x32_bf16 v[68:71], a[204:207], a[20:23], v[68:71]
    ds_read_b64_tr_b16 a[234:235], v29 offset:30720
    v_mfma_f32_16x16x32_bf16 v[72:75], a[208:211], a[16:19], v[72:75]
    ds_read_b64_tr_b16 a[204:205], v26 offset:0
    v_mfma_f32_16x16x32_bf16 v[76:79], a[208:211], a[20:23], v[76:79]
    ds_read_b64_tr_b16 a[206:207], v26 offset:2048
    s_waitcnt lgkmcnt(10)
    s_lshl_b32 s58, s2, 2
    v_mfma_f32_16x16x32_bf16 v[80:83], a[212:215], a[16:19], v[80:83]
    ds_read_b64_tr_b16 a[208:209], v27 offset:0
    v_mfma_f32_16x16x32_bf16 v[84:87], a[212:215], a[20:23], v[84:87]
    ds_read_b64_tr_b16 a[210:211], v27 offset:2048
    s_add_u32 s58, s58, s30
    v_mfma_f32_16x16x32_bf16 v[88:91], a[216:219], a[16:19], v[88:91]
    ds_read_b64_tr_b16 a[212:213], v28 offset:0
    v_mfma_f32_16x16x32_bf16 v[92:95], a[216:219], a[20:23], v[92:95]
    ds_read_b64_tr_b16 a[214:215], v28 offset:2048
    s_waitcnt lgkmcnt(10)
    s_mul_i32 s61, s58, 5248
    v_mfma_f32_16x16x32_bf16 v[64:67], a[220:223], a[24:27], v[64:67]
    ds_read_b64_tr_b16 a[216:217], v29 offset:0
    v_mfma_f32_16x16x32_bf16 v[68:71], a[220:223], a[28:31], v[68:71]
    ds_read_b64_tr_b16 a[218:219], v29 offset:2048
    s_xor_b32 s58, s58, 4
    v_mfma_f32_16x16x32_bf16 v[72:75], a[224:227], a[24:27], v[72:75]
    ds_read_b64_tr_b16 a[220:221], v26 offset:8192
    v_mfma_f32_16x16x32_bf16 v[76:79], a[224:227], a[28:31], v[76:79]
    ds_read_b64_tr_b16 a[222:223], v26 offset:10240
    s_waitcnt lgkmcnt(10)
    s_mul_i32 s62, s58, 5248
    v_mfma_f32_16x16x32_bf16 v[80:83], a[228:231], a[24:27], v[80:83]
    ds_read_b64_tr_b16 a[224:225], v27 offset:8192
    v_mfma_f32_16x16x32_bf16 v[84:87], a[228:231], a[28:31], v[84:87]
    ds_read_b64_tr_b16 a[226:227], v27 offset:10240
    s_add_u32 s63, s62, 4096
    v_mfma_f32_16x16x32_bf16 v[88:91], a[232:235], a[24:27], v[88:91]
    ds_read_b64_tr_b16 a[228:229], v28 offset:8192
    v_mfma_f32_16x16x32_bf16 v[92:95], a[232:235], a[28:31], v[92:95]
    ds_read_b64_tr_b16 a[230:231], v28 offset:10240
    s_waitcnt lgkmcnt(10)
    s_add_u32 s58, s61, 4096
    v_mfma_f32_16x16x32_bf16 v[32:35], a[204:207], a[0:3], v[32:35]
    ds_read_b64_tr_b16 a[232:233], v29 offset:8192
    s_waitcnt vmcnt(12)
    v_mfma_f32_16x16x32_bf16 v[36:39], a[204:207], a[4:7], v[36:39]
    s_barrier
    ds_read_b64_tr_b16 a[234:235], v29 offset:10240
    v_mfma_f32_16x16x32_bf16 v[40:43], a[208:211], a[0:3], v[40:43]
    ds_read_b64_tr_b16 a[204:205], v26 offset:36864
    v_mfma_f32_16x16x32_bf16 v[44:47], a[208:211], a[4:7], v[44:47]
    ds_read_b64_tr_b16 a[206:207], v26 offset:38912
    s_waitcnt lgkmcnt(10)
    v_mfma_f32_16x16x32_bf16 v[48:51], a[212:215], a[0:3], v[48:51]
    ds_read_b64_tr_b16 a[208:209], v27 offset:36864
    v_mfma_f32_16x16x32_bf16 v[52:55], a[212:215], a[4:7], v[52:55]
    ds_read_b64_tr_b16 a[210:211], v27 offset:38912
    v_mfma_f32_16x16x32_bf16 v[56:59], a[216:219], a[0:3], v[56:59]
    ds_read_b64_tr_b16 a[212:213], v28 offset:36864
    v_mfma_f32_16x16x32_bf16 v[60:63], a[216:219], a[4:7], v[60:63]
    ds_read_b64_tr_b16 a[214:215], v28 offset:38912
    s_waitcnt lgkmcnt(10)
    v_mfma_f32_16x16x32_bf16 v[32:35], a[220:223], a[8:11], v[32:35]
    ds_read_b64_tr_b16 a[216:217], v29 offset:36864
    v_mfma_f32_16x16x32_bf16 v[36:39], a[220:223], a[12:15], v[36:39]
    ds_read_b64_tr_b16 a[218:219], v29 offset:38912
    v_mfma_f32_16x16x32_bf16 v[40:43], a[224:227], a[8:11], v[40:43]
    ds_read_b64_tr_b16 a[220:221], v26 offset:45056
    v_mfma_f32_16x16x32_bf16 v[44:47], a[224:227], a[12:15], v[44:47]
    ds_read_b64_tr_b16 a[222:223], v26 offset:47104
    s_waitcnt lgkmcnt(10)
    v_mfma_f32_16x16x32_bf16 v[48:51], a[228:231], a[8:11], v[48:51]
    ds_read_b64_tr_b16 a[224:225], v27 offset:45056
    v_mfma_f32_16x16x32_bf16 v[52:55], a[228:231], a[12:15], v[52:55]
    ds_read_b64_tr_b16 a[226:227], v27 offset:47104
    v_mfma_f32_16x16x32_bf16 v[56:59], a[232:235], a[8:11], v[56:59]
    ds_read_b64_tr_b16 a[228:229], v28 offset:45056
    v_mfma_f32_16x16x32_bf16 v[60:63], a[232:235], a[12:15], v[60:63]
    ds_read_b64_tr_b16 a[230:231], v28 offset:47104
    s_waitcnt lgkmcnt(10)
    v_mfma_f32_16x16x32_bf16 v[64:67], a[204:207], a[160:163], v[64:67]
    ds_read_b64_tr_b16 a[232:233], v29 offset:45056
    s_waitcnt vmcnt(4)
    v_mfma_f32_16x16x32_bf16 v[68:71], a[204:207], a[164:167], v[68:71]
    s_barrier
    ds_read_b64_tr_b16 a[234:235], v29 offset:47104
    v_mfma_f32_16x16x32_bf16 v[72:75], a[208:211], a[160:163], v[72:75]
    ds_read_b64_tr_b16 a[204:205], v12 offset:53248
    v_mfma_f32_16x16x32_bf16 v[76:79], a[208:211], a[164:167], v[76:79]
    ds_read_b64_tr_b16 a[206:207], v12 offset:55296
    s_waitcnt lgkmcnt(10)
    v_mfma_f32_16x16x32_bf16 v[80:83], a[212:215], a[160:163], v[80:83]
    ds_read_b64_tr_b16 a[208:209], v13 offset:53248
    v_mfma_f32_16x16x32_bf16 v[84:87], a[212:215], a[164:167], v[84:87]
    ds_read_b64_tr_b16 a[210:211], v13 offset:55296
    v_mfma_f32_16x16x32_bf16 v[88:91], a[216:219], a[160:163], v[88:91]
    ds_read_b64_tr_b16 a[212:213], v14 offset:53248
    v_mfma_f32_16x16x32_bf16 v[92:95], a[216:219], a[164:167], v[92:95]
    ds_read_b64_tr_b16 a[214:215], v14 offset:55296
    s_waitcnt lgkmcnt(10)
    v_mfma_f32_16x16x32_bf16 v[64:67], a[220:223], a[168:171], v[64:67]
    ds_read_b64_tr_b16 a[216:217], v15 offset:53248
    v_mfma_f32_16x16x32_bf16 v[68:71], a[220:223], a[172:175], v[68:71]
    ds_read_b64_tr_b16 a[218:219], v15 offset:55296
    v_mfma_f32_16x16x32_bf16 v[72:75], a[224:227], a[168:171], v[72:75]
    ds_read_b64_tr_b16 a[220:221], v12 offset:61440
    v_mfma_f32_16x16x32_bf16 v[76:79], a[224:227], a[172:175], v[76:79]
    ds_read_b64_tr_b16 a[222:223], v12 offset:63488
    s_waitcnt lgkmcnt(10)
    v_mfma_f32_16x16x32_bf16 v[80:83], a[228:231], a[168:171], v[80:83]
    ds_read_b64_tr_b16 a[224:225], v13 offset:61440
    v_mfma_f32_16x16x32_bf16 v[84:87], a[228:231], a[172:175], v[84:87]
    ds_read_b64_tr_b16 a[226:227], v13 offset:63488
    v_mfma_f32_16x16x32_bf16 v[88:91], a[232:235], a[168:171], v[88:91]
    ds_read_b64_tr_b16 a[228:229], v14 offset:61440
    v_mfma_f32_16x16x32_bf16 v[92:95], a[232:235], a[172:175], v[92:95]
    ds_read_b64_tr_b16 a[230:231], v14 offset:63488
    s_waitcnt lgkmcnt(10)
    v_mfma_f32_16x16x32_bf16 v[64:67], a[204:207], a[176:179], v[64:67]
    ds_read_b64_tr_b16 a[232:233], v15 offset:61440
    v_mfma_f32_16x16x32_bf16 v[68:71], a[204:207], a[180:183], v[68:71]
    ds_read_b64_tr_b16 a[234:235], v15 offset:63488
    v_mfma_f32_16x16x32_bf16 v[72:75], a[208:211], a[176:179], v[72:75]
    ds_read_b64_tr_b16 a[204:205], v26 offset:16384
    v_mfma_f32_16x16x32_bf16 v[76:79], a[208:211], a[180:183], v[76:79]
    ds_read_b64_tr_b16 a[206:207], v26 offset:18432
    s_waitcnt lgkmcnt(10)
    v_mfma_f32_16x16x32_bf16 v[80:83], a[212:215], a[176:179], v[80:83]
    ds_read_b64_tr_b16 a[208:209], v27 offset:16384
    v_mfma_f32_16x16x32_bf16 v[84:87], a[212:215], a[180:183], v[84:87]
    ds_read_b64_tr_b16 a[210:211], v27 offset:18432
    v_mfma_f32_16x16x32_bf16 v[88:91], a[216:219], a[176:179], v[88:91]
    ds_read_b64_tr_b16 a[212:213], v28 offset:16384
    v_mfma_f32_16x16x32_bf16 v[92:95], a[216:219], a[180:183], v[92:95]
    ds_read_b64_tr_b16 a[214:215], v28 offset:18432
    s_waitcnt lgkmcnt(10)
    v_mfma_f32_16x16x32_bf16 v[64:67], a[220:223], a[184:187], v[64:67]
    ds_read_b64_tr_b16 a[216:217], v29 offset:16384
    v_mfma_f32_16x16x32_bf16 v[68:71], a[220:223], a[188:191], v[68:71]
    ds_read_b64_tr_b16 a[218:219], v29 offset:18432
    v_mfma_f32_16x16x32_bf16 v[72:75], a[224:227], a[184:187], v[72:75]
    ds_read_b64_tr_b16 a[220:221], v26 offset:24576
    v_mfma_f32_16x16x32_bf16 v[76:79], a[224:227], a[188:191], v[76:79]
    ds_read_b64_tr_b16 a[222:223], v26 offset:26624
    s_waitcnt lgkmcnt(10)
    v_mfma_f32_16x16x32_bf16 v[80:83], a[228:231], a[184:187], v[80:83]
    ds_read_b64_tr_b16 a[224:225], v27 offset:24576
    v_mfma_f32_16x16x32_bf16 v[84:87], a[228:231], a[188:191], v[84:87]
    ds_read_b64_tr_b16 a[226:227], v27 offset:26624
    v_mfma_f32_16x16x32_bf16 v[88:91], a[232:235], a[184:187], v[88:91]
    ds_read_b64_tr_b16 a[228:229], v28 offset:24576
    v_cvt_pk_bf16_f32 v64, v64, v65
    v_mfma_f32_16x16x32_bf16 v[92:95], a[232:235], a[188:191], v[92:95]
    ds_read_b64_tr_b16 a[230:231], v28 offset:26624
    s_waitcnt lgkmcnt(10)
    v_mfma_f32_16x16x32_bf16 v[32:35], a[204:207], a[16:19], v[32:35]
    ds_read_b64_tr_b16 a[232:233], v29 offset:24576
    v_cvt_pk_bf16_f32 v65, v66, v67
    v_mfma_f32_16x16x32_bf16 v[36:39], a[204:207], a[20:23], v[36:39]
    ds_read_b64_tr_b16 a[234:235], v29 offset:26624
    v_cvt_pk_bf16_f32 v66, v68, v69
    v_mfma_f32_16x16x32_bf16 v[40:43], a[208:211], a[16:19], v[40:43]
    ds_read_b64_tr_b16 a[204:205], v26 offset:32768
    v_cvt_pk_bf16_f32 v67, v70, v71
    v_mfma_f32_16x16x32_bf16 v[44:47], a[208:211], a[20:23], v[44:47]
    ds_read_b64_tr_b16 a[206:207], v26 offset:34816
    s_waitcnt lgkmcnt(10)
    v_mfma_f32_16x16x32_bf16 v[48:51], a[212:215], a[16:19], v[48:51]
    ds_read_b64_tr_b16 a[208:209], v27 offset:32768
    buffer_store_dwordx4 v[64:67], v24, s[32:35], s61 offen offset:0 sc1
    v_mfma_f32_16x16x32_bf16 v[52:55], a[212:215], a[20:23], v[52:55]
    ds_read_b64_tr_b16 a[210:211], v27 offset:34816
    v_cvt_pk_bf16_f32 v72, v72, v73
    v_mfma_f32_16x16x32_bf16 v[56:59], a[216:219], a[16:19], v[56:59]
    ds_read_b64_tr_b16 a[212:213], v28 offset:32768
    v_cvt_pk_bf16_f32 v73, v74, v75
    v_mfma_f32_16x16x32_bf16 v[60:63], a[216:219], a[20:23], v[60:63]
    ds_read_b64_tr_b16 a[214:215], v28 offset:34816
    s_waitcnt lgkmcnt(10)
    v_mfma_f32_16x16x32_bf16 v[32:35], a[220:223], a[24:27], v[32:35]
    ds_read_b64_tr_b16 a[216:217], v29 offset:32768
    v_cvt_pk_bf16_f32 v74, v76, v77
    v_mfma_f32_16x16x32_bf16 v[36:39], a[220:223], a[28:31], v[36:39]
    ds_read_b64_tr_b16 a[218:219], v29 offset:34816
    v_cvt_pk_bf16_f32 v75, v78, v79
    v_mfma_f32_16x16x32_bf16 v[40:43], a[224:227], a[24:27], v[40:43]
    ds_read_b64_tr_b16 a[220:221], v26 offset:40960
    buffer_store_dwordx4 v[72:75], v24, s[32:35], s61 offen offset:1024 sc1
    v_mfma_f32_16x16x32_bf16 v[44:47], a[224:227], a[28:31], v[44:47]
    ds_read_b64_tr_b16 a[222:223], v26 offset:43008
    s_waitcnt lgkmcnt(10)
    v_mfma_f32_16x16x32_bf16 v[48:51], a[228:231], a[24:27], v[48:51]
    ds_read_b64_tr_b16 a[224:225], v27 offset:40960
    v_cvt_pk_bf16_f32 v80, v80, v81
    v_mfma_f32_16x16x32_bf16 v[52:55], a[228:231], a[28:31], v[52:55]
    ds_read_b64_tr_b16 a[226:227], v27 offset:43008
    v_cvt_pk_bf16_f32 v81, v82, v83
    v_mfma_f32_16x16x32_bf16 v[56:59], a[232:235], a[24:27], v[56:59]
    ds_read_b64_tr_b16 a[228:229], v28 offset:40960
    v_cvt_pk_bf16_f32 v82, v84, v85
    v_mfma_f32_16x16x32_bf16 v[60:63], a[232:235], a[28:31], v[60:63]
    ds_read_b64_tr_b16 a[230:231], v28 offset:43008
    s_waitcnt lgkmcnt(10)
    v_mfma_f32_16x16x32_bf16 v[32:35], a[204:207], a[160:163], v[32:35]
    ds_read_b64_tr_b16 a[232:233], v29 offset:40960
    v_cvt_pk_bf16_f32 v83, v86, v87
    v_mfma_f32_16x16x32_bf16 v[36:39], a[204:207], a[164:167], v[36:39]
    ds_read_b64_tr_b16 a[234:235], v29 offset:43008
    buffer_store_dwordx4 v[80:83], v24, s[32:35], s61 offen offset:2048 sc1
    v_mfma_f32_16x16x32_bf16 v[40:43], a[208:211], a[160:163], v[40:43]
    ds_read_b64_tr_b16 a[204:205], v12 offset:49152
    v_cvt_pk_bf16_f32 v88, v88, v89
    v_mfma_f32_16x16x32_bf16 v[44:47], a[208:211], a[164:167], v[44:47]
    ds_read_b64_tr_b16 a[206:207], v12 offset:51200
    s_waitcnt lgkmcnt(10)
    v_mfma_f32_16x16x32_bf16 v[48:51], a[212:215], a[160:163], v[48:51]
    ds_read_b64_tr_b16 a[208:209], v13 offset:49152
    v_cvt_pk_bf16_f32 v89, v90, v91
    v_mfma_f32_16x16x32_bf16 v[52:55], a[212:215], a[164:167], v[52:55]
    ds_read_b64_tr_b16 a[210:211], v13 offset:51200
    v_cvt_pk_bf16_f32 v90, v92, v93
    v_mfma_f32_16x16x32_bf16 v[56:59], a[216:219], a[160:163], v[56:59]
    ds_read_b64_tr_b16 a[212:213], v14 offset:49152
    v_cvt_pk_bf16_f32 v91, v94, v95
    v_mfma_f32_16x16x32_bf16 v[60:63], a[216:219], a[164:167], v[60:63]
    ds_read_b64_tr_b16 a[214:215], v14 offset:51200
    s_waitcnt lgkmcnt(10)
    v_mfma_f32_16x16x32_bf16 v[32:35], a[220:223], a[168:171], v[32:35]
    ds_read_b64_tr_b16 a[216:217], v15 offset:49152
    buffer_store_dwordx4 v[88:91], v24, s[32:35], s61 offen offset:3072 sc1
    v_mfma_f32_16x16x32_bf16 v[36:39], a[220:223], a[172:175], v[36:39]
    ds_read_b64_tr_b16 a[218:219], v15 offset:51200
    v_mfma_f32_16x16x32_bf16 v[40:43], a[224:227], a[168:171], v[40:43]
    ds_read_b64_tr_b16 a[220:221], v12 offset:57344
    v_mfma_f32_16x16x32_bf16 v[44:47], a[224:227], a[172:175], v[44:47]
    ds_read_b64_tr_b16 a[222:223], v12 offset:59392
    s_waitcnt lgkmcnt(10)
    v_mfma_f32_16x16x32_bf16 v[48:51], a[228:231], a[168:171], v[48:51]
    ds_read_b64_tr_b16 a[224:225], v13 offset:57344
    v_mfma_f32_16x16x32_bf16 v[52:55], a[228:231], a[172:175], v[52:55]
    ds_read_b64_tr_b16 a[226:227], v13 offset:59392
    v_mfma_f32_16x16x32_bf16 v[56:59], a[232:235], a[168:171], v[56:59]
    ds_read_b64_tr_b16 a[228:229], v14 offset:57344
    v_mfma_f32_16x16x32_bf16 v[60:63], a[232:235], a[172:175], v[60:63]
    ds_read_b64_tr_b16 a[230:231], v14 offset:59392
    s_waitcnt lgkmcnt(10)
    v_mfma_f32_16x16x32_bf16 v[32:35], a[204:207], a[176:179], v[32:35]
    ds_read_b64_tr_b16 a[232:233], v15 offset:57344
    v_mfma_f32_16x16x32_bf16 v[36:39], a[204:207], a[180:183], v[36:39]
    ds_read_b64_tr_b16 a[234:235], v15 offset:59392
    v_mfma_f32_16x16x32_bf16 v[40:43], a[208:211], a[176:179], v[40:43]
    v_mfma_f32_16x16x32_bf16 v[44:47], a[208:211], a[180:183], v[44:47]
    s_waitcnt lgkmcnt(8)
    v_mfma_f32_16x16x32_bf16 v[48:51], a[212:215], a[176:179], v[48:51]
    v_mfma_f32_16x16x32_bf16 v[52:55], a[212:215], a[180:183], v[52:55]
    v_mfma_f32_16x16x32_bf16 v[56:59], a[216:219], a[176:179], v[56:59]
    v_mfma_f32_16x16x32_bf16 v[60:63], a[216:219], a[180:183], v[60:63]
    s_waitcnt lgkmcnt(4)
    v_mfma_f32_16x16x32_bf16 v[32:35], a[220:223], a[184:187], v[32:35]
    v_mfma_f32_16x16x32_bf16 v[36:39], a[220:223], a[188:191], v[36:39]
    v_mfma_f32_16x16x32_bf16 v[40:43], a[224:227], a[184:187], v[40:43]
    v_mfma_f32_16x16x32_bf16 v[44:47], a[224:227], a[188:191], v[44:47]
    s_waitcnt lgkmcnt(0)
    v_mfma_f32_16x16x32_bf16 v[48:51], a[228:231], a[184:187], v[48:51]
    v_mfma_f32_16x16x32_bf16 v[52:55], a[228:231], a[188:191], v[52:55]
    v_mfma_f32_16x16x32_bf16 v[56:59], a[232:235], a[184:187], v[56:59]
    v_mfma_f32_16x16x32_bf16 v[60:63], a[232:235], a[188:191], v[60:63]
    s_waitcnt vmcnt(4)
    v_permlane16_swap_b32 v96, v98
    v_permlane16_swap_b32 v97, v99
    v_permlane16_swap_b32 v100, v102
    v_permlane16_swap_b32 v101, v103
    v_permlane16_swap_b32 v104, v106
    v_permlane16_swap_b32 v105, v107
    v_permlane16_swap_b32 v108, v110
    v_permlane16_swap_b32 v109, v111
    v_lshlrev_b32 v4, 16, v96
    v_and_b32 v5, s56, v96
    v_lshlrev_b32 v6, 16, v97
    v_and_b32 v7, s56, v97
    v_pk_add_f32 v[32:33], v[32:33], v[4:5]
    v_pk_add_f32 v[34:35], v[34:35], v[6:7]
    v_lshlrev_b32 v4, 16, v104
    v_and_b32 v5, s56, v104
    v_lshlrev_b32 v6, 16, v105
    v_and_b32 v7, s56, v105
    v_pk_add_f32 v[36:37], v[36:37], v[4:5]
    v_pk_add_f32 v[38:39], v[38:39], v[6:7]
    v_lshlrev_b32 v4, 16, v98
    v_and_b32 v5, s56, v98
    v_lshlrev_b32 v6, 16, v99
    v_and_b32 v7, s56, v99
    v_pk_add_f32 v[40:41], v[40:41], v[4:5]
    v_pk_add_f32 v[42:43], v[42:43], v[6:7]
    v_lshlrev_b32 v4, 16, v106
    v_and_b32 v5, s56, v106
    v_lshlrev_b32 v6, 16, v107
    v_and_b32 v7, s56, v107
    v_pk_add_f32 v[44:45], v[44:45], v[4:5]
    v_pk_add_f32 v[46:47], v[46:47], v[6:7]
    v_lshlrev_b32 v4, 16, v100
    v_and_b32 v5, s56, v100
    v_lshlrev_b32 v6, 16, v101
    v_and_b32 v7, s56, v101
    v_pk_add_f32 v[48:49], v[48:49], v[4:5]
    v_pk_add_f32 v[50:51], v[50:51], v[6:7]
    v_lshlrev_b32 v4, 16, v108
    v_and_b32 v5, s56, v108
    v_lshlrev_b32 v6, 16, v109
    v_and_b32 v7, s56, v109
    v_pk_add_f32 v[52:53], v[52:53], v[4:5]
    v_pk_add_f32 v[54:55], v[54:55], v[6:7]
    v_lshlrev_b32 v4, 16, v102
    v_and_b32 v5, s56, v102
    v_lshlrev_b32 v6, 16, v103
    v_and_b32 v7, s56, v103
    v_pk_add_f32 v[56:57], v[56:57], v[4:5]
    v_pk_add_f32 v[58:59], v[58:59], v[6:7]
    v_lshlrev_b32 v4, 16, v110
    v_and_b32 v5, s56, v110
    v_lshlrev_b32 v6, 16, v111
    v_and_b32 v7, s56, v111
    v_pk_add_f32 v[60:61], v[60:61], v[4:5]
    v_pk_add_f32 v[62:63], v[62:63], v[6:7]
    buffer_load_dwordx4 v[112:115], v24, s[32:35], s62 offen offset:0 sc1
    buffer_load_dwordx4 v[116:119], v24, s[32:35], s62 offen offset:1024 sc1
    buffer_load_dwordx4 v[120:123], v24, s[32:35], s62 offen offset:2048 sc1
    buffer_load_dwordx4 v[124:127], v24, s[32:35], s62 offen offset:3072 sc1
    s_mov_b32 s59, 0
L_xpl_1030:
    s_waitcnt vmcnt(0)
    v_max3_u32 v4, v112, v113, v114
    v_max3_u32 v4, v4, v115, v116
    v_max3_u32 v4, v4, v117, v118
    v_max3_u32 v4, v4, v119, v120
    v_max3_u32 v4, v4, v121, v122
    v_max3_u32 v4, v4, v123, v124
    v_max3_u32 v4, v4, v125, v126
    v_max_u32 v4, v4, v127
    v_cmp_eq_u32 vcc, -1, v4
    s_add_u32 s59, s59, 1
    s_cmp_gt_u32 s59, 131072
    s_cbranch_scc1 L_xgo_1029
    s_cbranch_vccz L_xgo_1029
    buffer_load_dwordx4 v[112:115], v24, s[32:35], s62 offen offset:0 sc1
    buffer_load_dwordx4 v[116:119], v24, s[32:35], s62 offen offset:1024 sc1
    buffer_load_dwordx4 v[120:123], v24, s[32:35], s62 offen offset:2048 sc1
    buffer_load_dwordx4 v[124:127], v24, s[32:35], s62 offen offset:3072 sc1
    s_branch L_xpl_1030
L_xgo_1029:
    s_mov_b32 s61, 16384
    s_mov_b32 s62, 49152
    v_lshlrev_b32 v4, 16, v112
    v_and_b32 v5, s56, v112
    v_lshlrev_b32 v6, 16, v113
    v_and_b32 v7, s56, v113
    v_pk_add_f32 v[32:33], v[32:33], v[4:5]
    v_pk_add_f32 v[34:35], v[34:35], v[6:7]
    v_cvt_pk_bf16_f32 v96, v32, v33
    v_cvt_pk_bf16_f32 v97, v34, v35
    v_lshlrev_b32 v4, 16, v116
    v_and_b32 v5, s56, v116
    v_lshlrev_b32 v6, 16, v117
    v_and_b32 v7, s56, v117
    v_pk_add_f32 v[40:41], v[40:41], v[4:5]
    v_pk_add_f32 v[42:43], v[42:43], v[6:7]
    v_cvt_pk_bf16_f32 v98, v40, v41
    v_cvt_pk_bf16_f32 v99, v42, v43
    v_lshlrev_b32 v4, 16, v120
    v_and_b32 v5, s56, v120
    v_lshlrev_b32 v6, 16, v121
    v_and_b32 v7, s56, v121
    v_pk_add_f32 v[48:49], v[48:49], v[4:5]
    v_pk_add_f32 v[50:51], v[50:51], v[6:7]
    v_cvt_pk_bf16_f32 v100, v48, v49
    v_cvt_pk_bf16_f32 v101, v50, v51
    v_lshlrev_b32 v4, 16, v124
    v_and_b32 v5, s56, v124
    v_lshlrev_b32 v6, 16, v125
    v_and_b32 v7, s56, v125
    v_pk_add_f32 v[56:57], v[56:57], v[4:5]
    v_pk_add_f32 v[58:59], v[58:59], v[6:7]
    v_cvt_pk_bf16_f32 v102, v56, v57
    v_cvt_pk_bf16_f32 v103, v58, v59
    v_lshlrev_b32 v4, 16, v114
    v_and_b32 v5, s56, v114
    v_lshlrev_b32 v6, 16, v115
    v_and_b32 v7, s56, v115
    v_pk_add_f32 v[36:37], v[36:37], v[4:5]
    v_pk_add_f32 v[38:39], v[38:39], v[6:7]
    v_cvt_pk_bf16_f32 v104, v36, v37
    v_cvt_pk_bf16_f32 v105, v38, v39
    v_lshlrev_b32 v4, 16, v118
    v_and_b32 v5, s56, v118
    v_lshlrev_b32 v6, 16, v119
    v_and_b32 v7, s56, v119
    v_pk_add_f32 v[44:45], v[44:45], v[4:5]
    v_pk_add_f32 v[46:47], v[46:47], v[6:7]
    v_cvt_pk_bf16_f32 v106, v44, v45
    v_cvt_pk_bf16_f32 v107, v46, v47
    v_permlane16_swap_b32 v96, v98
    v_permlane16_swap_b32 v97, v99
    v_permlane16_swap_b32 v100, v102
    v_permlane16_swap_b32 v101, v103
    s_nop 0
    v_mov_b32 v4, v96
    v_mov_b32 v5, v97
    v_mov_b32 v6, v98
    v_mov_b32 v7, v99
    v_mov_b32_dpp v96, v100 row_ror:8 row_mask:0xf bank_mask:0xc
    v_mov_b32_dpp v97, v101 row_ror:8 row_mask:0xf bank_mask:0xc
    v_mov_b32_dpp v98, v102 row_ror:8 row_mask:0xf bank_mask:0xc
    v_mov_b32_dpp v99, v103 row_ror:8 row_mask:0xf bank_mask:0xc
    v_mov_b32_dpp v100, v4 row_ror:8 row_mask:0xf bank_mask:0x3
    v_mov_b32_dpp v101, v5 row_ror:8 row_mask:0xf bank_mask:0x3
    v_mov_b32_dpp v102, v6 row_ror:8 row_mask:0xf bank_mask:0x3
    v_mov_b32_dpp v103, v7 row_ror:8 row_mask:0xf bank_mask:0x3
    buffer_store_dwordx4 v[96:99], v22, s[44:47], 0 offen sc1
    buffer_store_dwordx4 v[100:103], v22, s[44:47], s61 offen sc1
    v_lshlrev_b32 v4, 16, v122
    v_and_b32 v5, s56, v122
    v_lshlrev_b32 v6, 16, v123
    v_and_b32 v7, s56, v123
    v_pk_add_f32 v[52:53], v[52:53], v[4:5]
    v_pk_add_f32 v[54:55], v[54:55], v[6:7]
    v_cvt_pk_bf16_f32 v108, v52, v53
    v_cvt_pk_bf16_f32 v109, v54, v55
    v_lshlrev_b32 v4, 16, v126
    v_and_b32 v5, s56, v126
    v_lshlrev_b32 v6, 16, v127
    v_and_b32 v7, s56, v127
    v_pk_add_f32 v[60:61], v[60:61], v[4:5]
    v_pk_add_f32 v[62:63], v[62:63], v[6:7]
    v_cvt_pk_bf16_f32 v110, v60, v61
    v_cvt_pk_bf16_f32 v111, v62, v63
    s_nop 1
    v_permlane16_swap_b32 v104, v106
    v_permlane16_swap_b32 v105, v107
    v_permlane16_swap_b32 v108, v110
    v_permlane16_swap_b32 v109, v111
    s_nop 0
    v_mov_b32 v4, v104
    v_mov_b32 v5, v105
    v_mov_b32 v6, v106
    v_mov_b32 v7, v107
    v_mov_b32_dpp v104, v108 row_ror:8 row_mask:0xf bank_mask:0xc
    v_mov_b32_dpp v105, v109 row_ror:8 row_mask:0xf bank_mask:0xc
    v_mov_b32_dpp v106, v110 row_ror:8 row_mask:0xf bank_mask:0xc
    v_mov_b32_dpp v107, v111 row_ror:8 row_mask:0xf bank_mask:0xc
    v_mov_b32_dpp v108, v4 row_ror:8 row_mask:0xf bank_mask:0x3
    v_mov_b32_dpp v109, v5 row_ror:8 row_mask:0xf bank_mask:0x3
    v_mov_b32_dpp v110, v6 row_ror:8 row_mask:0xf bank_mask:0x3
    v_mov_b32_dpp v111, v7 row_ror:8 row_mask:0xf bank_mask:0x3
    buffer_store_dwordx4 v[104:107], v22, s[44:47], s60 offen sc1
    buffer_store_dwordx4 v[108:111], v22, s[44:47], s62 offen sc1
sequential_preLN__ssm_conv_h3__glu_gated_bilinear__prompt_kernel_done:
    s_endpgm
L_c4s_1022:
    s_mov_b32 s80, 0
L_c4s_1022l:
    buffer_load_dword v31, v30, s[52:55], 0 offen sc1
    s_waitcnt vmcnt(0)
    v_cmp_gt_u32 vcc, 16, v31
    s_add_u32 s80, s80, 1
    s_cmp_gt_u32 s80, 131072
    s_cbranch_scc1 L_c4b_1023
    s_cbranch_vccnz L_c4s_1022l
    s_branch L_c4b_1023
L_c4t_1024:
    s_mov_b32 s80, 0
L_c4t_1024l:
    buffer_load_dword v31, v30, s[52:55], s79 offen sc1
    s_waitcnt vmcnt(0)
    v_cmp_gt_u32 vcc, 16, v31
    s_add_u32 s80, s80, 1
    s_cmp_gt_u32 s80, 131072
    s_cbranch_scc1 L_c4u_1025
    s_cbranch_vccnz L_c4t_1024l
    s_branch L_c4u_1025
L_c4t_1027:
    s_mov_b32 s80, 0
L_c4t_1027l:
    buffer_load_dword v31, v30, s[52:55], s77 offen sc1
    s_waitcnt vmcnt(0)
    v_cmp_gt_u32 vcc, 16, v31
    s_add_u32 s80, s80, 1
    s_cmp_gt_u32 s80, 131072
    s_cbranch_scc1 L_c4u_1028
    s_cbranch_vccnz L_c4t_1027l
    s_branch L_c4u_1028
    s_endpgm
.section .rodata,"a"
.p2align 6
.amdhsa_kernel sequential_preLN__ssm_conv_h3__glu_gated_bilinear__prompt_kernel
  .amdhsa_next_free_vgpr 512
  .amdhsa_next_free_sgpr 102
  .amdhsa_accum_offset 256
  .amdhsa_group_segment_fixed_size 0
  .amdhsa_kernarg_size 104
  .amdhsa_user_sgpr_count 2
  .amdhsa_user_sgpr_kernarg_segment_ptr 1
  .amdhsa_system_sgpr_workgroup_id_x 1
  .amdhsa_float_denorm_mode_32 3
.end_amdhsa_kernel
```
